```python
import torch

def _softmax(x, axis=-1):
    return torch.softmax(x, dim=axis)
def _gelu(x):
    return torch.nn.functional.gelu(x, approximate="tanh")
def _silu(x):
    return torch.nn.functional.silu(x)
def _sigmoid(x):
    return torch.sigmoid(x)
def _layernorm(x, axis=-1, eps=1e-5):
    m = x.mean(dim=axis, keepdim=True)
    v = x.var(dim=axis, keepdim=True, unbiased=False)
    return (x - m) / torch.sqrt(v + eps)
def _scatter_add(tgt, idx, src, axis=0):
    return tgt.clone().index_add_(axis, idx, src)
def _segment_sum(src, seg, n):
    out = torch.zeros((n,) + src.shape[1:], dtype=src.dtype)
    return out.index_add_(0, seg, src)
def _pad(x, pw):
    flat = tuple(v for pair in reversed(pw) for v in pair)
    return torch.nn.functional.pad(x, flat)

kernel_name = 'gated_mix__softmax_full_mha__dense_activation_squared_relu__prompt'

def setup_inputs():

    _w = (lambda a: (lambda t: t.to(torch.bfloat16) if t.is_floating_point() else t)(torch.as_tensor(a)))
    def _A_setup():
        B, S, D = 1, 2048, 512
        return {
            "x": _w((lambda *s: torch.randn(*s, dtype=torch.bfloat16) * 0.05)(B, S, D)),
            "wqkv": _w((lambda *s: torch.randn(*s, dtype=torch.bfloat16) * 0.8)(D, 3 * D)),
            "wo": _w((lambda *s: torch.randn(*s, dtype=torch.bfloat16) * 0.1)(D, D)),
        }
    _A_in = _A_setup()

    def _B_setup():
        B, S, D, F = 1, 2048, 512, 1376
        return {
            "x": _w((lambda *s: torch.randn(*s, dtype=torch.bfloat16) * 0.05)(B, S, D)),
            "w1": _w((lambda *s: torch.randn(*s, dtype=torch.bfloat16) * 0.1)(D, F)),
            "b1": _w((lambda *s: torch.randn(*s, dtype=torch.bfloat16) * 0.1)(F)),
            "w2": _w((lambda *s: torch.randn(*s, dtype=torch.bfloat16) * 0.1)(F, D)),
            "b2": _w((lambda *s: torch.randn(*s, dtype=torch.bfloat16) * 0.05)(D)),
        }
    _B_in = _B_setup()

    return {
        "A_x": _A_in["x"],
        "A_wqkv": _A_in["wqkv"],
        "A_wo": _A_in["wo"],
        "B_x": _B_in["x"],
        "B_w1": _B_in["w1"],
        "B_b1": _B_in["b1"],
        "B_w2": _B_in["w2"],
        "B_b2": _B_in["b2"],
        "gate_w": _w((lambda *s: torch.randn(*s, dtype=torch.bfloat16) * 0.05)(512) * 16.0),
    }

def reference(A_x, A_wqkv, A_wo, B_x, B_w1, B_b1, B_w2, B_b2, gate_w):
    def _A_ref(x, wqkv, wo):
        B, S, D = x.shape
        H = 32; Dh = D // H
        qkv = (lambda x, *d: x.permute(*d))((x @ wqkv).reshape(B, S, 3, H, Dh), 2, 0, 3, 1, 4)
        q, k, v = qkv[0], qkv[1], qkv[2]
        scale = Dh ** -0.5
        scores = torch.einsum("bhqd,bhkd->bhqk", q, k) * scale
        p = _softmax(scores, axis=-1)
        o = torch.einsum("bhqk,bhkd->bhqd", p, v)
        return (lambda x, *d: x.permute(*d))(o, 0, 2, 1, 3).reshape(B, S, D) @ wo

    def _B_ref(x, w1, b1, w2, b2):
        h = torch.einsum("bsd,df->bsf", x, w1) + b1
        zero = torch.zeros_like(h)
        r = torch.where(h > zero, h, zero)
        h = r * r
        out = torch.einsum("bsf,fd->bsd", h, w2) + b2
        return out

    x = A_x
    g = _sigmoid((x * gate_w).sum(-1, keepdims=True))
    a = _A_ref(x, A_wqkv, A_wo)
    b = _B_ref(x, B_w1, B_b1, B_w2, B_b2)
    return g * a + (1 - g) * b
```

```asm
; @launch grid=(256,1,1) block=(512,1,1) lds=163840
.amdgcn_target "amdgcn-amd-amdhsa--gfx950"
.text
.globl gated_mix__softmax_full_mha__dense_activation_squared_relu__prompt_kernel
.p2align 8
.type gated_mix__softmax_full_mha__dense_activation_squared_relu__prompt_kernel,@function
gated_mix__softmax_full_mha__dense_activation_squared_relu__prompt_kernel:
    s_cmp_ge_u32 s2, 256
    s_cbranch_scc1 Lend
    s_load_dwordx16 s[16:31], s[0:1], 0
    s_load_dwordx8 s[32:39], s[0:1], 64
    v_lshrrev_b32 v1, 6, v0
    v_and_b32 v0, 63, v0
    s_and_b32 s4, s2, 7
    v_readfirstlane_b32 s3, v1
    s_lshr_b32 s5, s2, 3
    s_and_b32 s14, s4, 1
    s_lshl_b32 s14, s14, 3
    s_and_b32 s15, s5, 7
    s_add_u32 s6, s14, s15
    s_lshr_b32 s14, s4, 1
    s_lshl_b32 s14, s14, 2
    s_lshr_b32 s80, s5, 3
    s_add_u32 s7, s14, s80
    s_lshl_b32 s80, s80, 1
    s_add_u32 s8, s15, s80
    s_and_b32 s99, s3, 3
    s_cmp_lt_u32 s3, 4
    s_cbranch_scc1 Lcomp
    v_lshrrev_b32 v12, 3, v0
    v_and_b32 v13, 7, v0
    v_lshrrev_b32 v14, 4, v0
    v_xor_b32 v13, v13, v14
    v_lshlrev_b32 v12, 10, v12
    s_lshl_b32 s14, s6, 2
    s_add_u32 s14, s14, s99
    s_lshl_b32 s14, s14, 15
    v_add_u32 v12, s14, v12
    v_lshl_add_u32 v1, v13, 4, v12
    v_xor_b32 v2, 64, v1
    v_add_u32 v2, 8192, v2
    v_add_u32 v3, 16384, v1
    v_add_u32 v4, 16384, v2
    s_mul_i32 s14, s7, 192
    s_lshl_b32 s15, s99, 4
    s_movk_i32 s82, 3072
    s_movk_i32 s83, 2752
    v_add_u32 v12, 0, v0
    v_mul_u32_u24 v13, 5462, v12
    v_lshrrev_b32 v13, 16, v13
    v_mul_u32_u24 v14, 12, v13
    v_sub_u32 v12, v12, v14
    v_lshl_add_u32 v12, v12, 4, s14
    v_add_u32 v13, s15, v13
    v_mad_u32_u24 v5, v13, s82, v12
    v_mad_u32_u24 v8, v13, s83, v12
    v_add_u32 v12, 64, v0
    v_mul_u32_u24 v13, 5462, v12
    v_lshrrev_b32 v13, 16, v13
    v_mul_u32_u24 v14, 12, v13
    v_sub_u32 v12, v12, v14
    v_lshl_add_u32 v12, v12, 4, s14
    v_add_u32 v13, s15, v13
    v_mad_u32_u24 v6, v13, s82, v12
    v_mad_u32_u24 v9, v13, s83, v12
    v_add_u32 v12, 128, v0
    v_mul_u32_u24 v13, 5462, v12
    v_lshrrev_b32 v13, 16, v13
    v_mul_u32_u24 v14, 12, v13
    v_sub_u32 v12, v12, v14
    v_lshl_add_u32 v12, v12, 4, s14
    v_add_u32 v13, s15, v13
    v_mad_u32_u24 v7, v13, s82, v12
    v_mad_u32_u24 v10, v13, s83, v12
    s_lshl_b32 s80, s99, 12
    s_mul_i32 s81, s99, 3072
    s_mov_b32 s42, 2097152
    s_mov_b32 s43, 0x20000
    s_mov_b32 s46, 1572864
    s_mov_b32 s47, 0x20000
    s_add_u32 s14, s8, 0
    s_and_b32 s14, s14, 7
    s_lshl_b32 s82, s14, 7
    s_mul_i32 s83, s14, 196608
    s_waitcnt lgkmcnt(0)
    s_mov_b32 s40, s16
    s_mov_b32 s41, s17
    s_mov_b32 s44, s18
    s_mov_b32 s45, s19
    s_add_u32 m0, s80, 28672
    s_nop 0
    buffer_load_dwordx4 v1, s[40:43], s82 offen   lds
    s_add_u32 m0, s80, 29696
    s_nop 0
    buffer_load_dwordx4 v2, s[40:43], s82 offen   lds
    s_add_u32 m0, s80, 30720
    s_nop 0
    buffer_load_dwordx4 v3, s[40:43], s82 offen   lds
    s_add_u32 m0, s80, 31744
    s_nop 0
    buffer_load_dwordx4 v4, s[40:43], s82 offen   lds
    s_add_u32 m0, s81, 45056
    s_nop 0
    buffer_load_dwordx4 v5, s[44:47], s83 offen   lds
    s_add_u32 m0, s81, 46080
    s_nop 0
    buffer_load_dwordx4 v6, s[44:47], s83 offen   lds
    s_add_u32 m0, s81, 47104
    s_nop 0
    buffer_load_dwordx4 v7, s[44:47], s83 offen   lds
    s_mov_b32 s54, 268435456
    s_mov_b32 s55, 0x20000
    s_mov_b32 s52, s38
    s_mov_b32 s53, s39
    s_mov_b32 s15, 15007744
    buffer_load_dword v15, off, s[52:55], s15 sc1
    s_add_u32 s14, s8, 1
    s_and_b32 s14, s14, 7
    s_lshl_b32 s82, s14, 7
    s_mul_i32 s83, s14, 196608
    s_add_u32 m0, s80, 57344
    s_nop 0
    buffer_load_dwordx4 v1, s[40:43], s82 offen   lds
    s_add_u32 m0, s80, 58368
    s_nop 0
    buffer_load_dwordx4 v2, s[40:43], s82 offen   lds
    s_add_u32 m0, s80, 59392
    s_nop 0
    buffer_load_dwordx4 v3, s[40:43], s82 offen   lds
    s_add_u32 m0, s80, 60416
    s_nop 0
    buffer_load_dwordx4 v4, s[40:43], s82 offen   lds
    s_add_u32 m0, s81, 73728
    s_nop 0
    buffer_load_dwordx4 v5, s[44:47], s83 offen   lds
    s_add_u32 m0, s81, 74752
    s_nop 0
    buffer_load_dwordx4 v6, s[44:47], s83 offen   lds
    s_add_u32 m0, s81, 75776
    s_nop 0
    buffer_load_dwordx4 v7, s[44:47], s83 offen   lds
    s_add_u32 s14, s8, 2
    s_and_b32 s14, s14, 7
    s_lshl_b32 s82, s14, 7
    s_mul_i32 s83, s14, 196608
    s_add_u32 m0, s80, 86016
    s_nop 0
    buffer_load_dwordx4 v1, s[40:43], s82 offen   lds
    s_add_u32 m0, s80, 87040
    s_nop 0
    buffer_load_dwordx4 v2, s[40:43], s82 offen   lds
    s_add_u32 m0, s80, 88064
    s_nop 0
    buffer_load_dwordx4 v3, s[40:43], s82 offen   lds
    s_add_u32 m0, s80, 89088
    s_nop 0
    buffer_load_dwordx4 v4, s[40:43], s82 offen   lds
    s_add_u32 m0, s81, 102400
    s_nop 0
    buffer_load_dwordx4 v5, s[44:47], s83 offen   lds
    s_add_u32 m0, s81, 103424
    s_nop 0
    buffer_load_dwordx4 v6, s[44:47], s83 offen   lds
    s_add_u32 m0, s81, 104448
    s_nop 0
    buffer_load_dwordx4 v7, s[44:47], s83 offen   lds
    s_add_u32 s14, s8, 3
    s_and_b32 s14, s14, 7
    s_lshl_b32 s82, s14, 7
    s_mul_i32 s83, s14, 196608
    s_add_u32 m0, s80, 114688
    s_nop 0
    buffer_load_dwordx4 v1, s[40:43], s82 offen   lds
    s_add_u32 m0, s80, 115712
    s_nop 0
    buffer_load_dwordx4 v2, s[40:43], s82 offen   lds
    s_add_u32 m0, s80, 116736
    s_nop 0
    buffer_load_dwordx4 v3, s[40:43], s82 offen   lds
    s_add_u32 m0, s80, 117760
    s_nop 0
    buffer_load_dwordx4 v4, s[40:43], s82 offen   lds
    s_add_u32 m0, s81, 131072
    s_nop 0
    buffer_load_dwordx4 v5, s[44:47], s83 offen   lds
    s_add_u32 m0, s81, 132096
    s_nop 0
    buffer_load_dwordx4 v6, s[44:47], s83 offen   lds
    s_add_u32 m0, s81, 133120
    s_nop 0
    buffer_load_dwordx4 v7, s[44:47], s83 offen   lds
    s_mov_b32 s50, 1409024
    s_mov_b32 s51, 0x20000
    s_mov_b32 s58, 524288
    s_mov_b32 s59, 0x20000
    s_mov_b32 s62, 1409024
    s_mov_b32 s63, 0x20000
    s_mov_b32 s66, 2097152
    s_mov_b32 s67, 0x20000
    s_mov_b32 s74, 1024
    s_mov_b32 s75, 0x20000
    s_mov_b32 s78, 1024
    s_mov_b32 s79, 0x20000
    s_mov_b32 s48, s24
    s_mov_b32 s49, s25
    s_mov_b32 s56, s20
    s_mov_b32 s57, s21
    s_mov_b32 s60, s28
    s_mov_b32 s61, s29
    s_mov_b32 s64, s34
    s_mov_b32 s65, s35
    s_mov_b32 s72, s30
    s_mov_b32 s73, s31
    s_mov_b32 s76, s32
    s_mov_b32 s77, s33
    s_cmp_eq_u32 s7, 15
    s_cselect_b32 s50, 0, s50
    v_lshlrev_b32 v11, 4, v0
    s_and_b32 s14, s5, 3
    s_lshl_b32 s15, s4, 2
    s_add_u32 s9, s15, s14
    s_lshr_b32 s10, s5, 2
    s_and_b32 s11, s4, 3
    s_and_b32 s15, s4, 4
    s_add_u32 s12, s15, s14
    s_waitcnt vmcnt(21)
    v_readfirstlane_b32 s14, v15
    s_mul_i32 s13, s14, 0x9E3779B1
    s_add_u32 s13, s13, 0x7F4A7C15
    s_or_b32 s13, s13, 0x80000000
    s_xor_b32 s15, s13, 1
    s_cmp_eq_u32 s13, s14
    s_cselect_b32 s13, s15, s13
    s_barrier
    s_add_u32 s14, s8, 4
    s_and_b32 s14, s14, 7
    s_lshl_b32 s82, s14, 7
    s_mul_i32 s83, s14, 196608
    s_add_u32 m0, s80, 0
    s_nop 0
    buffer_load_dwordx4 v1, s[40:43], s82 offen   lds
    s_add_u32 m0, s80, 1024
    s_nop 0
    buffer_load_dwordx4 v2, s[40:43], s82 offen   lds
    s_add_u32 m0, s80, 2048
    s_nop 0
    buffer_load_dwordx4 v3, s[40:43], s82 offen   lds
    s_add_u32 m0, s80, 3072
    s_nop 0
    buffer_load_dwordx4 v4, s[40:43], s82 offen   lds
    s_add_u32 m0, s81, 16384
    s_nop 0
    buffer_load_dwordx4 v5, s[44:47], s83 offen   lds
    s_add_u32 m0, s81, 17408
    s_nop 0
    buffer_load_dwordx4 v6, s[44:47], s83 offen   lds
    s_add_u32 m0, s81, 18432
    s_nop 0
    buffer_load_dwordx4 v7, s[44:47], s83 offen   lds
    s_lshr_b32 s84, s9, 1
    s_lshl_b32 s85, s99, 7
    s_add_u32 s85, s85, 14745600
    v_and_b32 v12, 15, v0
    v_lshlrev_b32 v12, 2, v12
    s_add_u32 s14, s84, 16
    s_mul_i32 s14, s14, 21846
    s_lshr_b32 s14, s14, 16
    s_lshl_b32 s14, s14, 9
    s_add_u32 s14, s14, s85
    v_add_u32 v208, s14, v12
    s_add_u32 s14, s84, 32
    s_mul_i32 s14, s14, 21846
    s_lshr_b32 s14, s14, 16
    s_lshl_b32 s14, s14, 9
    s_add_u32 s14, s14, s85
    v_add_u32 v13, s14, v12
    v_cmp_gt_u32 vcc, 16, v0
    s_mul_i32 s14, s84, 21846
    s_lshr_b32 s14, s14, 16
    s_lshl_b32 s14, s14, 9
    v_cndmask_b32 v208, v13, v208, vcc
    s_and_b32 s15, s99, 1
    s_lshl_b32 s15, s15, 8
    s_add_u32 s14, s14, s15
    s_lshl_b32 s15, s10, 1
    s_lshr_b32 s86, s99, 1
    s_add_u32 s15, s15, s86
    s_lshl_b32 s15, s15, 2
    s_add_u32 s14, s14, s15
    s_add_u32 s14, s14, 14745600
    v_and_b32 v12, 1, v0
    v_lshl_add_u32 v13, v12, 7, s14
    v_cmp_gt_u32 vcc, 32, v0
    v_lshrrev_b32 v12, 2, v0
    s_nop 0
    v_cndmask_b32 v208, v13, v208, vcc
    v_and_b32 v13, 3, v0
    s_waitcnt vmcnt(21)
    s_barrier
    s_mov_b32 m0, 155648
    s_mov_b32 s14, 0
    buffer_load_dwordx4 v11, s[76:79], s14 offen   lds
    s_add_u32 s14, s8, 0
    s_and_b32 s14, s14, 7
    s_mul_i32 s83, s14, 176128
    s_add_u32 m0, s81, 143360
    s_nop 0
    buffer_load_dwordx4 v8, s[48:51], s83 offen   lds
    s_add_u32 m0, s81, 144384
    s_nop 0
    buffer_load_dwordx4 v9, s[48:51], s83 offen   lds
    s_add_u32 m0, s81, 145408
    s_nop 0
    buffer_load_dwordx4 v10, s[48:51], s83 offen   lds
    v_lshlrev_b32 v209, 10, v12
    v_lshl_add_u32 v209, v13, 4, v209
    s_lshl_b32 s14, s12, 7
    s_and_b32 s15, s99, 1
    s_lshl_b32 s15, s15, 6
    s_add_u32 s14, s14, s15
    v_add_u32 v209, s14, v209
    v_xor_b32 v210, 64, v209
    s_lshl_b32 s85, s99, 11
    s_lshl_b32 s84, s9, 17
    s_add_u32 s84, s84, 2097152
    s_add_u32 s84, s84, s85
    s_lshl_b32 s14, s9, 6
    s_lshl_b32 s15, s10, 3
    s_add_u32 s14, s14, s15
    s_lshl_b32 s15, s99, 1
    s_add_u32 s14, s14, s15
    s_lshl_b32 s88, s14, 10
    s_lshl_b32 s89, s99, 13
    s_add_u32 s89, s89, 131072
    s_lshl_b32 s90, s99, 14
    s_lshl_b32 s91, s99, 17
    s_waitcnt vmcnt(18)
    s_barrier
    s_add_u32 s14, s8, 5
    s_and_b32 s14, s14, 7
    s_lshl_b32 s82, s14, 7
    s_mul_i32 s83, s14, 196608
    s_add_u32 m0, s80, 28672
    s_nop 0
    buffer_load_dwordx4 v1, s[40:43], s82 offen   lds
    s_add_u32 m0, s80, 29696
    s_nop 0
    buffer_load_dwordx4 v2, s[40:43], s82 offen   lds
    s_add_u32 m0, s80, 30720
    s_nop 0
    buffer_load_dwordx4 v3, s[40:43], s82 offen   lds
    s_add_u32 m0, s80, 31744
    s_nop 0
    buffer_load_dwordx4 v4, s[40:43], s82 offen   lds
    s_add_u32 m0, s81, 45056
    s_nop 0
    buffer_load_dwordx4 v5, s[44:47], s83 offen   lds
    s_add_u32 m0, s81, 46080
    s_nop 0
    buffer_load_dwordx4 v6, s[44:47], s83 offen   lds
    s_add_u32 m0, s81, 47104
    s_nop 0
    buffer_load_dwordx4 v7, s[44:47], s83 offen   lds
    v_lshrrev_b32 v14, 5, v0
    v_bfe_u32 v12, v0, 2, 2
    v_lshl_add_u32 v12, v14, 2, v12
    v_lshlrev_b32 v12, 6, v12
    v_bfe_u32 v13, v0, 4, 1
    v_lshl_add_u32 v12, v13, 5, v12
    v_and_b32 v13, 3, v0
    v_lshl_add_u32 v12, v13, 3, v12
    v_add_u32 v211, s89, v12
    s_lshl_b32 s14, s10, 2
    s_add_u32 s92, s14, s11
    s_lshl_b32 s14, s92, 8
    s_add_u32 s14, s14, 14811136
    v_bfe_u32 v12, v0, 4, 1
    v_and_b32 v13, 15, v0
    v_lshlrev_b32 v12, 7, v12
    v_lshl_add_u32 v12, v13, 2, v12
    v_add_u32 v212, s14, v12
    s_waitcnt vmcnt(18)
    s_barrier
    s_add_u32 s14, s8, 6
    s_and_b32 s14, s14, 7
    s_lshl_b32 s82, s14, 7
    s_mul_i32 s83, s14, 196608
    s_add_u32 m0, s80, 57344
    s_nop 0
    buffer_load_dwordx4 v1, s[40:43], s82 offen   lds
    s_add_u32 m0, s80, 58368
    s_nop 0
    buffer_load_dwordx4 v2, s[40:43], s82 offen   lds
    s_add_u32 m0, s80, 59392
    s_nop 0
    buffer_load_dwordx4 v3, s[40:43], s82 offen   lds
    s_add_u32 m0, s80, 60416
    s_nop 0
    buffer_load_dwordx4 v4, s[40:43], s82 offen   lds
    s_add_u32 m0, s81, 73728
    s_nop 0
    buffer_load_dwordx4 v5, s[44:47], s83 offen   lds
    s_add_u32 m0, s81, 74752
    s_nop 0
    buffer_load_dwordx4 v6, s[44:47], s83 offen   lds
    s_add_u32 m0, s81, 75776
    s_nop 0
    buffer_load_dwordx4 v7, s[44:47], s83 offen   lds
    v_and_b32 v13, 31, v0
    s_lshl_b32 s14, s92, 8
    s_add_u32 s14, s14, 14680064
    s_lshr_b32 s15, s99, 1
    s_lshl_b32 s15, s15, 7
    s_add_u32 s14, s14, s15
    v_lshl_add_u32 v213, v13, 2, s14
    v_xor_b32 v214, 128, v213
    s_lshl_b32 s14, s12, 7
    v_lshl_add_u32 v215, v13, 1, s14
    s_lshl_b32 s14, s92, 2
    s_add_u32 s14, s14, s99
    s_lshl_b32 s94, s14, 14
    s_add_u32 s94, s94, 12582912
    s_lshl_b32 s14, s14, 7
    s_add_u32 s14, s14, 14876672
    v_and_b32 v12, 7, v0
    v_lshl_add_u32 v216, v12, 2, s14
    s_mul_i32 s93, s92, 176128
    s_lshl_b32 s14, s99, 10
    s_add_u32 s93, s93, s14
    s_add_u32 s93, s93, 6291456
    s_waitcnt vmcnt(18)
    s_barrier
    s_add_u32 s14, s8, 7
    s_and_b32 s14, s14, 7
    s_lshl_b32 s82, s14, 7
    s_mul_i32 s83, s14, 196608
    s_add_u32 m0, s80, 86016
    s_nop 0
    buffer_load_dwordx4 v1, s[40:43], s82 offen   lds
    s_add_u32 m0, s80, 87040
    s_nop 0
    buffer_load_dwordx4 v2, s[40:43], s82 offen   lds
    s_add_u32 m0, s80, 88064
    s_nop 0
    buffer_load_dwordx4 v3, s[40:43], s82 offen   lds
    s_add_u32 m0, s80, 89088
    s_nop 0
    buffer_load_dwordx4 v4, s[40:43], s82 offen   lds
    s_add_u32 m0, s81, 102400
    s_nop 0
    buffer_load_dwordx4 v5, s[44:47], s83 offen   lds
    s_add_u32 m0, s81, 103424
    s_nop 0
    buffer_load_dwordx4 v6, s[44:47], s83 offen   lds
    s_add_u32 m0, s81, 104448
    s_nop 0
    buffer_load_dwordx4 v7, s[44:47], s83 offen   lds
    s_lshr_b32 s14, s99, 1
    s_lshl_b32 s14, s14, 5
    s_lshl_b32 s15, s92, 6
    s_add_u32 s14, s14, s15
    v_add_u32 v12, s14, v13
    v_lshlrev_b32 v12, 10, v12
    v_lshl_add_u32 v12, v14, 4, v12
    s_lshl_b32 s14, s12, 7
    s_and_b32 s15, s99, 1
    s_lshl_b32 s15, s15, 6
    s_add_u32 s14, s14, s15
    v_add_u32 v219, s14, v12
    v_mov_b32 v132, 0
    v_mov_b32 v133, 0
    v_mov_b32 v134, 0
    v_mov_b32 v135, 0
    v_mov_b32 v136, 0
    v_mov_b32 v137, 0
    v_mov_b32 v138, 0
    v_mov_b32 v139, 0
    v_mov_b32 v140, 0
    v_mov_b32 v141, 0
    v_mov_b32 v142, 0
    v_mov_b32 v143, 0
    v_mov_b32 v12, 0x3f80
    v_cmp_gt_u32 vcc, 32, v0
    s_lshr_b32 s14, s99, 1
    s_mul_i32 s15, s14, 88064
    v_cndmask_b32 v140, 0, v12, vcc
    v_add_u32 v217, s15, v11
    s_sub_u32 s15, 88064, s15
    v_add_u32 v218, s15, v11
    s_waitcnt vmcnt(14)
    s_barrier
    s_add_u32 s14, s8, 1
    s_and_b32 s14, s14, 7
    s_mul_i32 s83, s14, 176128
    s_add_u32 m0, s81, 114688
    s_nop 0
    buffer_load_dwordx4 v8, s[48:51], s83 offen   lds
    s_add_u32 m0, s81, 115712
    s_nop 0
    buffer_load_dwordx4 v9, s[48:51], s83 offen   lds
    s_add_u32 m0, s81, 116736
    s_nop 0
    buffer_load_dwordx4 v10, s[48:51], s83 offen   lds
    s_add_u32 s14, s8, 2
    s_and_b32 s14, s14, 7
    s_mul_i32 s83, s14, 176128
    s_add_u32 m0, s81, 126976
    s_nop 0
    buffer_load_dwordx4 v8, s[48:51], s83 offen   lds
    s_add_u32 m0, s81, 128000
    s_nop 0
    buffer_load_dwordx4 v9, s[48:51], s83 offen   lds
    s_add_u32 m0, s81, 129024
    s_nop 0
    buffer_load_dwordx4 v10, s[48:51], s83 offen   lds
    s_lshr_b32 s14, s99, 1
    s_lshl_b32 s14, s14, 10
    v_add_u32 v220, s14, v11
    v_xor_b32 v221, 1024, v220
    s_xor_b32 s14, s99, 1
    s_mul_i32 s14, s14, 12288
    s_add_u32 s14, s14, 0
    v_add_u32 v226, s14, v11
    s_xor_b32 s14, s99, 2
    s_mul_i32 s14, s14, 12288
    s_add_u32 s14, s14, 4096
    v_add_u32 v227, s14, v11
    s_xor_b32 s14, s99, 3
    s_mul_i32 s14, s14, 12288
    s_add_u32 s14, s14, 8192
    v_add_u32 v228, s14, v11
    s_mul_i32 s14, s99, 12288
    v_add_u32 v225, s14, v11
    v_lshrrev_b32 v14, 4, v0
    s_lshl_b32 s14, s99, 11
    s_add_u32 s14, s14, 14745600
    v_lshl_add_u32 v14, v14, 9, s14
    v_and_b32 v13, 15, v0
    v_lshl_add_u32 v222, v13, 2, v14
    s_waitcnt vmcnt(13)
    s_barrier
    s_add_u32 s14, s8, 3
    s_and_b32 s14, s14, 7
    s_mul_i32 s83, s14, 176128
    s_add_u32 m0, s81, 0
    s_nop 0
    buffer_load_dwordx4 v8, s[48:51], s83 offen   lds
    s_add_u32 m0, s81, 1024
    s_nop 0
    buffer_load_dwordx4 v9, s[48:51], s83 offen   lds
    s_add_u32 m0, s81, 2048
    s_nop 0
    buffer_load_dwordx4 v10, s[48:51], s83 offen   lds
    s_add_u32 s14, s8, 4
    s_and_b32 s14, s14, 7
    s_mul_i32 s83, s14, 176128
    s_add_u32 m0, s81, 12288
    s_nop 0
    buffer_load_dwordx4 v8, s[48:51], s83 offen   lds
    s_add_u32 m0, s81, 13312
    s_nop 0
    buffer_load_dwordx4 v9, s[48:51], s83 offen   lds
    s_add_u32 m0, s81, 14336
    s_nop 0
    buffer_load_dwordx4 v10, s[48:51], s83 offen   lds
    s_waitcnt vmcnt(12)
    s_barrier
    s_waitcnt vmcnt(9)
    s_barrier
    s_waitcnt vmcnt(0)
    s_barrier
    s_add_u32 s14, s8, 5
    s_and_b32 s14, s14, 7
    s_mul_i32 s83, s14, 176128
    s_add_u32 m0, s81, 28672
    s_nop 0
    buffer_load_dwordx4 v8, s[48:51], s83 offen   lds
    s_add_u32 m0, s81, 29696
    s_nop 0
    buffer_load_dwordx4 v9, s[48:51], s83 offen   lds
    s_add_u32 m0, s81, 30720
    s_nop 0
    buffer_load_dwordx4 v10, s[48:51], s83 offen   lds
    s_add_u32 s14, s8, 6
    s_and_b32 s14, s14, 7
    s_mul_i32 s83, s14, 176128
    s_add_u32 m0, s81, 40960
    s_nop 0
    buffer_load_dwordx4 v8, s[48:51], s83 offen   lds
    s_add_u32 m0, s81, 41984
    s_nop 0
    buffer_load_dwordx4 v9, s[48:51], s83 offen   lds
    s_add_u32 m0, s81, 43008
    s_nop 0
    buffer_load_dwordx4 v10, s[48:51], s83 offen   lds
    s_add_u32 s14, s8, 7
    s_and_b32 s14, s14, 7
    s_mul_i32 s83, s14, 176128
    s_add_u32 m0, s81, 57344
    s_nop 0
    buffer_load_dwordx4 v8, s[48:51], s83 offen   lds
    s_add_u32 m0, s81, 58368
    s_nop 0
    buffer_load_dwordx4 v9, s[48:51], s83 offen   lds
    s_add_u32 m0, s81, 59392
    s_nop 0
    buffer_load_dwordx4 v10, s[48:51], s83 offen   lds
    s_waitcnt vmcnt(0)
    s_barrier
    buffer_load_dword v12, v208, s[52:55], 0 offen sc1
    s_waitcnt vmcnt(0)
    s_mov_b32 s15, 400000
Lpq1:
    v_cmp_ne_u32 vcc, s13, v12
    s_mov_b32 s82, 0xffffffff
    s_mov_b32 s83, 0xffffffff
    s_nop 2
    s_and_b64 vcc, vcc, s[82:83]
    s_cbranch_scc0 Lpq1_x
    buffer_load_dword v12, v208, s[52:55], 0 offen sc1
    s_sub_u32 s15, s15, 1
    s_cmp_lg_u32 s15, 0
    s_waitcnt vmcnt(0)
    s_cbranch_scc1 Lpq1
Lpq1_x:
    s_add_u32 m0, s89, 6144
    s_nop 0
    buffer_load_dwordx4 v11, s[52:55], s88 offen  sc1 lds
    buffer_load_dwordx4 v11, s[52:55], s88 offen offset:1024 sc1 lds
    s_add_u32 m0, s85, 122880
    s_add_u32 s86, s84, 122880
    buffer_load_dwordx4 v11, s[52:55], s86 offen  sc1 lds
    buffer_load_dwordx4 v11, s[52:55], s86 offen offset:1024 sc1 lds
    s_add_u32 m0, s85, 114688
    s_add_u32 s86, s84, 114688
    buffer_load_dwordx4 v11, s[52:55], s86 offen  sc1 lds
    buffer_load_dwordx4 v11, s[52:55], s86 offen offset:1024 sc1 lds
    v_cmp_ne_u32 vcc, s13, v12
    s_mov_b32 s82, 0x0
    s_mov_b32 s83, 0x0
    s_nop 2
    s_and_b64 vcc, vcc, s[82:83]
    s_cbranch_scc0 LsA
    buffer_load_dword v12, v208, s[52:55], 0 offen sc1
    s_waitcnt vmcnt(0)
    s_barrier
    s_mov_b32 s15, 400000
Lpq2:
    v_cmp_ne_u32 vcc, s13, v12
    s_mov_b32 s82, 0x0
    s_mov_b32 s83, 0x0
    s_nop 2
    s_and_b64 vcc, vcc, s[82:83]
    s_cbranch_scc0 Lpq2_x
    buffer_load_dword v12, v208, s[52:55], 0 offen sc1
    s_sub_u32 s15, s15, 1
    s_cmp_lg_u32 s15, 0
    s_waitcnt vmcnt(0)
    s_cbranch_scc1 Lpq2
Lpq2_x:
    s_add_u32 m0, s85, 106496
    s_add_u32 s86, s84, 106496
    buffer_load_dwordx4 v11, s[52:55], s86 offen  sc1 lds
    buffer_load_dwordx4 v11, s[52:55], s86 offen offset:1024 sc1 lds
    s_add_u32 m0, s85, 98304
    s_add_u32 s86, s84, 98304
    buffer_load_dwordx4 v11, s[52:55], s86 offen  sc1 lds
    buffer_load_dwordx4 v11, s[52:55], s86 offen offset:1024 sc1 lds
    s_branch LsC
LsA:
    s_add_u32 m0, s85, 106496
    s_add_u32 s86, s84, 106496
    buffer_load_dwordx4 v11, s[52:55], s86 offen  sc1 lds
    buffer_load_dwordx4 v11, s[52:55], s86 offen offset:1024 sc1 lds
    s_add_u32 m0, s85, 98304
    s_add_u32 s86, s84, 98304
    buffer_load_dwordx4 v11, s[52:55], s86 offen  sc1 lds
    buffer_load_dwordx4 v11, s[52:55], s86 offen offset:1024 sc1 lds
    s_waitcnt vmcnt(4)
    s_barrier
LsC:
    v_cmp_ne_u32 vcc, s13, v12
    s_mov_b32 s82, 0x0
    s_mov_b32 s83, 0x0
    s_nop 2
    s_and_b64 vcc, vcc, s[82:83]
    s_cbranch_scc0 LsD
    buffer_load_dword v12, v208, s[52:55], 0 offen sc1
    s_waitcnt vmcnt(0)
    s_barrier
    s_mov_b32 s15, 400000
Lpq3:
    v_cmp_ne_u32 vcc, s13, v12
    s_mov_b32 s82, 0x0
    s_mov_b32 s83, 0x0
    s_nop 2
    s_and_b64 vcc, vcc, s[82:83]
    s_cbranch_scc0 Lpq3_x
    buffer_load_dword v12, v208, s[52:55], 0 offen sc1
    s_sub_u32 s15, s15, 1
    s_cmp_lg_u32 s15, 0
    s_waitcnt vmcnt(0)
    s_cbranch_scc1 Lpq3
Lpq3_x:
    s_add_u32 m0, s85, 90112
    s_add_u32 s86, s84, 90112
    buffer_load_dwordx4 v11, s[52:55], s86 offen  sc1 lds
    buffer_load_dwordx4 v11, s[52:55], s86 offen offset:1024 sc1 lds
    s_add_u32 m0, s85, 81920
    s_add_u32 s86, s84, 81920
    buffer_load_dwordx4 v11, s[52:55], s86 offen  sc1 lds
    buffer_load_dwordx4 v11, s[52:55], s86 offen offset:1024 sc1 lds
    s_add_u32 m0, s85, 73728
    s_add_u32 s86, s84, 73728
    buffer_load_dwordx4 v11, s[52:55], s86 offen  sc1 lds
    buffer_load_dwordx4 v11, s[52:55], s86 offen offset:1024 sc1 lds
    s_add_u32 m0, s85, 65536
    s_add_u32 s86, s84, 65536
    buffer_load_dwordx4 v11, s[52:55], s86 offen  sc1 lds
    buffer_load_dwordx4 v11, s[52:55], s86 offen offset:1024 sc1 lds
    s_add_u32 m0, s85, 57344
    s_add_u32 s86, s84, 57344
    buffer_load_dwordx4 v11, s[52:55], s86 offen  sc1 lds
    buffer_load_dwordx4 v11, s[52:55], s86 offen offset:1024 sc1 lds
    s_branch LsF
LsD:
    s_add_u32 m0, s85, 90112
    s_add_u32 s86, s84, 90112
    buffer_load_dwordx4 v11, s[52:55], s86 offen  sc1 lds
    buffer_load_dwordx4 v11, s[52:55], s86 offen offset:1024 sc1 lds
    s_add_u32 m0, s85, 81920
    s_add_u32 s86, s84, 81920
    buffer_load_dwordx4 v11, s[52:55], s86 offen  sc1 lds
    buffer_load_dwordx4 v11, s[52:55], s86 offen offset:1024 sc1 lds
    s_add_u32 m0, s85, 73728
    s_add_u32 s86, s84, 73728
    buffer_load_dwordx4 v11, s[52:55], s86 offen  sc1 lds
    buffer_load_dwordx4 v11, s[52:55], s86 offen offset:1024 sc1 lds
    s_add_u32 m0, s85, 65536
    s_add_u32 s86, s84, 65536
    buffer_load_dwordx4 v11, s[52:55], s86 offen  sc1 lds
    buffer_load_dwordx4 v11, s[52:55], s86 offen offset:1024 sc1 lds
    s_add_u32 m0, s85, 57344
    s_add_u32 s86, s84, 57344
    buffer_load_dwordx4 v11, s[52:55], s86 offen  sc1 lds
    buffer_load_dwordx4 v11, s[52:55], s86 offen offset:1024 sc1 lds
    s_waitcnt vmcnt(10)
    s_barrier
LsF:
    s_add_u32 m0, s85, 49152
    s_add_u32 s86, s84, 49152
    buffer_load_dwordx4 v11, s[52:55], s86 offen  sc1 lds
    buffer_load_dwordx4 v11, s[52:55], s86 offen offset:1024 sc1 lds
    s_add_u32 m0, s85, 40960
    s_add_u32 s86, s84, 40960
    buffer_load_dwordx4 v11, s[52:55], s86 offen  sc1 lds
    buffer_load_dwordx4 v11, s[52:55], s86 offen offset:1024 sc1 lds
    s_add_u32 m0, s85, 32768
    s_add_u32 s86, s84, 32768
    buffer_load_dwordx4 v11, s[52:55], s86 offen  sc1 lds
    buffer_load_dwordx4 v11, s[52:55], s86 offen offset:1024 sc1 lds
    s_add_u32 m0, s85, 24576
    s_add_u32 s86, s84, 24576
    buffer_load_dwordx4 v11, s[52:55], s86 offen  sc1 lds
    buffer_load_dwordx4 v11, s[52:55], s86 offen offset:1024 sc1 lds
    s_add_u32 m0, s85, 16384
    s_add_u32 s86, s84, 16384
    buffer_load_dwordx4 v11, s[52:55], s86 offen  sc1 lds
    buffer_load_dwordx4 v11, s[52:55], s86 offen offset:1024 sc1 lds
    s_add_u32 m0, s85, 8192
    s_add_u32 s86, s84, 8192
    buffer_load_dwordx4 v11, s[52:55], s86 offen  sc1 lds
    buffer_load_dwordx4 v11, s[52:55], s86 offen offset:1024 sc1 lds
    s_add_u32 m0, s85, 0
    s_add_u32 s86, s84, 0
    buffer_load_dwordx4 v11, s[52:55], s86 offen  sc1 lds
    buffer_load_dwordx4 v11, s[52:55], s86 offen offset:1024 sc1 lds
    s_add_u32 s14, s90, 0
    s_add_u32 m0, s89, 0
    s_nop 0
    buffer_load_dwordx4 v209, s[60:63], s14 offen   lds
    s_add_u32 m0, s89, 1024
    s_nop 0
    buffer_load_dwordx4 v210, s[60:63], s14 offen   lds
    s_add_u32 s14, s90, 65536
    s_add_u32 m0, s89, 2048
    s_nop 0
    buffer_load_dwordx4 v209, s[60:63], s14 offen   lds
    s_add_u32 m0, s89, 3072
    s_nop 0
    buffer_load_dwordx4 v210, s[60:63], s14 offen   lds
    s_add_u32 s14, s90, 131072
    s_add_u32 m0, s89, 4096
    s_nop 0
    buffer_load_dwordx4 v209, s[60:63], s14 offen   lds
    s_add_u32 m0, s89, 5120
    s_nop 0
    buffer_load_dwordx4 v210, s[60:63], s14 offen   lds
    s_waitcnt vmcnt(6)
    s_barrier
    s_mov_b32 s15, 400000
Lph:
    buffer_load_dword v12, v212, s[52:55], 0 offen sc1
    s_sub_u32 s15, s15, 1
    s_cmp_eq_u32 s15, 0
    s_cbranch_scc1 Lph_x
    s_waitcnt vmcnt(0)
    v_cmp_ne_u32 vcc, s13, v12
    s_nop 4
    s_cmp_lg_u64 vcc, 0
    s_cbranch_scc1 Lph
Lph_x:
    s_waitcnt vmcnt(0)
    s_cmp_lg_u32 s2, 0
    s_cbranch_scc1 Lnall
    s_mov_b32 s15, 400000
Lpa:
    buffer_load_dword v12, v222, s[52:55], 0 offen sc1
    s_sub_u32 s15, s15, 1
    s_cmp_eq_u32 s15, 0
    s_cbranch_scc1 Lpa_x
    s_waitcnt vmcnt(0)
    v_cmp_ne_u32 vcc, s13, v12
    s_nop 4
    s_cmp_lg_u64 vcc, 0
    s_cbranch_scc1 Lpa
Lpa_x:
    s_waitcnt vmcnt(0)
Lnall:
    buffer_load_dword v14, v213, s[52:55], 0 offen sc1
    buffer_load_dword v15, v214, s[52:55], 0 offen sc1
    buffer_load_ushort v132, v215, s[72:75], 0 offen
    buffer_load_ushort v136, v215, s[72:75], 0 offen offset:64
    s_add_u32 s14, s93, 0
    buffer_load_dwordx4 v[144:147], v217, s[52:55], s14 offen sc1
    buffer_load_dwordx4 v[148:151], v218, s[52:55], s14 offen sc1
    s_add_u32 s14, s93, 4096
    buffer_load_dwordx4 v[152:155], v217, s[52:55], s14 offen sc1
    buffer_load_dwordx4 v[156:159], v218, s[52:55], s14 offen sc1
    s_add_u32 s14, s93, 8192
    buffer_load_dwordx4 v[160:163], v217, s[52:55], s14 offen sc1
    buffer_load_dwordx4 v[164:167], v218, s[52:55], s14 offen sc1
    s_add_u32 s14, s93, 12288
    buffer_load_dwordx4 v[168:171], v217, s[52:55], s14 offen sc1
    buffer_load_dwordx4 v[172:175], v218, s[52:55], s14 offen sc1
    s_add_u32 s14, s93, 16384
    buffer_load_dwordx4 v[176:179], v217, s[52:55], s14 offen sc1
    buffer_load_dwordx4 v[180:183], v218, s[52:55], s14 offen sc1
    s_add_u32 s14, s90, 196608
    s_add_u32 m0, s89, 6144
    s_nop 0
    buffer_load_dwordx4 v209, s[60:63], s14 offen   lds
    s_add_u32 m0, s89, 7168
    s_nop 0
    buffer_load_dwordx4 v210, s[60:63], s14 offen   lds
    s_add_u32 s14, s93, 20480
    buffer_load_dwordx4 v[184:187], v217, s[52:55], s14 offen sc1
    buffer_load_dwordx4 v[188:191], v218, s[52:55], s14 offen sc1
    s_waitcnt vmcnt(12)
    ds_read_b64_tr_b16 v[240:241], v211 offset:0
    ds_read_b64_tr_b16 v[242:243], v211 offset:512
    ds_read_b64_tr_b16 v[244:245], v211 offset:1024
    ds_read_b64_tr_b16 v[246:247], v211 offset:1536
    s_waitcnt lgkmcnt(0)
    v_mfma_f32_32x32x16_bf16 v[16:31], v[240:243], v[144:147], 0
    v_mfma_f32_32x32x16_bf16 v[48:63], v[240:243], v[148:151], 0
    v_mfma_f32_32x32x16_bf16 v[32:47], v[244:247], v[144:147], 0
    v_mfma_f32_32x32x16_bf16 v[64:79], v[244:247], v[148:151], 0
    s_add_u32 s14, s90, 262144
    s_add_u32 m0, s89, 0
    s_nop 0
    buffer_load_dwordx4 v209, s[60:63], s14 offen   lds
    s_add_u32 m0, s89, 1024
    s_nop 0
    buffer_load_dwordx4 v210, s[60:63], s14 offen   lds
    s_add_u32 s14, s93, 24576
    buffer_load_dwordx4 v[192:195], v217, s[52:55], s14 offen sc1
    buffer_load_dwordx4 v[196:199], v218, s[52:55], s14 offen sc1
    s_waitcnt vmcnt(14)
    ds_read_b64_tr_b16 v[248:249], v211 offset:2048
    ds_read_b64_tr_b16 v[250:251], v211 offset:2560
    ds_read_b64_tr_b16 v[252:253], v211 offset:3072
    ds_read_b64_tr_b16 v[254:255], v211 offset:3584
    s_waitcnt lgkmcnt(0)
    v_mfma_f32_32x32x16_bf16 v[16:31], v[248:251], v[152:155], v[16:31]
    v_mfma_f32_32x32x16_bf16 v[48:63], v[248:251], v[156:159], v[48:63]
    v_mfma_f32_32x32x16_bf16 v[32:47], v[252:255], v[152:155], v[32:47]
    v_mfma_f32_32x32x16_bf16 v[64:79], v[252:255], v[156:159], v[64:79]
    s_add_u32 s14, s90, 327680
    s_add_u32 m0, s89, 2048
    s_nop 0
    buffer_load_dwordx4 v209, s[60:63], s14 offen   lds
    s_add_u32 m0, s89, 3072
    s_nop 0
    buffer_load_dwordx4 v210, s[60:63], s14 offen   lds
    s_add_u32 s14, s93, 28672
    buffer_load_dwordx4 v[200:203], v217, s[52:55], s14 offen sc1
    buffer_load_dwordx4 v[204:207], v218, s[52:55], s14 offen sc1
    s_waitcnt vmcnt(16)
    ds_read_b64_tr_b16 v[240:241], v211 offset:4096
    ds_read_b64_tr_b16 v[242:243], v211 offset:4608
    ds_read_b64_tr_b16 v[244:245], v211 offset:5120
    ds_read_b64_tr_b16 v[246:247], v211 offset:5632
    s_waitcnt lgkmcnt(0)
    v_mfma_f32_32x32x16_bf16 v[16:31], v[240:243], v[160:163], v[16:31]
    v_mfma_f32_32x32x16_bf16 v[48:63], v[240:243], v[164:167], v[48:63]
    v_mfma_f32_32x32x16_bf16 v[32:47], v[244:247], v[160:163], v[32:47]
    v_mfma_f32_32x32x16_bf16 v[64:79], v[244:247], v[164:167], v[64:79]
    s_add_u32 s14, s90, 393216
    s_add_u32 m0, s89, 4096
    s_nop 0
    buffer_load_dwordx4 v209, s[60:63], s14 offen   lds
    s_add_u32 m0, s89, 5120
    s_nop 0
    buffer_load_dwordx4 v210, s[60:63], s14 offen   lds
    s_add_u32 s14, s93, 32768
    buffer_load_dwordx4 v[144:147], v217, s[52:55], s14 offen sc1
    buffer_load_dwordx4 v[148:151], v218, s[52:55], s14 offen sc1
    s_waitcnt vmcnt(18)
    s_waitcnt vmcnt(14)
    ds_read_b64_tr_b16 v[248:249], v211 offset:6144
    ds_read_b64_tr_b16 v[250:251], v211 offset:6656
    ds_read_b64_tr_b16 v[252:253], v211 offset:7168
    ds_read_b64_tr_b16 v[254:255], v211 offset:7680
    s_waitcnt lgkmcnt(0)
    v_mfma_f32_32x32x16_bf16 v[16:31], v[248:251], v[168:171], v[16:31]
    v_mfma_f32_32x32x16_bf16 v[48:63], v[248:251], v[172:175], v[48:63]
    v_mfma_f32_32x32x16_bf16 v[32:47], v[252:255], v[168:171], v[32:47]
    v_mfma_f32_32x32x16_bf16 v[64:79], v[252:255], v[172:175], v[64:79]
    s_add_u32 s14, s90, 458752
    s_add_u32 m0, s89, 6144
    s_nop 0
    buffer_load_dwordx4 v209, s[60:63], s14 offen   lds
    s_add_u32 m0, s89, 7168
    s_nop 0
    buffer_load_dwordx4 v210, s[60:63], s14 offen   lds
    s_add_u32 s14, s93, 36864
    buffer_load_dwordx4 v[152:155], v217, s[52:55], s14 offen sc1
    buffer_load_dwordx4 v[156:159], v218, s[52:55], s14 offen sc1
    s_waitcnt vmcnt(14)
    ds_read_b64_tr_b16 v[240:241], v211 offset:0
    ds_read_b64_tr_b16 v[242:243], v211 offset:512
    ds_read_b64_tr_b16 v[244:245], v211 offset:1024
    ds_read_b64_tr_b16 v[246:247], v211 offset:1536
    s_waitcnt lgkmcnt(0)
    v_mfma_f32_32x32x16_bf16 v[16:31], v[240:243], v[176:179], v[16:31]
    v_mfma_f32_32x32x16_bf16 v[48:63], v[240:243], v[180:183], v[48:63]
    v_mfma_f32_32x32x16_bf16 v[32:47], v[244:247], v[176:179], v[32:47]
    v_mfma_f32_32x32x16_bf16 v[64:79], v[244:247], v[180:183], v[64:79]
    s_add_u32 s14, s90, 524288
    s_add_u32 m0, s89, 0
    s_nop 0
    buffer_load_dwordx4 v209, s[60:63], s14 offen   lds
    s_add_u32 m0, s89, 1024
    s_nop 0
    buffer_load_dwordx4 v210, s[60:63], s14 offen   lds
    s_add_u32 s14, s93, 40960
    buffer_load_dwordx4 v[160:163], v217, s[52:55], s14 offen sc1
    buffer_load_dwordx4 v[164:167], v218, s[52:55], s14 offen sc1
    s_waitcnt vmcnt(14)
    ds_read_b64_tr_b16 v[248:249], v211 offset:2048
    ds_read_b64_tr_b16 v[250:251], v211 offset:2560
    ds_read_b64_tr_b16 v[252:253], v211 offset:3072
    ds_read_b64_tr_b16 v[254:255], v211 offset:3584
    s_waitcnt lgkmcnt(0)
    v_mfma_f32_32x32x16_bf16 v[16:31], v[248:251], v[184:187], v[16:31]
    v_mfma_f32_32x32x16_bf16 v[48:63], v[248:251], v[188:191], v[48:63]
    v_mfma_f32_32x32x16_bf16 v[32:47], v[252:255], v[184:187], v[32:47]
    v_mfma_f32_32x32x16_bf16 v[64:79], v[252:255], v[188:191], v[64:79]
    s_add_u32 s14, s90, 589824
    s_add_u32 m0, s89, 2048
    s_nop 0
    buffer_load_dwordx4 v209, s[60:63], s14 offen   lds
    s_add_u32 m0, s89, 3072
    s_nop 0
    buffer_load_dwordx4 v210, s[60:63], s14 offen   lds
    s_add_u32 s14, s93, 45056
    buffer_load_dwordx4 v[168:171], v217, s[52:55], s14 offen sc1
    buffer_load_dwordx4 v[172:175], v218, s[52:55], s14 offen sc1
    s_waitcnt vmcnt(14)
    ds_read_b64_tr_b16 v[240:241], v211 offset:4096
    ds_read_b64_tr_b16 v[242:243], v211 offset:4608
    ds_read_b64_tr_b16 v[244:245], v211 offset:5120
    ds_read_b64_tr_b16 v[246:247], v211 offset:5632
    s_waitcnt lgkmcnt(0)
    v_mfma_f32_32x32x16_bf16 v[16:31], v[240:243], v[192:195], v[16:31]
    v_mfma_f32_32x32x16_bf16 v[48:63], v[240:243], v[196:199], v[48:63]
    v_mfma_f32_32x32x16_bf16 v[32:47], v[244:247], v[192:195], v[32:47]
    v_mfma_f32_32x32x16_bf16 v[64:79], v[244:247], v[196:199], v[64:79]
    s_add_u32 s14, s90, 655360
    s_add_u32 m0, s89, 4096
    s_nop 0
    buffer_load_dwordx4 v209, s[60:63], s14 offen   lds
    s_add_u32 m0, s89, 5120
    s_nop 0
    buffer_load_dwordx4 v210, s[60:63], s14 offen   lds
    s_add_u32 s14, s93, 49152
    buffer_load_dwordx4 v[176:179], v217, s[52:55], s14 offen sc1
    buffer_load_dwordx4 v[180:183], v218, s[52:55], s14 offen sc1
    s_waitcnt vmcnt(14)
    ds_read_b64_tr_b16 v[248:249], v211 offset:6144
    ds_read_b64_tr_b16 v[250:251], v211 offset:6656
    ds_read_b64_tr_b16 v[252:253], v211 offset:7168
    ds_read_b64_tr_b16 v[254:255], v211 offset:7680
    s_waitcnt lgkmcnt(0)
    v_mfma_f32_32x32x16_bf16 v[16:31], v[248:251], v[200:203], v[16:31]
    v_mfma_f32_32x32x16_bf16 v[48:63], v[248:251], v[204:207], v[48:63]
    v_mfma_f32_32x32x16_bf16 v[32:47], v[252:255], v[200:203], v[32:47]
    v_mfma_f32_32x32x16_bf16 v[64:79], v[252:255], v[204:207], v[64:79]
    s_add_u32 s14, s90, 720896
    s_add_u32 m0, s89, 6144
    s_nop 0
    buffer_load_dwordx4 v209, s[60:63], s14 offen   lds
    s_add_u32 m0, s89, 7168
    s_nop 0
    buffer_load_dwordx4 v210, s[60:63], s14 offen   lds
    s_add_u32 s14, s93, 53248
    buffer_load_dwordx4 v[184:187], v217, s[52:55], s14 offen sc1
    buffer_load_dwordx4 v[188:191], v218, s[52:55], s14 offen sc1
    s_waitcnt vmcnt(14)
    ds_read_b64_tr_b16 v[240:241], v211 offset:0
    ds_read_b64_tr_b16 v[242:243], v211 offset:512
    ds_read_b64_tr_b16 v[244:245], v211 offset:1024
    ds_read_b64_tr_b16 v[246:247], v211 offset:1536
    s_waitcnt lgkmcnt(0)
    v_mfma_f32_32x32x16_bf16 v[16:31], v[240:243], v[144:147], v[16:31]
    v_mfma_f32_32x32x16_bf16 v[48:63], v[240:243], v[148:151], v[48:63]
    v_mfma_f32_32x32x16_bf16 v[32:47], v[244:247], v[144:147], v[32:47]
    v_mfma_f32_32x32x16_bf16 v[64:79], v[244:247], v[148:151], v[64:79]
    s_add_u32 s14, s90, 786432
    s_add_u32 m0, s89, 0
    s_nop 0
    buffer_load_dwordx4 v209, s[60:63], s14 offen   lds
    s_add_u32 m0, s89, 1024
    s_nop 0
    buffer_load_dwordx4 v210, s[60:63], s14 offen   lds
    s_add_u32 s14, s93, 57344
    buffer_load_dwordx4 v[192:195], v217, s[52:55], s14 offen sc1
    buffer_load_dwordx4 v[196:199], v218, s[52:55], s14 offen sc1
    s_waitcnt vmcnt(14)
    ds_read_b64_tr_b16 v[248:249], v211 offset:2048
    ds_read_b64_tr_b16 v[250:251], v211 offset:2560
    ds_read_b64_tr_b16 v[252:253], v211 offset:3072
    ds_read_b64_tr_b16 v[254:255], v211 offset:3584
    s_waitcnt lgkmcnt(0)
    v_mfma_f32_32x32x16_bf16 v[16:31], v[248:251], v[152:155], v[16:31]
    v_mfma_f32_32x32x16_bf16 v[48:63], v[248:251], v[156:159], v[48:63]
    v_mfma_f32_32x32x16_bf16 v[32:47], v[252:255], v[152:155], v[32:47]
    v_mfma_f32_32x32x16_bf16 v[64:79], v[252:255], v[156:159], v[64:79]
    s_add_u32 s14, s90, 851968
    s_add_u32 m0, s89, 2048
    s_nop 0
    buffer_load_dwordx4 v209, s[60:63], s14 offen   lds
    s_add_u32 m0, s89, 3072
    s_nop 0
    buffer_load_dwordx4 v210, s[60:63], s14 offen   lds
    s_add_u32 s14, s93, 61440
    buffer_load_dwordx4 v[200:203], v217, s[52:55], s14 offen sc1
    buffer_load_dwordx4 v[204:207], v218, s[52:55], s14 offen sc1
    s_waitcnt vmcnt(14)
    ds_read_b64_tr_b16 v[240:241], v211 offset:4096
    ds_read_b64_tr_b16 v[242:243], v211 offset:4608
    ds_read_b64_tr_b16 v[244:245], v211 offset:5120
    ds_read_b64_tr_b16 v[246:247], v211 offset:5632
    s_waitcnt lgkmcnt(0)
    v_mfma_f32_32x32x16_bf16 v[16:31], v[240:243], v[160:163], v[16:31]
    v_mfma_f32_32x32x16_bf16 v[48:63], v[240:243], v[164:167], v[48:63]
    v_mfma_f32_32x32x16_bf16 v[32:47], v[244:247], v[160:163], v[32:47]
    v_mfma_f32_32x32x16_bf16 v[64:79], v[244:247], v[164:167], v[64:79]
    s_add_u32 s14, s90, 917504
    s_add_u32 m0, s89, 4096
    s_nop 0
    buffer_load_dwordx4 v209, s[60:63], s14 offen   lds
    s_add_u32 m0, s89, 5120
    s_nop 0
    buffer_load_dwordx4 v210, s[60:63], s14 offen   lds
    s_add_u32 s14, s93, 65536
    buffer_load_dwordx4 v[144:147], v217, s[52:55], s14 offen sc1
    buffer_load_dwordx4 v[148:151], v218, s[52:55], s14 offen sc1
    s_waitcnt vmcnt(14)
    ds_read_b64_tr_b16 v[248:249], v211 offset:6144
    ds_read_b64_tr_b16 v[250:251], v211 offset:6656
    ds_read_b64_tr_b16 v[252:253], v211 offset:7168
    ds_read_b64_tr_b16 v[254:255], v211 offset:7680
    s_waitcnt lgkmcnt(0)
    v_mfma_f32_32x32x16_bf16 v[16:31], v[248:251], v[168:171], v[16:31]
    v_mfma_f32_32x32x16_bf16 v[48:63], v[248:251], v[172:175], v[48:63]
    v_mfma_f32_32x32x16_bf16 v[32:47], v[252:255], v[168:171], v[32:47]
    v_mfma_f32_32x32x16_bf16 v[64:79], v[252:255], v[172:175], v[64:79]
    s_add_u32 s14, s90, 983040
    s_add_u32 m0, s89, 6144
    s_nop 0
    buffer_load_dwordx4 v209, s[60:63], s14 offen   lds
    s_add_u32 m0, s89, 7168
    s_nop 0
    buffer_load_dwordx4 v210, s[60:63], s14 offen   lds
    s_add_u32 s14, s93, 69632
    buffer_load_dwordx4 v[152:155], v217, s[52:55], s14 offen sc1
    buffer_load_dwordx4 v[156:159], v218, s[52:55], s14 offen sc1
    s_waitcnt vmcnt(14)
    ds_read_b64_tr_b16 v[240:241], v211 offset:0
    ds_read_b64_tr_b16 v[242:243], v211 offset:512
    ds_read_b64_tr_b16 v[244:245], v211 offset:1024
    ds_read_b64_tr_b16 v[246:247], v211 offset:1536
    s_waitcnt lgkmcnt(0)
    v_mfma_f32_32x32x16_bf16 v[16:31], v[240:243], v[176:179], v[16:31]
    v_mfma_f32_32x32x16_bf16 v[48:63], v[240:243], v[180:183], v[48:63]
    v_mfma_f32_32x32x16_bf16 v[32:47], v[244:247], v[176:179], v[32:47]
    v_mfma_f32_32x32x16_bf16 v[64:79], v[244:247], v[180:183], v[64:79]
    s_add_u32 s14, s90, 1048576
    s_add_u32 m0, s89, 0
    s_nop 0
    buffer_load_dwordx4 v209, s[60:63], s14 offen   lds
    s_add_u32 m0, s89, 1024
    s_nop 0
    buffer_load_dwordx4 v210, s[60:63], s14 offen   lds
    s_add_u32 s14, s93, 73728
    buffer_load_dwordx4 v[160:163], v217, s[52:55], s14 offen sc1
    buffer_load_dwordx4 v[164:167], v218, s[52:55], s14 offen sc1
    s_waitcnt vmcnt(14)
    ds_read_b64_tr_b16 v[248:249], v211 offset:2048
    ds_read_b64_tr_b16 v[250:251], v211 offset:2560
    ds_read_b64_tr_b16 v[252:253], v211 offset:3072
    ds_read_b64_tr_b16 v[254:255], v211 offset:3584
    s_waitcnt lgkmcnt(0)
    v_mfma_f32_32x32x16_bf16 v[16:31], v[248:251], v[184:187], v[16:31]
    v_mfma_f32_32x32x16_bf16 v[48:63], v[248:251], v[188:191], v[48:63]
    v_mfma_f32_32x32x16_bf16 v[32:47], v[252:255], v[184:187], v[32:47]
    v_mfma_f32_32x32x16_bf16 v[64:79], v[252:255], v[188:191], v[64:79]
    s_add_u32 s14, s90, 1114112
    s_add_u32 m0, s89, 2048
    s_nop 0
    buffer_load_dwordx4 v209, s[60:63], s14 offen   lds
    s_add_u32 m0, s89, 3072
    s_nop 0
    buffer_load_dwordx4 v210, s[60:63], s14 offen   lds
    s_add_u32 s14, s93, 77824
    buffer_load_dwordx4 v[168:171], v217, s[52:55], s14 offen sc1
    buffer_load_dwordx4 v[172:175], v218, s[52:55], s14 offen sc1
    s_waitcnt vmcnt(14)
    ds_read_b64_tr_b16 v[240:241], v211 offset:4096
    ds_read_b64_tr_b16 v[242:243], v211 offset:4608
    ds_read_b64_tr_b16 v[244:245], v211 offset:5120
    ds_read_b64_tr_b16 v[246:247], v211 offset:5632
    s_waitcnt lgkmcnt(0)
    v_mfma_f32_32x32x16_bf16 v[16:31], v[240:243], v[192:195], v[16:31]
    v_mfma_f32_32x32x16_bf16 v[48:63], v[240:243], v[196:199], v[48:63]
    v_mfma_f32_32x32x16_bf16 v[32:47], v[244:247], v[192:195], v[32:47]
    v_mfma_f32_32x32x16_bf16 v[64:79], v[244:247], v[196:199], v[64:79]
    s_add_u32 s14, s90, 1179648
    s_add_u32 m0, s89, 4096
    s_nop 0
    buffer_load_dwordx4 v209, s[60:63], s14 offen   lds
    s_add_u32 m0, s89, 5120
    s_nop 0
    buffer_load_dwordx4 v210, s[60:63], s14 offen   lds
    s_add_u32 s14, s93, 81920
    buffer_load_dwordx4 v[176:179], v217, s[52:55], s14 offen sc1
    buffer_load_dwordx4 v[180:183], v218, s[52:55], s14 offen sc1
    s_waitcnt vmcnt(14)
    ds_read_b64_tr_b16 v[248:249], v211 offset:6144
    ds_read_b64_tr_b16 v[250:251], v211 offset:6656
    ds_read_b64_tr_b16 v[252:253], v211 offset:7168
    ds_read_b64_tr_b16 v[254:255], v211 offset:7680
    s_waitcnt lgkmcnt(0)
    v_mfma_f32_32x32x16_bf16 v[16:31], v[248:251], v[200:203], v[16:31]
    v_mfma_f32_32x32x16_bf16 v[48:63], v[248:251], v[204:207], v[48:63]
    v_mfma_f32_32x32x16_bf16 v[32:47], v[252:255], v[200:203], v[32:47]
    v_mfma_f32_32x32x16_bf16 v[64:79], v[252:255], v[204:207], v[64:79]
    s_add_u32 s14, s90, 1245184
    s_add_u32 m0, s89, 6144
    s_nop 0
    buffer_load_dwordx4 v209, s[60:63], s14 offen   lds
    s_add_u32 m0, s89, 7168
    s_nop 0
    buffer_load_dwordx4 v210, s[60:63], s14 offen   lds
    s_add_u32 s14, s93, 86016
    buffer_load_dwordx4 v[184:187], v217, s[52:55], s14 offen sc1
    buffer_load_dwordx4 v[188:191], v218, s[52:55], s14 offen sc1
    s_waitcnt vmcnt(14)
    ds_read_b64_tr_b16 v[240:241], v211 offset:0
    ds_read_b64_tr_b16 v[242:243], v211 offset:512
    ds_read_b64_tr_b16 v[244:245], v211 offset:1024
    ds_read_b64_tr_b16 v[246:247], v211 offset:1536
    s_waitcnt lgkmcnt(0)
    v_mfma_f32_32x32x16_bf16 v[16:31], v[240:243], v[144:147], v[16:31]
    v_mfma_f32_32x32x16_bf16 v[48:63], v[240:243], v[148:151], v[48:63]
    v_mfma_f32_32x32x16_bf16 v[32:47], v[244:247], v[144:147], v[32:47]
    v_mfma_f32_32x32x16_bf16 v[64:79], v[244:247], v[148:151], v[64:79]
    s_add_u32 s14, s90, 1310720
    s_add_u32 m0, s89, 0
    s_nop 0
    buffer_load_dwordx4 v209, s[60:63], s14 offen   lds
    s_add_u32 m0, s89, 1024
    s_nop 0
    buffer_load_dwordx4 v210, s[60:63], s14 offen   lds
    s_waitcnt vmcnt(12)
    ds_read_b64_tr_b16 v[248:249], v211 offset:2048
    ds_read_b64_tr_b16 v[250:251], v211 offset:2560
    ds_read_b64_tr_b16 v[252:253], v211 offset:3072
    ds_read_b64_tr_b16 v[254:255], v211 offset:3584
    s_waitcnt lgkmcnt(0)
    v_mfma_f32_32x32x16_bf16 v[16:31], v[248:251], v[152:155], v[16:31]
    v_mfma_f32_32x32x16_bf16 v[48:63], v[248:251], v[156:159], v[48:63]
    v_mfma_f32_32x32x16_bf16 v[32:47], v[252:255], v[152:155], v[32:47]
    v_mfma_f32_32x32x16_bf16 v[64:79], v[252:255], v[156:159], v[64:79]
    s_add_u32 s14, s90, 1376256
    s_add_u32 m0, s89, 2048
    s_nop 0
    buffer_load_dwordx4 v209, s[60:63], s14 offen   lds
    s_add_u32 m0, s89, 3072
    s_nop 0
    buffer_load_dwordx4 v210, s[60:63], s14 offen   lds
    s_waitcnt vmcnt(10)
    ds_read_b64_tr_b16 v[240:241], v211 offset:4096
    ds_read_b64_tr_b16 v[242:243], v211 offset:4608
    ds_read_b64_tr_b16 v[244:245], v211 offset:5120
    ds_read_b64_tr_b16 v[246:247], v211 offset:5632
    s_waitcnt lgkmcnt(0)
    v_mfma_f32_32x32x16_bf16 v[16:31], v[240:243], v[160:163], v[16:31]
    v_mfma_f32_32x32x16_bf16 v[48:63], v[240:243], v[164:167], v[48:63]
    v_mfma_f32_32x32x16_bf16 v[32:47], v[244:247], v[160:163], v[32:47]
    v_mfma_f32_32x32x16_bf16 v[64:79], v[244:247], v[164:167], v[64:79]
    s_add_u32 s14, s91, 0
    s_add_u32 m0, s89, 4096
    s_nop 0
    buffer_load_dwordx4 v209, s[56:59], s14 offen   lds
    s_add_u32 m0, s89, 5120
    s_nop 0
    buffer_load_dwordx4 v210, s[56:59], s14 offen   lds
    s_waitcnt vmcnt(8)
    ds_read_b64_tr_b16 v[248:249], v211 offset:6144
    ds_read_b64_tr_b16 v[250:251], v211 offset:6656
    ds_read_b64_tr_b16 v[252:253], v211 offset:7168
    ds_read_b64_tr_b16 v[254:255], v211 offset:7680
    s_waitcnt lgkmcnt(0)
    v_mfma_f32_32x32x16_bf16 v[16:31], v[248:251], v[168:171], v[16:31]
    v_mfma_f32_32x32x16_bf16 v[48:63], v[248:251], v[172:175], v[48:63]
    v_mfma_f32_32x32x16_bf16 v[32:47], v[252:255], v[168:171], v[32:47]
    v_mfma_f32_32x32x16_bf16 v[64:79], v[252:255], v[172:175], v[64:79]
    s_add_u32 s14, s91, 16384
    s_add_u32 m0, s89, 6144
    s_nop 0
    buffer_load_dwordx4 v209, s[56:59], s14 offen   lds
    s_add_u32 m0, s89, 7168
    s_nop 0
    buffer_load_dwordx4 v210, s[56:59], s14 offen   lds
    s_waitcnt vmcnt(6)
    ds_read_b64_tr_b16 v[240:241], v211 offset:0
    ds_read_b64_tr_b16 v[242:243], v211 offset:512
    ds_read_b64_tr_b16 v[244:245], v211 offset:1024
    ds_read_b64_tr_b16 v[246:247], v211 offset:1536
    s_waitcnt lgkmcnt(0)
    v_mfma_f32_32x32x16_bf16 v[16:31], v[240:243], v[176:179], v[16:31]
    v_mfma_f32_32x32x16_bf16 v[48:63], v[240:243], v[180:183], v[48:63]
    v_mfma_f32_32x32x16_bf16 v[32:47], v[244:247], v[176:179], v[32:47]
    v_mfma_f32_32x32x16_bf16 v[64:79], v[244:247], v[180:183], v[64:79]
    s_add_u32 s14, s91, 32768
    s_add_u32 m0, s89, 0
    s_nop 0
    buffer_load_dwordx4 v209, s[56:59], s14 offen   lds
    s_add_u32 m0, s89, 1024
    s_nop 0
    buffer_load_dwordx4 v210, s[56:59], s14 offen   lds
    s_waitcnt vmcnt(6)
    s_cmp_ge_u32 s99, 2
    s_cbranch_scc1 Lb2
    ds_read_b64_tr_b16 v[248:249], v211 offset:2048
    ds_read_b64_tr_b16 v[250:251], v211 offset:2560
    ds_read_b64_tr_b16 v[252:253], v211 offset:3072
    ds_read_b64_tr_b16 v[254:255], v211 offset:3584
    s_waitcnt lgkmcnt(0)
    v_mfma_f32_32x32x16_bf16 v[16:31], v[248:251], v[184:187], v[16:31]
    v_mfma_f32_32x32x16_bf16 v[48:63], v[248:251], v[188:191], v[48:63]
    v_mfma_f32_32x32x16_bf16 v[32:47], v[252:255], v[184:187], v[32:47]
    v_mfma_f32_32x32x16_bf16 v[64:79], v[252:255], v[188:191], v[64:79]
    s_branch Lb2x
Lb2:
    s_cmp_eq_u32 s99, 3
    s_cbranch_scc1 Lb2x
    v_mfma_f32_32x32x16_bf16 v[16:31], v[132:135], v[140:143], v[16:31]
    v_mfma_f32_32x32x16_bf16 v[48:63], v[132:135], v[140:143], v[48:63]
    v_mfma_f32_32x32x16_bf16 v[32:47], v[136:139], v[140:143], v[32:47]
    v_mfma_f32_32x32x16_bf16 v[64:79], v[136:139], v[140:143], v[64:79]
Lb2x:
    s_add_u32 s14, s91, 49152
    s_add_u32 m0, s89, 2048
    s_nop 0
    buffer_load_dwordx4 v209, s[56:59], s14 offen   lds
    s_add_u32 m0, s89, 3072
    s_nop 0
    buffer_load_dwordx4 v210, s[56:59], s14 offen   lds
    s_waitcnt vmcnt(6)
    ds_read_b64_tr_b16 v[80:81], v211 offset:4096
    ds_read_b64_tr_b16 v[82:83], v211 offset:4608
    ds_read_b64_tr_b16 v[84:85], v211 offset:5120
    ds_read_b64_tr_b16 v[86:87], v211 offset:5632
    s_waitcnt lgkmcnt(0)
    s_add_u32 s14, s91, 65536
    s_add_u32 m0, s89, 4096
    s_nop 0
    buffer_load_dwordx4 v209, s[56:59], s14 offen   lds
    s_add_u32 m0, s89, 5120
    s_nop 0
    buffer_load_dwordx4 v210, s[56:59], s14 offen   lds
    s_waitcnt vmcnt(6)
    ds_read_b64_tr_b16 v[88:89], v211 offset:6144
    ds_read_b64_tr_b16 v[90:91], v211 offset:6656
    ds_read_b64_tr_b16 v[92:93], v211 offset:7168
    ds_read_b64_tr_b16 v[94:95], v211 offset:7680
    s_waitcnt lgkmcnt(0)
    s_add_u32 s14, s91, 81920
    s_add_u32 m0, s89, 6144
    s_nop 0
    buffer_load_dwordx4 v209, s[56:59], s14 offen   lds
    s_add_u32 m0, s89, 7168
    s_nop 0
    buffer_load_dwordx4 v210, s[56:59], s14 offen   lds
    s_waitcnt vmcnt(6)
    ds_read_b64_tr_b16 v[96:97], v211 offset:0
    ds_read_b64_tr_b16 v[98:99], v211 offset:512
    ds_read_b64_tr_b16 v[100:101], v211 offset:1024
    ds_read_b64_tr_b16 v[102:103], v211 offset:1536
    s_waitcnt lgkmcnt(0)
    s_add_u32 s14, s91, 98304
    s_add_u32 m0, s89, 0
    s_nop 0
    buffer_load_dwordx4 v209, s[56:59], s14 offen   lds
    s_add_u32 m0, s89, 1024
    s_nop 0
    buffer_load_dwordx4 v210, s[56:59], s14 offen   lds
    s_waitcnt vmcnt(6)
    ds_read_b64_tr_b16 v[104:105], v211 offset:2048
    ds_read_b64_tr_b16 v[106:107], v211 offset:2560
    ds_read_b64_tr_b16 v[108:109], v211 offset:3072
    ds_read_b64_tr_b16 v[110:111], v211 offset:3584
    s_waitcnt lgkmcnt(0)
    s_add_u32 s14, s91, 114688
    s_add_u32 m0, s89, 2048
    s_nop 0
    buffer_load_dwordx4 v209, s[56:59], s14 offen   lds
    s_add_u32 m0, s89, 3072
    s_nop 0
    buffer_load_dwordx4 v210, s[56:59], s14 offen   lds
    s_waitcnt vmcnt(6)
    ds_read_b64_tr_b16 v[112:113], v211 offset:4096
    ds_read_b64_tr_b16 v[114:115], v211 offset:4608
    ds_read_b64_tr_b16 v[116:117], v211 offset:5120
    ds_read_b64_tr_b16 v[118:119], v211 offset:5632
    s_waitcnt lgkmcnt(0)
    s_waitcnt vmcnt(4)
    ds_read_b64_tr_b16 v[120:121], v211 offset:6144
    ds_read_b64_tr_b16 v[122:123], v211 offset:6656
    ds_read_b64_tr_b16 v[124:125], v211 offset:7168
    ds_read_b64_tr_b16 v[126:127], v211 offset:7680
    s_waitcnt lgkmcnt(0)
    s_waitcnt vmcnt(2)
    ds_read_b64_tr_b16 v[128:129], v211 offset:0
    ds_read_b64_tr_b16 v[130:131], v211 offset:512
    ds_read_b64_tr_b16 v[132:133], v211 offset:1024
    ds_read_b64_tr_b16 v[134:135], v211 offset:1536
    s_waitcnt lgkmcnt(0)
    s_waitcnt vmcnt(0)
    ds_read_b64_tr_b16 v[136:137], v211 offset:2048
    ds_read_b64_tr_b16 v[138:139], v211 offset:2560
    ds_read_b64_tr_b16 v[140:141], v211 offset:3072
    ds_read_b64_tr_b16 v[142:143], v211 offset:3584
    s_waitcnt lgkmcnt(0)
Lskip:
    s_barrier
    buffer_load_dword v12, v216, s[52:55], 0 offen sc1
    v_sub_f32 v14, 1.0, v14
    v_sub_f32 v15, 1.0, v15
    v_pk_mul_f32 v[16:17], v[16:17], v[14:15] op_sel:[0,0] op_sel_hi:[1,0]
    v_pk_mul_f32 v[18:19], v[18:19], v[14:15] op_sel:[0,0] op_sel_hi:[1,0]
    v_pk_mul_f32 v[20:21], v[20:21], v[14:15] op_sel:[0,0] op_sel_hi:[1,0]
    v_pk_mul_f32 v[22:23], v[22:23], v[14:15] op_sel:[0,0] op_sel_hi:[1,0]
    v_pk_mul_f32 v[24:25], v[24:25], v[14:15] op_sel:[0,0] op_sel_hi:[1,0]
    v_pk_mul_f32 v[26:27], v[26:27], v[14:15] op_sel:[0,0] op_sel_hi:[1,0]
    v_pk_mul_f32 v[28:29], v[28:29], v[14:15] op_sel:[0,0] op_sel_hi:[1,0]
    v_pk_mul_f32 v[30:31], v[30:31], v[14:15] op_sel:[0,0] op_sel_hi:[1,0]
    v_pk_mul_f32 v[32:33], v[32:33], v[14:15] op_sel:[0,0] op_sel_hi:[1,0]
    v_pk_mul_f32 v[34:35], v[34:35], v[14:15] op_sel:[0,0] op_sel_hi:[1,0]
    v_pk_mul_f32 v[36:37], v[36:37], v[14:15] op_sel:[0,0] op_sel_hi:[1,0]
    v_pk_mul_f32 v[38:39], v[38:39], v[14:15] op_sel:[0,0] op_sel_hi:[1,0]
    v_pk_mul_f32 v[40:41], v[40:41], v[14:15] op_sel:[0,0] op_sel_hi:[1,0]
    v_pk_mul_f32 v[42:43], v[42:43], v[14:15] op_sel:[0,0] op_sel_hi:[1,0]
    v_pk_mul_f32 v[44:45], v[44:45], v[14:15] op_sel:[0,0] op_sel_hi:[1,0]
    v_pk_mul_f32 v[46:47], v[46:47], v[14:15] op_sel:[0,0] op_sel_hi:[1,0]
    v_pk_mul_f32 v[48:49], v[48:49], v[14:15] op_sel:[0,1] op_sel_hi:[1,1]
    v_pk_mul_f32 v[50:51], v[50:51], v[14:15] op_sel:[0,1] op_sel_hi:[1,1]
    v_pk_mul_f32 v[52:53], v[52:53], v[14:15] op_sel:[0,1] op_sel_hi:[1,1]
    v_pk_mul_f32 v[54:55], v[54:55], v[14:15] op_sel:[0,1] op_sel_hi:[1,1]
    v_pk_mul_f32 v[56:57], v[56:57], v[14:15] op_sel:[0,1] op_sel_hi:[1,1]
    v_pk_mul_f32 v[58:59], v[58:59], v[14:15] op_sel:[0,1] op_sel_hi:[1,1]
    v_pk_mul_f32 v[60:61], v[60:61], v[14:15] op_sel:[0,1] op_sel_hi:[1,1]
    v_pk_mul_f32 v[62:63], v[62:63], v[14:15] op_sel:[0,1] op_sel_hi:[1,1]
    v_pk_mul_f32 v[64:65], v[64:65], v[14:15] op_sel:[0,1] op_sel_hi:[1,1]
    v_pk_mul_f32 v[66:67], v[66:67], v[14:15] op_sel:[0,1] op_sel_hi:[1,1]
    v_pk_mul_f32 v[68:69], v[68:69], v[14:15] op_sel:[0,1] op_sel_hi:[1,1]
    v_pk_mul_f32 v[70:71], v[70:71], v[14:15] op_sel:[0,1] op_sel_hi:[1,1]
    v_pk_mul_f32 v[72:73], v[72:73], v[14:15] op_sel:[0,1] op_sel_hi:[1,1]
    v_pk_mul_f32 v[74:75], v[74:75], v[14:15] op_sel:[0,1] op_sel_hi:[1,1]
    v_pk_mul_f32 v[76:77], v[76:77], v[14:15] op_sel:[0,1] op_sel_hi:[1,1]
    v_pk_mul_f32 v[78:79], v[78:79], v[14:15] op_sel:[0,1] op_sel_hi:[1,1]
    s_mov_b32 s80, 0
    s_mov_b32 s81, 0
    s_mov_b32 s15, 400000
Lw:
    s_waitcnt vmcnt(0)
    v_cmp_ne_u32 vcc, s13, v12
    s_sub_u32 s15, s15, 1
    s_cmp_eq_u32 s15, 0
    s_cbranch_scc1 Lwx
    s_mov_b32 s83, s80
    s_nop 1
    s_and_b32 s14, vcc_lo, 0xff
    s_bitset1_b32 s14, 8
    s_ff1_i32_b32 s82, s14
    s_max_u32 s82, s82, s80
    s_cmp_eq_u32 s82, s81
    s_cbranch_scc0 Lw2
    buffer_load_dword v12, v216, s[52:55], 0 offen sc1
    s_branch Lw
Lw2:
    s_sub_u32 s14, s82, s80
    s_bfm_b32 s84, s14, s80
    s_bitcmp1_b32 s84, 0
    s_cbranch_scc0 Lwi0
    s_add_u32 s14, s94, 0
    buffer_load_dwordx4 v[144:147], v220, s[52:55], s14 offen sc1
    buffer_load_dwordx4 v[148:151], v221, s[52:55], s14 offen sc1
Lwi0:
    s_bitcmp1_b32 s84, 1
    s_cbranch_scc0 Lwi1
    s_add_u32 s14, s94, 2048
    buffer_load_dwordx4 v[152:155], v220, s[52:55], s14 offen sc1
    buffer_load_dwordx4 v[156:159], v221, s[52:55], s14 offen sc1
Lwi1:
    s_bitcmp1_b32 s84, 2
    s_cbranch_scc0 Lwi2
    s_add_u32 s14, s94, 4096
    buffer_load_dwordx4 v[160:163], v220, s[52:55], s14 offen sc1
    buffer_load_dwordx4 v[164:167], v221, s[52:55], s14 offen sc1
Lwi2:
    s_bitcmp1_b32 s84, 3
    s_cbranch_scc0 Lwi3
    s_add_u32 s14, s94, 6144
    buffer_load_dwordx4 v[168:171], v220, s[52:55], s14 offen sc1
    buffer_load_dwordx4 v[172:175], v221, s[52:55], s14 offen sc1
Lwi3:
    s_bitcmp1_b32 s84, 4
    s_cbranch_scc0 Lwi4
    s_add_u32 s14, s94, 8192
    buffer_load_dwordx4 v[176:179], v220, s[52:55], s14 offen sc1
    buffer_load_dwordx4 v[180:183], v221, s[52:55], s14 offen sc1
Lwi4:
    s_bitcmp1_b32 s84, 5
    s_cbranch_scc0 Lwi5
    s_add_u32 s14, s94, 10240
    buffer_load_dwordx4 v[184:187], v220, s[52:55], s14 offen sc1
    buffer_load_dwordx4 v[188:191], v221, s[52:55], s14 offen sc1
Lwi5:
    s_bitcmp1_b32 s84, 6
    s_cbranch_scc0 Lwi6
    s_add_u32 s14, s94, 12288
    buffer_load_dwordx4 v[192:195], v220, s[52:55], s14 offen sc1
    buffer_load_dwordx4 v[196:199], v221, s[52:55], s14 offen sc1
Lwi6:
    s_bitcmp1_b32 s84, 7
    s_cbranch_scc0 Lwi7
    s_add_u32 s14, s94, 14336
    buffer_load_dwordx4 v[200:203], v220, s[52:55], s14 offen sc1
    buffer_load_dwordx4 v[204:207], v221, s[52:55], s14 offen sc1
Lwi7:
    s_mov_b32 s80, s82
    s_cmp_eq_u32 s82, 8
    s_cselect_b32 s83, 8, s83
    s_cbranch_scc1 Lw4
    buffer_load_dword v12, v216, s[52:55], 0 offen sc1
Lw4:
    s_sub_u32 s14, s83, s81
    s_bfm_b32 s84, s14, s81
    s_mov_b32 s81, s83
    s_bitcmp1_b32 s84, 0
    s_cbranch_scc0 Lwv0
    s_waitcnt vmcnt(14)
    v_mfma_f32_32x32x16_bf16 v[16:31], v[80:83], v[144:147], v[16:31]
    v_mfma_f32_32x32x16_bf16 v[48:63], v[80:83], v[148:151], v[48:63]
    v_mfma_f32_32x32x16_bf16 v[32:47], v[84:87], v[144:147], v[32:47]
    v_mfma_f32_32x32x16_bf16 v[64:79], v[84:87], v[148:151], v[64:79]
Lwv0:
    s_bitcmp1_b32 s84, 1
    s_cbranch_scc0 Lwv1
    s_waitcnt vmcnt(12)
    v_mfma_f32_32x32x16_bf16 v[16:31], v[88:91], v[152:155], v[16:31]
    v_mfma_f32_32x32x16_bf16 v[48:63], v[88:91], v[156:159], v[48:63]
    v_mfma_f32_32x32x16_bf16 v[32:47], v[92:95], v[152:155], v[32:47]
    v_mfma_f32_32x32x16_bf16 v[64:79], v[92:95], v[156:159], v[64:79]
Lwv1:
    s_bitcmp1_b32 s84, 2
    s_cbranch_scc0 Lwv2
    s_waitcnt vmcnt(10)
    v_mfma_f32_32x32x16_bf16 v[16:31], v[96:99], v[160:163], v[16:31]
    v_mfma_f32_32x32x16_bf16 v[48:63], v[96:99], v[164:167], v[48:63]
    v_mfma_f32_32x32x16_bf16 v[32:47], v[100:103], v[160:163], v[32:47]
    v_mfma_f32_32x32x16_bf16 v[64:79], v[100:103], v[164:167], v[64:79]
Lwv2:
    s_bitcmp1_b32 s84, 3
    s_cbranch_scc0 Lwv3
    s_waitcnt vmcnt(8)
    v_mfma_f32_32x32x16_bf16 v[16:31], v[104:107], v[168:171], v[16:31]
    v_mfma_f32_32x32x16_bf16 v[48:63], v[104:107], v[172:175], v[48:63]
    v_mfma_f32_32x32x16_bf16 v[32:47], v[108:111], v[168:171], v[32:47]
    v_mfma_f32_32x32x16_bf16 v[64:79], v[108:111], v[172:175], v[64:79]
Lwv3:
    s_bitcmp1_b32 s84, 4
    s_cbranch_scc0 Lwv4
    s_waitcnt vmcnt(6)
    v_mfma_f32_32x32x16_bf16 v[16:31], v[112:115], v[176:179], v[16:31]
    v_mfma_f32_32x32x16_bf16 v[48:63], v[112:115], v[180:183], v[48:63]
    v_mfma_f32_32x32x16_bf16 v[32:47], v[116:119], v[176:179], v[32:47]
    v_mfma_f32_32x32x16_bf16 v[64:79], v[116:119], v[180:183], v[64:79]
Lwv4:
    s_bitcmp1_b32 s84, 5
    s_cbranch_scc0 Lwv5
    s_waitcnt vmcnt(4)
    v_mfma_f32_32x32x16_bf16 v[16:31], v[120:123], v[184:187], v[16:31]
    v_mfma_f32_32x32x16_bf16 v[48:63], v[120:123], v[188:191], v[48:63]
    v_mfma_f32_32x32x16_bf16 v[32:47], v[124:127], v[184:187], v[32:47]
    v_mfma_f32_32x32x16_bf16 v[64:79], v[124:127], v[188:191], v[64:79]
Lwv5:
    s_bitcmp1_b32 s84, 6
    s_cbranch_scc0 Lwv6
    s_waitcnt vmcnt(2)
    v_mfma_f32_32x32x16_bf16 v[16:31], v[128:131], v[192:195], v[16:31]
    v_mfma_f32_32x32x16_bf16 v[48:63], v[128:131], v[196:199], v[48:63]
    v_mfma_f32_32x32x16_bf16 v[32:47], v[132:135], v[192:195], v[32:47]
    v_mfma_f32_32x32x16_bf16 v[64:79], v[132:135], v[196:199], v[64:79]
Lwv6:
    s_bitcmp1_b32 s84, 7
    s_cbranch_scc0 Lwv7
    s_waitcnt vmcnt(0)
    v_mfma_f32_32x32x16_bf16 v[16:31], v[136:139], v[200:203], v[16:31]
    v_mfma_f32_32x32x16_bf16 v[48:63], v[136:139], v[204:207], v[48:63]
    v_mfma_f32_32x32x16_bf16 v[32:47], v[140:143], v[200:203], v[32:47]
    v_mfma_f32_32x32x16_bf16 v[64:79], v[140:143], v[204:207], v[64:79]
Lwv7:
    s_cmp_lg_u32 s81, 8
    s_cbranch_scc1 Lw
Lwx:
    s_nop 7
    ds_write_b128 v227, v[48:51] offset:0
    ds_write_b128 v227, v[52:55] offset:1024
    ds_write_b128 v227, v[56:59] offset:2048
    ds_write_b128 v227, v[60:63] offset:3072
    ds_write_b128 v226, v[32:35] offset:0
    ds_write_b128 v226, v[36:39] offset:1024
    ds_write_b128 v226, v[40:43] offset:2048
    ds_write_b128 v226, v[44:47] offset:3072
    ds_write_b128 v228, v[64:67] offset:0
    ds_write_b128 v228, v[68:71] offset:1024
    ds_write_b128 v228, v[72:75] offset:2048
    ds_write_b128 v228, v[76:79] offset:3072
    s_waitcnt lgkmcnt(0)
    s_barrier
    ds_read_b128 v[32:35], v225 offset:0
    ds_read_b128 v[36:39], v225 offset:1024
    ds_read_b128 v[40:43], v225 offset:2048
    ds_read_b128 v[44:47], v225 offset:3072
    ds_read_b128 v[48:51], v225 offset:4096
    ds_read_b128 v[52:55], v225 offset:5120
    ds_read_b128 v[56:59], v225 offset:6144
    ds_read_b128 v[60:63], v225 offset:7168
    ds_read_b128 v[64:67], v225 offset:8192
    ds_read_b128 v[68:71], v225 offset:9216
    ds_read_b128 v[72:75], v225 offset:10240
    ds_read_b128 v[76:79], v225 offset:11264
    s_cmp_lg_u32 s2, 0
    s_cbranch_scc1 Lnoep
    s_cmp_lg_u32 s99, 0
    s_cbranch_scc1 Lnoep
    s_mov_b32 s14, 15007744
    v_mov_b32 v12, s13
    s_mov_b64 exec, 1
    buffer_store_dword v12, off, s[52:55], s14 sc1
    s_mov_b64 exec, -1
Lnoep:
    s_waitcnt lgkmcnt(8)
    v_pk_add_f32 v[16:17], v[16:17], v[32:33]
    v_pk_add_f32 v[18:19], v[18:19], v[34:35]
    v_pk_add_f32 v[20:21], v[20:21], v[36:37]
    v_pk_add_f32 v[22:23], v[22:23], v[38:39]
    v_pk_add_f32 v[24:25], v[24:25], v[40:41]
    v_pk_add_f32 v[26:27], v[26:27], v[42:43]
    v_pk_add_f32 v[28:29], v[28:29], v[44:45]
    v_pk_add_f32 v[30:31], v[30:31], v[46:47]
    s_waitcnt lgkmcnt(4)
    v_pk_add_f32 v[16:17], v[16:17], v[48:49]
    v_pk_add_f32 v[18:19], v[18:19], v[50:51]
    v_pk_add_f32 v[20:21], v[20:21], v[52:53]
    v_pk_add_f32 v[22:23], v[22:23], v[54:55]
    v_pk_add_f32 v[24:25], v[24:25], v[56:57]
    v_pk_add_f32 v[26:27], v[26:27], v[58:59]
    v_pk_add_f32 v[28:29], v[28:29], v[60:61]
    v_pk_add_f32 v[30:31], v[30:31], v[62:63]
    s_waitcnt lgkmcnt(0)
    v_pk_add_f32 v[16:17], v[16:17], v[64:65]
    v_pk_add_f32 v[18:19], v[18:19], v[66:67]
    v_pk_add_f32 v[20:21], v[20:21], v[68:69]
    v_pk_add_f32 v[22:23], v[22:23], v[70:71]
    v_pk_add_f32 v[24:25], v[24:25], v[72:73]
    v_pk_add_f32 v[26:27], v[26:27], v[74:75]
    v_pk_add_f32 v[28:29], v[28:29], v[76:77]
    v_pk_add_f32 v[30:31], v[30:31], v[78:79]
    v_cvt_pk_bf16_f32 v16, v16, v17
    v_cvt_pk_bf16_f32 v17, v18, v19
    v_cvt_pk_bf16_f32 v18, v20, v21
    v_cvt_pk_bf16_f32 v19, v22, v23
    v_cvt_pk_bf16_f32 v20, v24, v25
    v_cvt_pk_bf16_f32 v21, v26, v27
    v_cvt_pk_bf16_f32 v22, v28, v29
    v_cvt_pk_bf16_f32 v23, v30, v31
    s_nop 1
    v_permlane32_swap_b32 v16, v18
    v_permlane32_swap_b32 v17, v19
    v_permlane32_swap_b32 v20, v22
    v_permlane32_swap_b32 v21, v23
    s_nop 0
    buffer_store_dwordx4 v[16:19], v219, s[64:67], 0 offen
    buffer_store_dwordx4 v[20:23], v219, s[64:67], 0 offen offset:32
Lend:
    s_endpgm
Lcomp:
    s_getpc_b64 s[92:93]
Lpc:
    s_sub_u32 s92, s92, Lpc-gated_mix__softmax_full_mha__dense_activation_squared_relu__prompt_kernel
    s_subb_u32 s93, s93, 0
    s_and_b32 s14, s5, 3
    s_lshl_b32 s14, s14, 2
    s_add_u32 s14, s14, s99
    s_lshl_b32 s14, s14, 12
    v_lshl_add_u32 v9, v0, 6, s14
    v_min_u32 v9, Llast_-gated_mix__softmax_full_mha__dense_activation_squared_relu__prompt_kernel, v9
    global_load_dword v16, v9, s[92:93]
    s_and_b32 s14, s5, 3
    s_lshl_b32 s15, s4, 2
    s_add_u32 s9, s15, s14
    s_lshr_b32 s10, s5, 2
    s_and_b32 s11, s4, 3
    s_and_b32 s15, s4, 4
    s_add_u32 s12, s15, s14
    s_mov_b32 s54, 268435456
    s_mov_b32 s55, 0x20000
    s_mov_b32 s70, 2752
    s_mov_b32 s71, 0x20000
    s_mov_b32 s42, 2097152
    s_mov_b32 s43, 0x20000
    s_mov_b32 s46, 1572864
    s_mov_b32 s47, 0x20000
    s_mov_b32 s96, 0xffff
    s_mov_b32 s97, 0xffff
    v_and_b32 v1, 31, v0
    v_lshrrev_b32 v2, 5, v0
    v_bfe_u32 v9, v0, 1, 3
    v_xor_b32 v9, v9, v2
    v_lshlrev_b32 v9, 4, v9
    v_lshl_add_u32 v9, v1, 7, v9
    s_lshl_b32 s14, s99, 12
    v_add_u32 v3, s14, v9
    v_xor_b32 v4, 32, v3
    v_xor_b32 v5, 64, v3
    v_xor_b32 v6, 96, v3
    v_bfe_u32 v9, v0, 2, 2
    v_lshl_add_u32 v9, v2, 3, v9
    v_mul_u32_u24 v9, 192, v9
    v_bfe_u32 v10, v0, 4, 1
    v_lshl_add_u32 v9, v10, 5, v9
    v_and_b32 v10, 3, v0
    v_lshl_add_u32 v7, v10, 3, v9
    v_lshlrev_b32 v12, 4, v0
    v_and_b32 v9, 0x33, v0
    v_and_b32 v10, 4, v0
    v_lshl_add_u32 v9, v10, 1, v9
    v_bfe_u32 v10, v0, 3, 1
    v_lshl_add_u32 v9, v10, 2, v9
    v_lshlrev_b32 v9, 4, v9
    v_and_b32 v11, 15, v0
    v_lshl_add_u32 v11, v2, 4, v11
    v_lshlrev_b32 v11, 4, v11
    v_bfe_u32 v10, v0, 4, 1
    v_lshl_add_u32 v11, v10, 17, v11
    v_add_u32 v10, 1024, v11
    s_lshl_b32 s14, s6, 2
    s_add_u32 s80, s14, s99
    s_mul_i32 s14, s7, 3
    s_add_u32 s14, s14, 0
    s_lshr_b32 s15, s14, 4
    s_and_b32 s14, s14, 15
    s_lshl_b32 s14, s14, 7
    s_add_u32 s14, s14, s80
    s_lshl_b32 s81, s14, 11
    s_add_u32 s81, s81, 2097152
    s_lshl_b32 s14, s14, 10
    s_movk_i32 s82, 512
    s_cmp_eq_u32 s15, 1
    s_cselect_b32 s82, 131072, s82
    s_cselect_b64 vcc, -1, 0
    v_cndmask_b32 v13, v10, v9, vcc
    s_cmp_eq_u32 s15, 0
    s_cselect_b32 s82, 65536, s82
    s_cselect_b32 s81, s14, s81
    s_cselect_b32 s90, 0x3eb8aa3b, 1.0
    s_cselect_b64 vcc, -1, 0
    v_cndmask_b32 v13, v13, v12, vcc
    s_add_u32 s82, s82, s81
    s_mov_b32 s91, s90
    s_mul_i32 s14, s7, 3
    s_add_u32 s14, s14, 1
    s_lshr_b32 s15, s14, 4
    s_and_b32 s14, s14, 15
    s_lshl_b32 s14, s14, 7
    s_add_u32 s14, s14, s80
    s_lshl_b32 s83, s14, 11
    s_add_u32 s83, s83, 2097152
    s_lshl_b32 s14, s14, 10
    s_movk_i32 s84, 512
    s_cmp_eq_u32 s15, 1
    s_cselect_b32 s84, 131072, s84
    s_cselect_b64 vcc, -1, 0
    v_cndmask_b32 v14, v10, v9, vcc
    s_cmp_eq_u32 s15, 0
    s_cselect_b32 s84, 65536, s84
    s_cselect_b32 s83, s14, s83
    s_cselect_b32 s94, 0x3eb8aa3b, 1.0
    s_cselect_b64 vcc, -1, 0
    v_cndmask_b32 v14, v14, v12, vcc
    s_add_u32 s84, s84, s83
    s_mov_b32 s95, s94
    s_mul_i32 s14, s7, 3
    s_add_u32 s14, s14, 2
    s_lshr_b32 s15, s14, 4
    s_and_b32 s14, s14, 15
    s_lshl_b32 s14, s14, 7
    s_add_u32 s14, s14, s80
    s_lshl_b32 s92, s14, 11
    s_add_u32 s92, s92, 2097152
    s_lshl_b32 s14, s14, 10
    s_movk_i32 s93, 512
    s_cmp_eq_u32 s15, 1
    s_cselect_b32 s93, 131072, s93
    s_cselect_b64 vcc, -1, 0
    v_cndmask_b32 v15, v10, v9, vcc
    s_cmp_eq_u32 s15, 0
    s_cselect_b32 s93, 65536, s93
    s_cselect_b32 s92, s14, s92
    s_cselect_b32 s100, 0x3eb8aa3b, 1.0
    s_cselect_b64 vcc, -1, 0
    v_cndmask_b32 v15, v15, v12, vcc
    s_add_u32 s93, s93, s92
    s_mov_b32 s101, s100
    v_mov_b32 v240, 0
    v_mov_b32 v241, 0
    v_mov_b32 v242, 0
    v_mov_b32 v243, 0
    v_mov_b32 v244, 0
    v_mov_b32 v245, 0
    v_mov_b32 v246, 0
    v_mov_b32 v247, 0
    v_mov_b32 v248, 0
    v_mov_b32 v249, 0
    v_mov_b32 v250, 0
    v_mov_b32 v251, 0
    v_mov_b32 v252, 0
    v_mov_b32 v253, 0
    v_mov_b32 v254, 0
    v_mov_b32 v255, 0
    v_mov_b32 v9, 0x3f80
    v_cmp_gt_u32 vcc, 32, v0
    s_mul_i32 s14, s7, 192
    v_lshl_add_u32 v10, v1, 1, s14
    v_cndmask_b32 v252, 0, v9, vcc
    s_waitcnt lgkmcnt(0)
    s_mov_b32 s52, s38
    s_mov_b32 s53, s39
    s_mov_b32 s68, s26
    s_mov_b32 s69, s27
    s_mov_b32 s40, s38
    s_mov_b32 s41, s39
    s_cmp_lt_u32 s7, 15
    s_cselect_b32 s42, s54, 0
    s_mov_b32 s44, s38
    s_mov_b32 s45, s39
    s_cmp_lt_u32 s7, 14
    s_cselect_b32 s46, s54, 0
    s_mov_b32 s15, 15007744
    buffer_load_dword v11, off, s[52:55], s15 sc1
    buffer_load_ushort v240, v10, s[68:71], 0 offen offset:0
    buffer_load_ushort v244, v10, s[68:71], 0 offen offset:64
    buffer_load_ushort v248, v10, s[68:71], 0 offen offset:128
    s_mul_i32 s85, s80, 86
    s_mul_i32 s14, s7, 6
    s_add_u32 s85, s85, s14
    s_lshl_b32 s85, s85, 10
    s_add_u32 s85, s85, 6291456
    s_add_u32 s86, s85, 4096
    s_lshl_b32 s14, s7, 2
    s_add_u32 s14, s14, s99
    s_lshl_b32 s14, s14, 5
    s_add_u32 s14, s14, s6
    s_lshl_b32 s14, s14, 2
    s_add_u32 s87, s14, 14745600
    s_lshl_b32 s14, s80, 5
    s_add_u32 s14, s14, s7
    s_lshl_b32 s14, s14, 2
    s_add_u32 s88, s14, 14811136
    s_waitcnt vmcnt(0)
    v_readfirstlane_b32 s14, v11
    s_mul_i32 s13, s14, 0x9E3779B1
    s_add_u32 s13, s13, 0x7F4A7C15
    s_or_b32 s13, s13, 0x80000000
    s_xor_b32 s15, s13, 1
    s_cmp_eq_u32 s13, s14
    s_cselect_b32 s13, s15, s13
    v_add_u32 v8, 45056, v7
    s_barrier
    ds_read_b128 v[16:19], v3 offset:28672
    ds_read_b64_tr_b16 v[192:193], v8 offset:0
    ds_read_b64_tr_b16 v[194:195], v8 offset:768
    ds_read_b64_tr_b16 v[196:197], v8 offset:64
    ds_read_b64_tr_b16 v[198:199], v8 offset:832
    ds_read_b64_tr_b16 v[200:201], v8 offset:128
    ds_read_b64_tr_b16 v[202:203], v8 offset:896
    ds_read_b128 v[20:23], v4 offset:28672
    ds_read_b64_tr_b16 v[204:205], v8 offset:3072
    ds_read_b64_tr_b16 v[206:207], v8 offset:3840
    ds_read_b64_tr_b16 v[208:209], v8 offset:3136
    ds_read_b64_tr_b16 v[210:211], v8 offset:3904
    ds_read_b64_tr_b16 v[212:213], v8 offset:3200
    ds_read_b64_tr_b16 v[214:215], v8 offset:3968
    s_cmp_eq_u32 s7, 10
    s_cbranch_scc1 LA_TTN
    s_cmp_gt_u32 s7, 10
    s_cbranch_scc1 LA_NNN
LA_TTT:
    s_waitcnt lgkmcnt(11)
    v_mfma_f32_32x32x16_bf16 v[144:159], v[192:195], v[16:19], 0
    ds_read_b128 v[24:27], v5 offset:28672
    ds_read_b64_tr_b16 v[216:217], v8 offset:6144
    ds_read_b64_tr_b16 v[218:219], v8 offset:6912
    s_waitcnt lgkmcnt(12)
    v_mfma_f32_32x32x16_bf16 v[160:175], v[196:199], v[16:19], 0
    ds_read_b64_tr_b16 v[220:221], v8 offset:6208
    ds_read_b64_tr_b16 v[222:223], v8 offset:6976
    ds_read_b64_tr_b16 v[224:225], v8 offset:6272
    s_waitcnt lgkmcnt(13)
    v_mfma_f32_32x32x16_bf16 v[176:191], v[200:203], v[16:19], 0
    ds_read_b64_tr_b16 v[226:227], v8 offset:7040
    ds_read_b128 v[28:31], v6 offset:28672
    ds_read_b64_tr_b16 v[228:229], v8 offset:9216
    s_waitcnt lgkmcnt(13)
    v_mfma_f32_32x32x16_bf16 v[144:159], v[204:207], v[20:23], v[144:159]
    ds_read_b64_tr_b16 v[230:231], v8 offset:9984
    ds_read_b64_tr_b16 v[232:233], v8 offset:9280
    ds_read_b64_tr_b16 v[234:235], v8 offset:10048
    s_waitcnt lgkmcnt(14)
    v_mfma_f32_32x32x16_bf16 v[160:175], v[208:211], v[20:23], v[160:175]
    ds_read_b64_tr_b16 v[236:237], v8 offset:9344
    ds_read_b64_tr_b16 v[238:239], v8 offset:10112
    s_waitcnt lgkmcnt(14)
    v_mfma_f32_32x32x16_bf16 v[176:191], v[212:215], v[20:23], v[176:191]
    v_add_u32 v3, 0xe000, v3
    v_add_u32 v4, 0xe000, v4
    v_add_u32 v5, 0xe000, v5
    v_add_u32 v6, 0xe000, v6
    v_add_u32 v8, 73728, v7
    s_barrier
    s_waitcnt lgkmcnt(11)
    v_mfma_f32_32x32x16_bf16 v[144:159], v[216:219], v[24:27], v[144:159]
    ds_read_b128 v[32:35], v3 offset:0
    ds_read_b64_tr_b16 v[192:193], v8 offset:0
    ds_read_b64_tr_b16 v[194:195], v8 offset:768
    s_waitcnt lgkmcnt(12)
    v_mfma_f32_32x32x16_bf16 v[160:175], v[220:223], v[24:27], v[160:175]
    ds_read_b64_tr_b16 v[196:197], v8 offset:64
    ds_read_b64_tr_b16 v[198:199], v8 offset:832
    ds_read_b64_tr_b16 v[200:201], v8 offset:128
    s_waitcnt lgkmcnt(13)
    v_mfma_f32_32x32x16_bf16 v[176:191], v[224:227], v[24:27], v[176:191]
    ds_read_b64_tr_b16 v[202:203], v8 offset:896
    ds_read_b128 v[36:39], v4 offset:0
    ds_read_b64_tr_b16 v[204:205], v8 offset:3072
    s_waitcnt lgkmcnt(13)
    v_mfma_f32_32x32x16_bf16 v[144:159], v[228:231], v[28:31], v[144:159]
    ds_read_b64_tr_b16 v[206:207], v8 offset:3840
    ds_read_b64_tr_b16 v[208:209], v8 offset:3136
    ds_read_b64_tr_b16 v[210:211], v8 offset:3904
    s_waitcnt lgkmcnt(14)
    v_mfma_f32_32x32x16_bf16 v[160:175], v[232:235], v[28:31], v[160:175]
    ds_read_b64_tr_b16 v[212:213], v8 offset:3200
    ds_read_b64_tr_b16 v[214:215], v8 offset:3968
    s_waitcnt lgkmcnt(14)
    v_mfma_f32_32x32x16_bf16 v[176:191], v[236:239], v[28:31], v[176:191]
    s_waitcnt lgkmcnt(11)
    v_mfma_f32_32x32x16_bf16 v[144:159], v[192:195], v[32:35], v[144:159]
    ds_read_b128 v[40:43], v5 offset:0
    ds_read_b64_tr_b16 v[216:217], v8 offset:6144
    ds_read_b64_tr_b16 v[218:219], v8 offset:6912
    s_waitcnt lgkmcnt(12)
    v_mfma_f32_32x32x16_bf16 v[160:175], v[196:199], v[32:35], v[160:175]
    ds_read_b64_tr_b16 v[220:221], v8 offset:6208
    ds_read_b64_tr_b16 v[222:223], v8 offset:6976
    ds_read_b64_tr_b16 v[224:225], v8 offset:6272
    s_waitcnt lgkmcnt(13)
    v_mfma_f32_32x32x16_bf16 v[176:191], v[200:203], v[32:35], v[176:191]
    ds_read_b64_tr_b16 v[226:227], v8 offset:7040
    ds_read_b128 v[44:47], v6 offset:0
    ds_read_b64_tr_b16 v[228:229], v8 offset:9216
    s_waitcnt lgkmcnt(13)
    v_mfma_f32_32x32x16_bf16 v[144:159], v[204:207], v[36:39], v[144:159]
    ds_read_b64_tr_b16 v[230:231], v8 offset:9984
    ds_read_b64_tr_b16 v[232:233], v8 offset:9280
    ds_read_b64_tr_b16 v[234:235], v8 offset:10048
    s_waitcnt lgkmcnt(14)
    v_mfma_f32_32x32x16_bf16 v[160:175], v[208:211], v[36:39], v[160:175]
    ds_read_b64_tr_b16 v[236:237], v8 offset:9344
    ds_read_b64_tr_b16 v[238:239], v8 offset:10112
    s_waitcnt lgkmcnt(14)
    v_mfma_f32_32x32x16_bf16 v[176:191], v[212:215], v[36:39], v[176:191]
    v_add_u32 v8, 102400, v7
    s_barrier
    s_waitcnt lgkmcnt(11)
    v_mfma_f32_32x32x16_bf16 v[144:159], v[216:219], v[40:43], v[144:159]
    ds_read_b128 v[48:51], v3 offset:28672
    ds_read_b64_tr_b16 v[192:193], v8 offset:0
    ds_read_b64_tr_b16 v[194:195], v8 offset:768
    s_waitcnt lgkmcnt(12)
    v_mfma_f32_32x32x16_bf16 v[160:175], v[220:223], v[40:43], v[160:175]
    ds_read_b64_tr_b16 v[196:197], v8 offset:64
    ds_read_b64_tr_b16 v[198:199], v8 offset:832
    ds_read_b64_tr_b16 v[200:201], v8 offset:128
    s_waitcnt lgkmcnt(13)
    v_mfma_f32_32x32x16_bf16 v[176:191], v[224:227], v[40:43], v[176:191]
    ds_read_b64_tr_b16 v[202:203], v8 offset:896
    ds_read_b128 v[52:55], v4 offset:28672
    ds_read_b64_tr_b16 v[204:205], v8 offset:3072
    s_waitcnt lgkmcnt(13)
    v_mfma_f32_32x32x16_bf16 v[144:159], v[228:231], v[44:47], v[144:159]
    ds_read_b64_tr_b16 v[206:207], v8 offset:3840
    ds_read_b64_tr_b16 v[208:209], v8 offset:3136
    ds_read_b64_tr_b16 v[210:211], v8 offset:3904
    s_waitcnt lgkmcnt(14)
    v_mfma_f32_32x32x16_bf16 v[160:175], v[232:235], v[44:47], v[160:175]
    ds_read_b64_tr_b16 v[212:213], v8 offset:3200
    ds_read_b64_tr_b16 v[214:215], v8 offset:3968
    s_waitcnt lgkmcnt(14)
    v_mfma_f32_32x32x16_bf16 v[176:191], v[236:239], v[44:47], v[176:191]
    s_waitcnt lgkmcnt(11)
    v_mfma_f32_32x32x16_bf16 v[144:159], v[192:195], v[48:51], v[144:159]
    ds_read_b128 v[56:59], v5 offset:28672
    ds_read_b64_tr_b16 v[216:217], v8 offset:6144
    ds_read_b64_tr_b16 v[218:219], v8 offset:6912
    s_waitcnt lgkmcnt(12)
    v_mfma_f32_32x32x16_bf16 v[160:175], v[196:199], v[48:51], v[160:175]
    ds_read_b64_tr_b16 v[220:221], v8 offset:6208
    ds_read_b64_tr_b16 v[222:223], v8 offset:6976
    ds_read_b64_tr_b16 v[224:225], v8 offset:6272
    s_waitcnt lgkmcnt(13)
    v_mfma_f32_32x32x16_bf16 v[176:191], v[200:203], v[48:51], v[176:191]
    ds_read_b64_tr_b16 v[226:227], v8 offset:7040
    ds_read_b128 v[60:63], v6 offset:28672
    ds_read_b64_tr_b16 v[228:229], v8 offset:9216
    s_waitcnt lgkmcnt(13)
    v_mfma_f32_32x32x16_bf16 v[144:159], v[204:207], v[52:55], v[144:159]
    ds_read_b64_tr_b16 v[230:231], v8 offset:9984
    ds_read_b64_tr_b16 v[232:233], v8 offset:9280
    ds_read_b64_tr_b16 v[234:235], v8 offset:10048
    s_waitcnt lgkmcnt(14)
    v_mfma_f32_32x32x16_bf16 v[160:175], v[208:211], v[52:55], v[160:175]
    ds_read_b64_tr_b16 v[236:237], v8 offset:9344
    ds_read_b64_tr_b16 v[238:239], v8 offset:10112
    s_waitcnt lgkmcnt(14)
    v_mfma_f32_32x32x16_bf16 v[176:191], v[212:215], v[52:55], v[176:191]
    v_add_u32 v3, 0xe000, v3
    v_add_u32 v4, 0xe000, v4
    v_add_u32 v5, 0xe000, v5
    v_add_u32 v6, 0xe000, v6
    v_add_u32 v8, 131072, v7
    s_barrier
    s_waitcnt lgkmcnt(11)
    v_mfma_f32_32x32x16_bf16 v[144:159], v[216:219], v[56:59], v[144:159]
    ds_read_b128 v[64:67], v3 offset:0
    ds_read_b64_tr_b16 v[192:193], v8 offset:0
    ds_read_b64_tr_b16 v[194:195], v8 offset:768
    s_waitcnt lgkmcnt(12)
    v_mfma_f32_32x32x16_bf16 v[160:175], v[220:223], v[56:59], v[160:175]
    ds_read_b64_tr_b16 v[196:197], v8 offset:64
    ds_read_b64_tr_b16 v[198:199], v8 offset:832
    ds_read_b64_tr_b16 v[200:201], v8 offset:128
    s_waitcnt lgkmcnt(13)
    v_mfma_f32_32x32x16_bf16 v[176:191], v[224:227], v[56:59], v[176:191]
    ds_read_b64_tr_b16 v[202:203], v8 offset:896
    ds_read_b128 v[68:71], v4 offset:0
    ds_read_b64_tr_b16 v[204:205], v8 offset:3072
    s_waitcnt lgkmcnt(13)
    v_mfma_f32_32x32x16_bf16 v[144:159], v[228:231], v[60:63], v[144:159]
    ds_read_b64_tr_b16 v[206:207], v8 offset:3840
    ds_read_b64_tr_b16 v[208:209], v8 offset:3136
    ds_read_b64_tr_b16 v[210:211], v8 offset:3904
    s_waitcnt lgkmcnt(14)
    v_mfma_f32_32x32x16_bf16 v[160:175], v[232:235], v[60:63], v[160:175]
    ds_read_b64_tr_b16 v[212:213], v8 offset:3200
    ds_read_b64_tr_b16 v[214:215], v8 offset:3968
    s_waitcnt lgkmcnt(14)
    v_mfma_f32_32x32x16_bf16 v[176:191], v[236:239], v[60:63], v[176:191]
    s_waitcnt lgkmcnt(11)
    v_mfma_f32_32x32x16_bf16 v[144:159], v[192:195], v[64:67], v[144:159]
    ds_read_b128 v[72:75], v5 offset:0
    ds_read_b64_tr_b16 v[216:217], v8 offset:6144
    ds_read_b64_tr_b16 v[218:219], v8 offset:6912
    s_waitcnt lgkmcnt(12)
    v_mfma_f32_32x32x16_bf16 v[160:175], v[196:199], v[64:67], v[160:175]
    ds_read_b64_tr_b16 v[220:221], v8 offset:6208
    ds_read_b64_tr_b16 v[222:223], v8 offset:6976
    ds_read_b64_tr_b16 v[224:225], v8 offset:6272
    s_waitcnt lgkmcnt(13)
    v_mfma_f32_32x32x16_bf16 v[176:191], v[200:203], v[64:67], v[176:191]
    ds_read_b64_tr_b16 v[226:227], v8 offset:7040
    ds_read_b128 v[76:79], v6 offset:0
    ds_read_b64_tr_b16 v[228:229], v8 offset:9216
    s_waitcnt lgkmcnt(13)
    v_mfma_f32_32x32x16_bf16 v[144:159], v[204:207], v[68:71], v[144:159]
    ds_read_b64_tr_b16 v[230:231], v8 offset:9984
    ds_read_b64_tr_b16 v[232:233], v8 offset:9280
    ds_read_b64_tr_b16 v[234:235], v8 offset:10048
    s_waitcnt lgkmcnt(14)
    v_mfma_f32_32x32x16_bf16 v[160:175], v[208:211], v[68:71], v[160:175]
    ds_read_b64_tr_b16 v[236:237], v8 offset:9344
    ds_read_b64_tr_b16 v[238:239], v8 offset:10112
    s_waitcnt lgkmcnt(14)
    v_mfma_f32_32x32x16_bf16 v[176:191], v[212:215], v[68:71], v[176:191]
    v_add_u32 v3, 0xfffe4000, v3
    v_add_u32 v4, 0xfffe4000, v4
    v_add_u32 v5, 0xfffe4000, v5
    v_add_u32 v6, 0xfffe4000, v6
    v_add_u32 v8, 16384, v7
    s_barrier
    s_waitcnt lgkmcnt(11)
    v_mfma_f32_32x32x16_bf16 v[144:159], v[216:219], v[72:75], v[144:159]
    ds_read_b128 v[80:83], v3 offset:0
    ds_read_b64_tr_b16 v[192:193], v8 offset:0
    ds_read_b64_tr_b16 v[194:195], v8 offset:768
    s_waitcnt lgkmcnt(12)
    v_mfma_f32_32x32x16_bf16 v[160:175], v[220:223], v[72:75], v[160:175]
    ds_read_b64_tr_b16 v[196:197], v8 offset:64
    ds_read_b64_tr_b16 v[198:199], v8 offset:832
    ds_read_b64_tr_b16 v[200:201], v8 offset:128
    s_waitcnt lgkmcnt(13)
    v_mfma_f32_32x32x16_bf16 v[176:191], v[224:227], v[72:75], v[176:191]
    ds_read_b64_tr_b16 v[202:203], v8 offset:896
    ds_read_b128 v[84:87], v4 offset:0
    ds_read_b64_tr_b16 v[204:205], v8 offset:3072
    s_waitcnt lgkmcnt(13)
    v_mfma_f32_32x32x16_bf16 v[144:159], v[228:231], v[76:79], v[144:159]
    ds_read_b64_tr_b16 v[206:207], v8 offset:3840
    ds_read_b64_tr_b16 v[208:209], v8 offset:3136
    ds_read_b64_tr_b16 v[210:211], v8 offset:3904
    s_waitcnt lgkmcnt(14)
    v_mfma_f32_32x32x16_bf16 v[160:175], v[232:235], v[76:79], v[160:175]
    ds_read_b64_tr_b16 v[212:213], v8 offset:3200
    ds_read_b64_tr_b16 v[214:215], v8 offset:3968
    s_waitcnt lgkmcnt(14)
    v_mfma_f32_32x32x16_bf16 v[176:191], v[236:239], v[76:79], v[176:191]
    s_waitcnt lgkmcnt(11)
    v_mfma_f32_32x32x16_bf16 v[144:159], v[192:195], v[80:83], v[144:159]
    ds_read_b128 v[88:91], v5 offset:0
    ds_read_b64_tr_b16 v[216:217], v8 offset:6144
    ds_read_b64_tr_b16 v[218:219], v8 offset:6912
    s_waitcnt lgkmcnt(12)
    v_mfma_f32_32x32x16_bf16 v[160:175], v[196:199], v[80:83], v[160:175]
    ds_read_b64_tr_b16 v[220:221], v8 offset:6208
    ds_read_b64_tr_b16 v[222:223], v8 offset:6976
    ds_read_b64_tr_b16 v[224:225], v8 offset:6272
    s_waitcnt lgkmcnt(13)
    v_mfma_f32_32x32x16_bf16 v[176:191], v[200:203], v[80:83], v[176:191]
    ds_read_b64_tr_b16 v[226:227], v8 offset:7040
    ds_read_b128 v[92:95], v6 offset:0
    ds_read_b64_tr_b16 v[228:229], v8 offset:9216
    s_waitcnt lgkmcnt(13)
    v_mfma_f32_32x32x16_bf16 v[144:159], v[204:207], v[84:87], v[144:159]
    ds_read_b64_tr_b16 v[230:231], v8 offset:9984
    ds_read_b64_tr_b16 v[232:233], v8 offset:9280
    ds_read_b64_tr_b16 v[234:235], v8 offset:10048
    s_waitcnt lgkmcnt(14)
    v_mfma_f32_32x32x16_bf16 v[160:175], v[208:211], v[84:87], v[160:175]
    ds_read_b64_tr_b16 v[236:237], v8 offset:9344
    ds_read_b64_tr_b16 v[238:239], v8 offset:10112
    s_waitcnt lgkmcnt(14)
    v_mfma_f32_32x32x16_bf16 v[176:191], v[212:215], v[84:87], v[176:191]
    v_add_u32 v8, 45056, v7
    s_barrier
    s_waitcnt lgkmcnt(11)
    v_mfma_f32_32x32x16_bf16 v[144:159], v[216:219], v[88:91], v[144:159]
    ds_read_b128 v[96:99], v3 offset:28672
    ds_read_b64_tr_b16 v[192:193], v8 offset:0
    ds_read_b64_tr_b16 v[194:195], v8 offset:768
    s_waitcnt lgkmcnt(12)
    v_mfma_f32_32x32x16_bf16 v[160:175], v[220:223], v[88:91], v[160:175]
    ds_read_b64_tr_b16 v[196:197], v8 offset:64
    ds_read_b64_tr_b16 v[198:199], v8 offset:832
    ds_read_b64_tr_b16 v[200:201], v8 offset:128
    s_waitcnt lgkmcnt(13)
    v_mfma_f32_32x32x16_bf16 v[176:191], v[224:227], v[88:91], v[176:191]
    ds_read_b64_tr_b16 v[202:203], v8 offset:896
    ds_read_b128 v[100:103], v4 offset:28672
    ds_read_b64_tr_b16 v[204:205], v8 offset:3072
    s_waitcnt lgkmcnt(13)
    v_mfma_f32_32x32x16_bf16 v[144:159], v[228:231], v[92:95], v[144:159]
    ds_read_b64_tr_b16 v[206:207], v8 offset:3840
    ds_read_b64_tr_b16 v[208:209], v8 offset:3136
    ds_read_b64_tr_b16 v[210:211], v8 offset:3904
    s_waitcnt lgkmcnt(14)
    v_mfma_f32_32x32x16_bf16 v[160:175], v[232:235], v[92:95], v[160:175]
    ds_read_b64_tr_b16 v[212:213], v8 offset:3200
    ds_read_b64_tr_b16 v[214:215], v8 offset:3968
    s_waitcnt lgkmcnt(14)
    v_mfma_f32_32x32x16_bf16 v[176:191], v[236:239], v[92:95], v[176:191]
    s_waitcnt lgkmcnt(11)
    v_mfma_f32_32x32x16_bf16 v[144:159], v[192:195], v[96:99], v[144:159]
    ds_read_b128 v[104:107], v5 offset:28672
    ds_read_b64_tr_b16 v[216:217], v8 offset:6144
    ds_read_b64_tr_b16 v[218:219], v8 offset:6912
    s_waitcnt lgkmcnt(12)
    v_mfma_f32_32x32x16_bf16 v[160:175], v[196:199], v[96:99], v[160:175]
    ds_read_b64_tr_b16 v[220:221], v8 offset:6208
    ds_read_b64_tr_b16 v[222:223], v8 offset:6976
    ds_read_b64_tr_b16 v[224:225], v8 offset:6272
    s_waitcnt lgkmcnt(13)
    v_mfma_f32_32x32x16_bf16 v[176:191], v[200:203], v[96:99], v[176:191]
    ds_read_b64_tr_b16 v[226:227], v8 offset:7040
    ds_read_b128 v[108:111], v6 offset:28672
    ds_read_b64_tr_b16 v[228:229], v8 offset:9216
    s_waitcnt lgkmcnt(13)
    v_mfma_f32_32x32x16_bf16 v[144:159], v[204:207], v[100:103], v[144:159]
    ds_read_b64_tr_b16 v[230:231], v8 offset:9984
    ds_read_b64_tr_b16 v[232:233], v8 offset:9280
    ds_read_b64_tr_b16 v[234:235], v8 offset:10048
    s_waitcnt lgkmcnt(14)
    v_mfma_f32_32x32x16_bf16 v[160:175], v[208:211], v[100:103], v[160:175]
    ds_read_b64_tr_b16 v[236:237], v8 offset:9344
    ds_read_b64_tr_b16 v[238:239], v8 offset:10112
    s_waitcnt lgkmcnt(14)
    v_mfma_f32_32x32x16_bf16 v[176:191], v[212:215], v[100:103], v[176:191]
    v_add_u32 v3, 0xe000, v3
    v_add_u32 v4, 0xe000, v4
    v_add_u32 v5, 0xe000, v5
    v_add_u32 v6, 0xe000, v6
    v_add_u32 v8, 73728, v7
    s_barrier
    s_waitcnt lgkmcnt(11)
    v_mfma_f32_32x32x16_bf16 v[144:159], v[216:219], v[104:107], v[144:159]
    ds_read_b128 v[112:115], v3 offset:0
    ds_read_b64_tr_b16 v[192:193], v8 offset:0
    ds_read_b64_tr_b16 v[194:195], v8 offset:768
    s_waitcnt lgkmcnt(12)
    v_mfma_f32_32x32x16_bf16 v[160:175], v[220:223], v[104:107], v[160:175]
    ds_read_b64_tr_b16 v[196:197], v8 offset:64
    ds_read_b64_tr_b16 v[198:199], v8 offset:832
    ds_read_b64_tr_b16 v[200:201], v8 offset:128
    s_waitcnt lgkmcnt(13)
    v_mfma_f32_32x32x16_bf16 v[176:191], v[224:227], v[104:107], v[176:191]
    ds_read_b64_tr_b16 v[202:203], v8 offset:896
    ds_read_b128 v[116:119], v4 offset:0
    ds_read_b64_tr_b16 v[204:205], v8 offset:3072
    s_waitcnt lgkmcnt(13)
    v_mfma_f32_32x32x16_bf16 v[144:159], v[228:231], v[108:111], v[144:159]
    ds_read_b64_tr_b16 v[206:207], v8 offset:3840
    ds_read_b64_tr_b16 v[208:209], v8 offset:3136
    ds_read_b64_tr_b16 v[210:211], v8 offset:3904
    s_waitcnt lgkmcnt(14)
    v_mfma_f32_32x32x16_bf16 v[160:175], v[232:235], v[108:111], v[160:175]
    ds_read_b64_tr_b16 v[212:213], v8 offset:3200
    ds_read_b64_tr_b16 v[214:215], v8 offset:3968
    s_waitcnt lgkmcnt(14)
    v_mfma_f32_32x32x16_bf16 v[176:191], v[236:239], v[108:111], v[176:191]
    s_waitcnt lgkmcnt(11)
    v_mfma_f32_32x32x16_bf16 v[144:159], v[192:195], v[112:115], v[144:159]
    ds_read_b128 v[120:123], v5 offset:0
    ds_read_b64_tr_b16 v[216:217], v8 offset:6144
    ds_read_b64_tr_b16 v[218:219], v8 offset:6912
    s_waitcnt lgkmcnt(12)
    v_mfma_f32_32x32x16_bf16 v[160:175], v[196:199], v[112:115], v[160:175]
    ds_read_b64_tr_b16 v[220:221], v8 offset:6208
    ds_read_b64_tr_b16 v[222:223], v8 offset:6976
    ds_read_b64_tr_b16 v[224:225], v8 offset:6272
    s_waitcnt lgkmcnt(13)
    v_mfma_f32_32x32x16_bf16 v[176:191], v[200:203], v[112:115], v[176:191]
    ds_read_b64_tr_b16 v[226:227], v8 offset:7040
    ds_read_b128 v[124:127], v6 offset:0
    ds_read_b64_tr_b16 v[228:229], v8 offset:9216
    s_waitcnt lgkmcnt(13)
    v_mfma_f32_32x32x16_bf16 v[144:159], v[204:207], v[116:119], v[144:159]
    ds_read_b64_tr_b16 v[230:231], v8 offset:9984
    ds_read_b64_tr_b16 v[232:233], v8 offset:9280
    ds_read_b64_tr_b16 v[234:235], v8 offset:10048
    s_waitcnt lgkmcnt(14)
    v_mfma_f32_32x32x16_bf16 v[160:175], v[208:211], v[116:119], v[160:175]
    ds_read_b64_tr_b16 v[236:237], v8 offset:9344
    ds_read_b64_tr_b16 v[238:239], v8 offset:10112
    s_waitcnt lgkmcnt(14)
    v_mfma_f32_32x32x16_bf16 v[176:191], v[212:215], v[116:119], v[176:191]
    v_add_u32 v8, 102400, v7
    s_barrier
    s_waitcnt lgkmcnt(11)
    v_mfma_f32_32x32x16_bf16 v[144:159], v[216:219], v[120:123], v[144:159]
    ds_read_b128 v[128:131], v3 offset:28672
    ds_read_b64_tr_b16 v[192:193], v8 offset:0
    ds_read_b64_tr_b16 v[194:195], v8 offset:768
    s_waitcnt lgkmcnt(12)
    v_mfma_f32_32x32x16_bf16 v[160:175], v[220:223], v[120:123], v[160:175]
    ds_read_b64_tr_b16 v[196:197], v8 offset:64
    ds_read_b64_tr_b16 v[198:199], v8 offset:832
    ds_read_b64_tr_b16 v[200:201], v8 offset:128
    s_waitcnt lgkmcnt(13)
    v_mfma_f32_32x32x16_bf16 v[176:191], v[224:227], v[120:123], v[176:191]
    ds_read_b64_tr_b16 v[202:203], v8 offset:896
    ds_read_b128 v[132:135], v4 offset:28672
    ds_read_b64_tr_b16 v[204:205], v8 offset:3072
    s_waitcnt lgkmcnt(13)
    v_mfma_f32_32x32x16_bf16 v[144:159], v[228:231], v[124:127], v[144:159]
    ds_read_b64_tr_b16 v[206:207], v8 offset:3840
    ds_read_b64_tr_b16 v[208:209], v8 offset:3136
    ds_read_b64_tr_b16 v[210:211], v8 offset:3904
    s_waitcnt lgkmcnt(14)
    v_mfma_f32_32x32x16_bf16 v[160:175], v[232:235], v[124:127], v[160:175]
    ds_read_b64_tr_b16 v[212:213], v8 offset:3200
    ds_read_b64_tr_b16 v[214:215], v8 offset:3968
    s_waitcnt lgkmcnt(14)
    v_mfma_f32_32x32x16_bf16 v[176:191], v[236:239], v[124:127], v[176:191]
    s_waitcnt lgkmcnt(11)
    v_mfma_f32_32x32x16_bf16 v[144:159], v[192:195], v[128:131], v[144:159]
    ds_read_b128 v[136:139], v5 offset:28672
    ds_read_b64_tr_b16 v[216:217], v8 offset:6144
    ds_read_b64_tr_b16 v[218:219], v8 offset:6912
    s_waitcnt lgkmcnt(12)
    v_mfma_f32_32x32x16_bf16 v[160:175], v[196:199], v[128:131], v[160:175]
    ds_read_b64_tr_b16 v[220:221], v8 offset:6208
    ds_read_b64_tr_b16 v[222:223], v8 offset:6976
    ds_read_b64_tr_b16 v[224:225], v8 offset:6272
    s_waitcnt lgkmcnt(13)
    v_mfma_f32_32x32x16_bf16 v[176:191], v[200:203], v[128:131], v[176:191]
    ds_read_b64_tr_b16 v[226:227], v8 offset:7040
    ds_read_b128 v[140:143], v6 offset:28672
    ds_read_b64_tr_b16 v[228:229], v8 offset:9216
    s_waitcnt lgkmcnt(13)
    v_mfma_f32_32x32x16_bf16 v[144:159], v[204:207], v[132:135], v[144:159]
    ds_read_b64_tr_b16 v[230:231], v8 offset:9984
    ds_read_b64_tr_b16 v[232:233], v8 offset:9280
    ds_read_b64_tr_b16 v[234:235], v8 offset:10048
    s_waitcnt lgkmcnt(14)
    v_mfma_f32_32x32x16_bf16 v[160:175], v[208:211], v[132:135], v[160:175]
    ds_read_b64_tr_b16 v[236:237], v8 offset:9344
    ds_read_b64_tr_b16 v[238:239], v8 offset:10112
    s_waitcnt lgkmcnt(14)
    v_mfma_f32_32x32x16_bf16 v[176:191], v[212:215], v[132:135], v[176:191]
    v_add_u32 v8, 143360, v7
    s_barrier
    s_waitcnt lgkmcnt(11)
    v_mfma_f32_32x32x16_bf16 v[144:159], v[216:219], v[136:139], v[144:159]
    ds_read_b64_tr_b16 v[192:193], v8 offset:0
    ds_read_b64_tr_b16 v[194:195], v8 offset:768
    ds_read_b64_tr_b16 v[196:197], v8 offset:64
    s_waitcnt lgkmcnt(12)
    v_mfma_f32_32x32x16_bf16 v[160:175], v[220:223], v[136:139], v[160:175]
    ds_read_b64_tr_b16 v[198:199], v8 offset:832
    ds_read_b64_tr_b16 v[200:201], v8 offset:128
    ds_read_b64_tr_b16 v[202:203], v8 offset:896
    s_waitcnt lgkmcnt(13)
    v_mfma_f32_32x32x16_bf16 v[176:191], v[224:227], v[136:139], v[176:191]
    ds_read_b64_tr_b16 v[204:205], v8 offset:3072
    ds_read_b64_tr_b16 v[206:207], v8 offset:3840
    ds_read_b64_tr_b16 v[208:209], v8 offset:3136
    s_waitcnt lgkmcnt(13)
    v_mfma_f32_32x32x16_bf16 v[144:159], v[228:231], v[140:143], v[144:159]
    ds_read_b64_tr_b16 v[210:211], v8 offset:3904
    ds_read_b64_tr_b16 v[212:213], v8 offset:3200
    ds_read_b64_tr_b16 v[214:215], v8 offset:3968
    s_waitcnt lgkmcnt(14)
    v_mfma_f32_32x32x16_bf16 v[160:175], v[232:235], v[140:143], v[160:175]
    s_waitcnt lgkmcnt(12)
    v_mfma_f32_32x32x16_bf16 v[176:191], v[236:239], v[140:143], v[176:191]
    s_nop 7
    v_pk_mul_f32 v[144:145], v[144:145], s[90:91]
    v_pk_mul_f32 v[146:147], v[146:147], s[90:91]
    v_pk_mul_f32 v[148:149], v[148:149], s[90:91]
    v_pk_mul_f32 v[150:151], v[150:151], s[90:91]
    v_pk_mul_f32 v[152:153], v[152:153], s[90:91]
    v_pk_mul_f32 v[154:155], v[154:155], s[90:91]
    v_pk_mul_f32 v[156:157], v[156:157], s[90:91]
    v_pk_mul_f32 v[158:159], v[158:159], s[90:91]
    v_cvt_pk_bf16_f32 v144, v144, v145
    v_cvt_pk_bf16_f32 v145, v146, v147
    v_cvt_pk_bf16_f32 v146, v148, v149
    v_cvt_pk_bf16_f32 v147, v150, v151
    v_cvt_pk_bf16_f32 v148, v152, v153
    v_cvt_pk_bf16_f32 v149, v154, v155
    v_cvt_pk_bf16_f32 v150, v156, v157
    v_cvt_pk_bf16_f32 v151, v158, v159
    buffer_store_dwordx4 v[144:147], v13, s[52:55], s81 offen sc1
    buffer_store_dwordx4 v[148:151], v13, s[52:55], s82 offen sc1
    v_pk_mul_f32 v[160:161], v[160:161], s[94:95]
    v_pk_mul_f32 v[162:163], v[162:163], s[94:95]
    v_pk_mul_f32 v[164:165], v[164:165], s[94:95]
    v_pk_mul_f32 v[166:167], v[166:167], s[94:95]
    v_pk_mul_f32 v[168:169], v[168:169], s[94:95]
    v_pk_mul_f32 v[170:171], v[170:171], s[94:95]
    v_pk_mul_f32 v[172:173], v[172:173], s[94:95]
    v_pk_mul_f32 v[174:175], v[174:175], s[94:95]
    v_cvt_pk_bf16_f32 v160, v160, v161
    v_cvt_pk_bf16_f32 v161, v162, v163
    v_cvt_pk_bf16_f32 v162, v164, v165
    v_cvt_pk_bf16_f32 v163, v166, v167
    v_cvt_pk_bf16_f32 v164, v168, v169
    v_cvt_pk_bf16_f32 v165, v170, v171
    v_cvt_pk_bf16_f32 v166, v172, v173
    v_cvt_pk_bf16_f32 v167, v174, v175
    buffer_store_dwordx4 v[160:163], v14, s[52:55], s83 offen sc1
    buffer_store_dwordx4 v[164:167], v14, s[52:55], s84 offen sc1
    v_pk_mul_f32 v[176:177], v[176:177], s[100:101]
    v_pk_mul_f32 v[178:179], v[178:179], s[100:101]
    v_pk_mul_f32 v[180:181], v[180:181], s[100:101]
    v_pk_mul_f32 v[182:183], v[182:183], s[100:101]
    v_pk_mul_f32 v[184:185], v[184:185], s[100:101]
    v_pk_mul_f32 v[186:187], v[186:187], s[100:101]
    v_pk_mul_f32 v[188:189], v[188:189], s[100:101]
    v_pk_mul_f32 v[190:191], v[190:191], s[100:101]
    v_cvt_pk_bf16_f32 v176, v176, v177
    v_cvt_pk_bf16_f32 v177, v178, v179
    v_cvt_pk_bf16_f32 v178, v180, v181
    v_cvt_pk_bf16_f32 v179, v182, v183
    v_cvt_pk_bf16_f32 v180, v184, v185
    v_cvt_pk_bf16_f32 v181, v186, v187
    v_cvt_pk_bf16_f32 v182, v188, v189
    v_cvt_pk_bf16_f32 v183, v190, v191
    buffer_store_dwordx4 v[176:179], v15, s[52:55], s92 offen sc1
    buffer_store_dwordx4 v[180:183], v15, s[52:55], s93 offen sc1
    s_branch LB
LA_TTN:
    s_waitcnt lgkmcnt(11)
    v_mfma_f32_32x32x16_bf16 v[144:159], v[192:195], v[16:19], 0
    ds_read_b128 v[24:27], v5 offset:28672
    ds_read_b64_tr_b16 v[216:217], v8 offset:6144
    ds_read_b64_tr_b16 v[218:219], v8 offset:6912
    s_waitcnt lgkmcnt(12)
    v_mfma_f32_32x32x16_bf16 v[160:175], v[196:199], v[16:19], 0
    ds_read_b64_tr_b16 v[220:221], v8 offset:6208
    ds_read_b64_tr_b16 v[222:223], v8 offset:6976
    ds_read_b64_tr_b16 v[224:225], v8 offset:6272
    s_waitcnt lgkmcnt(13)
    v_mfma_f32_32x32x16_bf16 v[176:191], v[16:19], v[200:203], 0
    ds_read_b64_tr_b16 v[226:227], v8 offset:7040
    ds_read_b128 v[28:31], v6 offset:28672
    ds_read_b64_tr_b16 v[228:229], v8 offset:9216
    s_waitcnt lgkmcnt(13)
    v_mfma_f32_32x32x16_bf16 v[144:159], v[204:207], v[20:23], v[144:159]
    ds_read_b64_tr_b16 v[230:231], v8 offset:9984
    ds_read_b64_tr_b16 v[232:233], v8 offset:9280
    ds_read_b64_tr_b16 v[234:235], v8 offset:10048
    s_waitcnt lgkmcnt(14)
    v_mfma_f32_32x32x16_bf16 v[160:175], v[208:211], v[20:23], v[160:175]
    ds_read_b64_tr_b16 v[236:237], v8 offset:9344
    ds_read_b64_tr_b16 v[238:239], v8 offset:10112
    s_waitcnt lgkmcnt(14)
    v_mfma_f32_32x32x16_bf16 v[176:191], v[20:23], v[212:215], v[176:191]
    v_add_u32 v3, 0xe000, v3
    v_add_u32 v4, 0xe000, v4
    v_add_u32 v5, 0xe000, v5
    v_add_u32 v6, 0xe000, v6
    v_add_u32 v8, 73728, v7
    s_barrier
    s_waitcnt lgkmcnt(11)
    v_mfma_f32_32x32x16_bf16 v[144:159], v[216:219], v[24:27], v[144:159]
    ds_read_b128 v[32:35], v3 offset:0
    ds_read_b64_tr_b16 v[192:193], v8 offset:0
    ds_read_b64_tr_b16 v[194:195], v8 offset:768
    s_waitcnt lgkmcnt(12)
    v_mfma_f32_32x32x16_bf16 v[160:175], v[220:223], v[24:27], v[160:175]
    ds_read_b64_tr_b16 v[196:197], v8 offset:64
    ds_read_b64_tr_b16 v[198:199], v8 offset:832
    ds_read_b64_tr_b16 v[200:201], v8 offset:128
    s_waitcnt lgkmcnt(13)
    v_mfma_f32_32x32x16_bf16 v[176:191], v[24:27], v[224:227], v[176:191]
    ds_read_b64_tr_b16 v[202:203], v8 offset:896
    ds_read_b128 v[36:39], v4 offset:0
    ds_read_b64_tr_b16 v[204:205], v8 offset:3072
    s_waitcnt lgkmcnt(13)
    v_mfma_f32_32x32x16_bf16 v[144:159], v[228:231], v[28:31], v[144:159]
    ds_read_b64_tr_b16 v[206:207], v8 offset:3840
    ds_read_b64_tr_b16 v[208:209], v8 offset:3136
    ds_read_b64_tr_b16 v[210:211], v8 offset:3904
    s_waitcnt lgkmcnt(14)
    v_mfma_f32_32x32x16_bf16 v[160:175], v[232:235], v[28:31], v[160:175]
    ds_read_b64_tr_b16 v[212:213], v8 offset:3200
    ds_read_b64_tr_b16 v[214:215], v8 offset:3968
    s_waitcnt lgkmcnt(14)
    v_mfma_f32_32x32x16_bf16 v[176:191], v[28:31], v[236:239], v[176:191]
    s_waitcnt lgkmcnt(11)
    v_mfma_f32_32x32x16_bf16 v[144:159], v[192:195], v[32:35], v[144:159]
    ds_read_b128 v[40:43], v5 offset:0
    ds_read_b64_tr_b16 v[216:217], v8 offset:6144
    ds_read_b64_tr_b16 v[218:219], v8 offset:6912
    s_waitcnt lgkmcnt(12)
    v_mfma_f32_32x32x16_bf16 v[160:175], v[196:199], v[32:35], v[160:175]
    ds_read_b64_tr_b16 v[220:221], v8 offset:6208
    ds_read_b64_tr_b16 v[222:223], v8 offset:6976
    ds_read_b64_tr_b16 v[224:225], v8 offset:6272
    s_waitcnt lgkmcnt(13)
    v_mfma_f32_32x32x16_bf16 v[176:191], v[32:35], v[200:203], v[176:191]
    ds_read_b64_tr_b16 v[226:227], v8 offset:7040
    ds_read_b128 v[44:47], v6 offset:0
    ds_read_b64_tr_b16 v[228:229], v8 offset:9216
    s_waitcnt lgkmcnt(13)
    v_mfma_f32_32x32x16_bf16 v[144:159], v[204:207], v[36:39], v[144:159]
    ds_read_b64_tr_b16 v[230:231], v8 offset:9984
    ds_read_b64_tr_b16 v[232:233], v8 offset:9280
    ds_read_b64_tr_b16 v[234:235], v8 offset:10048
    s_waitcnt lgkmcnt(14)
    v_mfma_f32_32x32x16_bf16 v[160:175], v[208:211], v[36:39], v[160:175]
    ds_read_b64_tr_b16 v[236:237], v8 offset:9344
    ds_read_b64_tr_b16 v[238:239], v8 offset:10112
    s_waitcnt lgkmcnt(14)
    v_mfma_f32_32x32x16_bf16 v[176:191], v[36:39], v[212:215], v[176:191]
    v_add_u32 v8, 102400, v7
    s_barrier
    s_waitcnt lgkmcnt(11)
    v_mfma_f32_32x32x16_bf16 v[144:159], v[216:219], v[40:43], v[144:159]
    ds_read_b128 v[48:51], v3 offset:28672
    ds_read_b64_tr_b16 v[192:193], v8 offset:0
    ds_read_b64_tr_b16 v[194:195], v8 offset:768
    s_waitcnt lgkmcnt(12)
    v_mfma_f32_32x32x16_bf16 v[160:175], v[220:223], v[40:43], v[160:175]
    ds_read_b64_tr_b16 v[196:197], v8 offset:64
    ds_read_b64_tr_b16 v[198:199], v8 offset:832
    ds_read_b64_tr_b16 v[200:201], v8 offset:128
    s_waitcnt lgkmcnt(13)
    v_mfma_f32_32x32x16_bf16 v[176:191], v[40:43], v[224:227], v[176:191]
    ds_read_b64_tr_b16 v[202:203], v8 offset:896
    ds_read_b128 v[52:55], v4 offset:28672
    ds_read_b64_tr_b16 v[204:205], v8 offset:3072
    s_waitcnt lgkmcnt(13)
    v_mfma_f32_32x32x16_bf16 v[144:159], v[228:231], v[44:47], v[144:159]
    ds_read_b64_tr_b16 v[206:207], v8 offset:3840
    ds_read_b64_tr_b16 v[208:209], v8 offset:3136
    ds_read_b64_tr_b16 v[210:211], v8 offset:3904
    s_waitcnt lgkmcnt(14)
    v_mfma_f32_32x32x16_bf16 v[160:175], v[232:235], v[44:47], v[160:175]
    ds_read_b64_tr_b16 v[212:213], v8 offset:3200
    ds_read_b64_tr_b16 v[214:215], v8 offset:3968
    s_waitcnt lgkmcnt(14)
    v_mfma_f32_32x32x16_bf16 v[176:191], v[44:47], v[236:239], v[176:191]
    s_waitcnt lgkmcnt(11)
    v_mfma_f32_32x32x16_bf16 v[144:159], v[192:195], v[48:51], v[144:159]
    ds_read_b128 v[56:59], v5 offset:28672
    ds_read_b64_tr_b16 v[216:217], v8 offset:6144
    ds_read_b64_tr_b16 v[218:219], v8 offset:6912
    s_waitcnt lgkmcnt(12)
    v_mfma_f32_32x32x16_bf16 v[160:175], v[196:199], v[48:51], v[160:175]
    ds_read_b64_tr_b16 v[220:221], v8 offset:6208
    ds_read_b64_tr_b16 v[222:223], v8 offset:6976
    ds_read_b64_tr_b16 v[224:225], v8 offset:6272
    s_waitcnt lgkmcnt(13)
    v_mfma_f32_32x32x16_bf16 v[176:191], v[48:51], v[200:203], v[176:191]
    ds_read_b64_tr_b16 v[226:227], v8 offset:7040
    ds_read_b128 v[60:63], v6 offset:28672
    ds_read_b64_tr_b16 v[228:229], v8 offset:9216
    s_waitcnt lgkmcnt(13)
    v_mfma_f32_32x32x16_bf16 v[144:159], v[204:207], v[52:55], v[144:159]
    ds_read_b64_tr_b16 v[230:231], v8 offset:9984
    ds_read_b64_tr_b16 v[232:233], v8 offset:9280
    ds_read_b64_tr_b16 v[234:235], v8 offset:10048
    s_waitcnt lgkmcnt(14)
    v_mfma_f32_32x32x16_bf16 v[160:175], v[208:211], v[52:55], v[160:175]
    ds_read_b64_tr_b16 v[236:237], v8 offset:9344
    ds_read_b64_tr_b16 v[238:239], v8 offset:10112
    s_waitcnt lgkmcnt(14)
    v_mfma_f32_32x32x16_bf16 v[176:191], v[52:55], v[212:215], v[176:191]
    v_add_u32 v3, 0xe000, v3
    v_add_u32 v4, 0xe000, v4
    v_add_u32 v5, 0xe000, v5
    v_add_u32 v6, 0xe000, v6
    v_add_u32 v8, 131072, v7
    s_barrier
    s_waitcnt lgkmcnt(11)
    v_mfma_f32_32x32x16_bf16 v[144:159], v[216:219], v[56:59], v[144:159]
    ds_read_b128 v[64:67], v3 offset:0
    ds_read_b64_tr_b16 v[192:193], v8 offset:0
    ds_read_b64_tr_b16 v[194:195], v8 offset:768
    s_waitcnt lgkmcnt(12)
    v_mfma_f32_32x32x16_bf16 v[160:175], v[220:223], v[56:59], v[160:175]
    ds_read_b64_tr_b16 v[196:197], v8 offset:64
    ds_read_b64_tr_b16 v[198:199], v8 offset:832
    ds_read_b64_tr_b16 v[200:201], v8 offset:128
    s_waitcnt lgkmcnt(13)
    v_mfma_f32_32x32x16_bf16 v[176:191], v[56:59], v[224:227], v[176:191]
    ds_read_b64_tr_b16 v[202:203], v8 offset:896
    ds_read_b128 v[68:71], v4 offset:0
    ds_read_b64_tr_b16 v[204:205], v8 offset:3072
    s_waitcnt lgkmcnt(13)
    v_mfma_f32_32x32x16_bf16 v[144:159], v[228:231], v[60:63], v[144:159]
    ds_read_b64_tr_b16 v[206:207], v8 offset:3840
    ds_read_b64_tr_b16 v[208:209], v8 offset:3136
    ds_read_b64_tr_b16 v[210:211], v8 offset:3904
    s_waitcnt lgkmcnt(14)
    v_mfma_f32_32x32x16_bf16 v[160:175], v[232:235], v[60:63], v[160:175]
    ds_read_b64_tr_b16 v[212:213], v8 offset:3200
    ds_read_b64_tr_b16 v[214:215], v8 offset:3968
    s_waitcnt lgkmcnt(14)
    v_mfma_f32_32x32x16_bf16 v[176:191], v[60:63], v[236:239], v[176:191]
    s_waitcnt lgkmcnt(11)
    v_mfma_f32_32x32x16_bf16 v[144:159], v[192:195], v[64:67], v[144:159]
    ds_read_b128 v[72:75], v5 offset:0
    ds_read_b64_tr_b16 v[216:217], v8 offset:6144
    ds_read_b64_tr_b16 v[218:219], v8 offset:6912
    s_waitcnt lgkmcnt(12)
    v_mfma_f32_32x32x16_bf16 v[160:175], v[196:199], v[64:67], v[160:175]
    ds_read_b64_tr_b16 v[220:221], v8 offset:6208
    ds_read_b64_tr_b16 v[222:223], v8 offset:6976
    ds_read_b64_tr_b16 v[224:225], v8 offset:6272
    s_waitcnt lgkmcnt(13)
    v_mfma_f32_32x32x16_bf16 v[176:191], v[64:67], v[200:203], v[176:191]
    ds_read_b64_tr_b16 v[226:227], v8 offset:7040
    ds_read_b128 v[76:79], v6 offset:0
    ds_read_b64_tr_b16 v[228:229], v8 offset:9216
    s_waitcnt lgkmcnt(13)
    v_mfma_f32_32x32x16_bf16 v[144:159], v[204:207], v[68:71], v[144:159]
    ds_read_b64_tr_b16 v[230:231], v8 offset:9984
    ds_read_b64_tr_b16 v[232:233], v8 offset:9280
    ds_read_b64_tr_b16 v[234:235], v8 offset:10048
    s_waitcnt lgkmcnt(14)
    v_mfma_f32_32x32x16_bf16 v[160:175], v[208:211], v[68:71], v[160:175]
    ds_read_b64_tr_b16 v[236:237], v8 offset:9344
    ds_read_b64_tr_b16 v[238:239], v8 offset:10112
    s_waitcnt lgkmcnt(14)
    v_mfma_f32_32x32x16_bf16 v[176:191], v[68:71], v[212:215], v[176:191]
    v_add_u32 v3, 0xfffe4000, v3
    v_add_u32 v4, 0xfffe4000, v4
    v_add_u32 v5, 0xfffe4000, v5
    v_add_u32 v6, 0xfffe4000, v6
    v_add_u32 v8, 16384, v7
    s_barrier
    s_waitcnt lgkmcnt(11)
    v_mfma_f32_32x32x16_bf16 v[144:159], v[216:219], v[72:75], v[144:159]
    ds_read_b128 v[80:83], v3 offset:0
    ds_read_b64_tr_b16 v[192:193], v8 offset:0
    ds_read_b64_tr_b16 v[194:195], v8 offset:768
    s_waitcnt lgkmcnt(12)
    v_mfma_f32_32x32x16_bf16 v[160:175], v[220:223], v[72:75], v[160:175]
    ds_read_b64_tr_b16 v[196:197], v8 offset:64
    ds_read_b64_tr_b16 v[198:199], v8 offset:832
    ds_read_b64_tr_b16 v[200:201], v8 offset:128
    s_waitcnt lgkmcnt(13)
    v_mfma_f32_32x32x16_bf16 v[176:191], v[72:75], v[224:227], v[176:191]
    ds_read_b64_tr_b16 v[202:203], v8 offset:896
    ds_read_b128 v[84:87], v4 offset:0
    ds_read_b64_tr_b16 v[204:205], v8 offset:3072
    s_waitcnt lgkmcnt(13)
    v_mfma_f32_32x32x16_bf16 v[144:159], v[228:231], v[76:79], v[144:159]
    ds_read_b64_tr_b16 v[206:207], v8 offset:3840
    ds_read_b64_tr_b16 v[208:209], v8 offset:3136
    ds_read_b64_tr_b16 v[210:211], v8 offset:3904
    s_waitcnt lgkmcnt(14)
    v_mfma_f32_32x32x16_bf16 v[160:175], v[232:235], v[76:79], v[160:175]
    ds_read_b64_tr_b16 v[212:213], v8 offset:3200
    ds_read_b64_tr_b16 v[214:215], v8 offset:3968
    s_waitcnt lgkmcnt(14)
    v_mfma_f32_32x32x16_bf16 v[176:191], v[76:79], v[236:239], v[176:191]
    s_waitcnt lgkmcnt(11)
    v_mfma_f32_32x32x16_bf16 v[144:159], v[192:195], v[80:83], v[144:159]
    ds_read_b128 v[88:91], v5 offset:0
    ds_read_b64_tr_b16 v[216:217], v8 offset:6144
    ds_read_b64_tr_b16 v[218:219], v8 offset:6912
    s_waitcnt lgkmcnt(12)
    v_mfma_f32_32x32x16_bf16 v[160:175], v[196:199], v[80:83], v[160:175]
    ds_read_b64_tr_b16 v[220:221], v8 offset:6208
    ds_read_b64_tr_b16 v[222:223], v8 offset:6976
    ds_read_b64_tr_b16 v[224:225], v8 offset:6272
    s_waitcnt lgkmcnt(13)
    v_mfma_f32_32x32x16_bf16 v[176:191], v[80:83], v[200:203], v[176:191]
    ds_read_b64_tr_b16 v[226:227], v8 offset:7040
    ds_read_b128 v[92:95], v6 offset:0
    ds_read_b64_tr_b16 v[228:229], v8 offset:9216
    s_waitcnt lgkmcnt(13)
    v_mfma_f32_32x32x16_bf16 v[144:159], v[204:207], v[84:87], v[144:159]
    ds_read_b64_tr_b16 v[230:231], v8 offset:9984
    ds_read_b64_tr_b16 v[232:233], v8 offset:9280
    ds_read_b64_tr_b16 v[234:235], v8 offset:10048
    s_waitcnt lgkmcnt(14)
    v_mfma_f32_32x32x16_bf16 v[160:175], v[208:211], v[84:87], v[160:175]
    ds_read_b64_tr_b16 v[236:237], v8 offset:9344
    ds_read_b64_tr_b16 v[238:239], v8 offset:10112
    s_waitcnt lgkmcnt(14)
    v_mfma_f32_32x32x16_bf16 v[176:191], v[84:87], v[212:215], v[176:191]
    v_add_u32 v8, 45056, v7
    s_barrier
    s_waitcnt lgkmcnt(11)
    v_mfma_f32_32x32x16_bf16 v[144:159], v[216:219], v[88:91], v[144:159]
    ds_read_b128 v[96:99], v3 offset:28672
    ds_read_b64_tr_b16 v[192:193], v8 offset:0
    ds_read_b64_tr_b16 v[194:195], v8 offset:768
    s_waitcnt lgkmcnt(12)
    v_mfma_f32_32x32x16_bf16 v[160:175], v[220:223], v[88:91], v[160:175]
    ds_read_b64_tr_b16 v[196:197], v8 offset:64
    ds_read_b64_tr_b16 v[198:199], v8 offset:832
    ds_read_b64_tr_b16 v[200:201], v8 offset:128
    s_waitcnt lgkmcnt(13)
    v_mfma_f32_32x32x16_bf16 v[176:191], v[88:91], v[224:227], v[176:191]
    ds_read_b64_tr_b16 v[202:203], v8 offset:896
    ds_read_b128 v[100:103], v4 offset:28672
    ds_read_b64_tr_b16 v[204:205], v8 offset:3072
    s_waitcnt lgkmcnt(13)
    v_mfma_f32_32x32x16_bf16 v[144:159], v[228:231], v[92:95], v[144:159]
    ds_read_b64_tr_b16 v[206:207], v8 offset:3840
    ds_read_b64_tr_b16 v[208:209], v8 offset:3136
    ds_read_b64_tr_b16 v[210:211], v8 offset:3904
    s_waitcnt lgkmcnt(14)
    v_mfma_f32_32x32x16_bf16 v[160:175], v[232:235], v[92:95], v[160:175]
    ds_read_b64_tr_b16 v[212:213], v8 offset:3200
    ds_read_b64_tr_b16 v[214:215], v8 offset:3968
    s_waitcnt lgkmcnt(14)
    v_mfma_f32_32x32x16_bf16 v[176:191], v[92:95], v[236:239], v[176:191]
    s_waitcnt lgkmcnt(11)
    v_mfma_f32_32x32x16_bf16 v[144:159], v[192:195], v[96:99], v[144:159]
    ds_read_b128 v[104:107], v5 offset:28672
    ds_read_b64_tr_b16 v[216:217], v8 offset:6144
    ds_read_b64_tr_b16 v[218:219], v8 offset:6912
    s_waitcnt lgkmcnt(12)
    v_mfma_f32_32x32x16_bf16 v[160:175], v[196:199], v[96:99], v[160:175]
    ds_read_b64_tr_b16 v[220:221], v8 offset:6208
    ds_read_b64_tr_b16 v[222:223], v8 offset:6976
    ds_read_b64_tr_b16 v[224:225], v8 offset:6272
    s_waitcnt lgkmcnt(13)
    v_mfma_f32_32x32x16_bf16 v[176:191], v[96:99], v[200:203], v[176:191]
    ds_read_b64_tr_b16 v[226:227], v8 offset:7040
    ds_read_b128 v[108:111], v6 offset:28672
    ds_read_b64_tr_b16 v[228:229], v8 offset:9216
    s_waitcnt lgkmcnt(13)
    v_mfma_f32_32x32x16_bf16 v[144:159], v[204:207], v[100:103], v[144:159]
    ds_read_b64_tr_b16 v[230:231], v8 offset:9984
    ds_read_b64_tr_b16 v[232:233], v8 offset:9280
    ds_read_b64_tr_b16 v[234:235], v8 offset:10048
    s_waitcnt lgkmcnt(14)
    v_mfma_f32_32x32x16_bf16 v[160:175], v[208:211], v[100:103], v[160:175]
    ds_read_b64_tr_b16 v[236:237], v8 offset:9344
    ds_read_b64_tr_b16 v[238:239], v8 offset:10112
    s_waitcnt lgkmcnt(14)
    v_mfma_f32_32x32x16_bf16 v[176:191], v[100:103], v[212:215], v[176:191]
    v_add_u32 v3, 0xe000, v3
    v_add_u32 v4, 0xe000, v4
    v_add_u32 v5, 0xe000, v5
    v_add_u32 v6, 0xe000, v6
    v_add_u32 v8, 73728, v7
    s_barrier
    s_waitcnt lgkmcnt(11)
    v_mfma_f32_32x32x16_bf16 v[144:159], v[216:219], v[104:107], v[144:159]
    ds_read_b128 v[112:115], v3 offset:0
    ds_read_b64_tr_b16 v[192:193], v8 offset:0
    ds_read_b64_tr_b16 v[194:195], v8 offset:768
    s_waitcnt lgkmcnt(12)
    v_mfma_f32_32x32x16_bf16 v[160:175], v[220:223], v[104:107], v[160:175]
    ds_read_b64_tr_b16 v[196:197], v8 offset:64
    ds_read_b64_tr_b16 v[198:199], v8 offset:832
    ds_read_b64_tr_b16 v[200:201], v8 offset:128
    s_waitcnt lgkmcnt(13)
    v_mfma_f32_32x32x16_bf16 v[176:191], v[104:107], v[224:227], v[176:191]
    ds_read_b64_tr_b16 v[202:203], v8 offset:896
    ds_read_b128 v[116:119], v4 offset:0
    ds_read_b64_tr_b16 v[204:205], v8 offset:3072
    s_waitcnt lgkmcnt(13)
    v_mfma_f32_32x32x16_bf16 v[144:159], v[228:231], v[108:111], v[144:159]
    ds_read_b64_tr_b16 v[206:207], v8 offset:3840
    ds_read_b64_tr_b16 v[208:209], v8 offset:3136
    ds_read_b64_tr_b16 v[210:211], v8 offset:3904
    s_waitcnt lgkmcnt(14)
    v_mfma_f32_32x32x16_bf16 v[160:175], v[232:235], v[108:111], v[160:175]
    ds_read_b64_tr_b16 v[212:213], v8 offset:3200
    ds_read_b64_tr_b16 v[214:215], v8 offset:3968
    s_waitcnt lgkmcnt(14)
    v_mfma_f32_32x32x16_bf16 v[176:191], v[108:111], v[236:239], v[176:191]
    s_waitcnt lgkmcnt(11)
    v_mfma_f32_32x32x16_bf16 v[144:159], v[192:195], v[112:115], v[144:159]
    ds_read_b128 v[120:123], v5 offset:0
    ds_read_b64_tr_b16 v[216:217], v8 offset:6144
    ds_read_b64_tr_b16 v[218:219], v8 offset:6912
    s_waitcnt lgkmcnt(12)
    v_mfma_f32_32x32x16_bf16 v[160:175], v[196:199], v[112:115], v[160:175]
    ds_read_b64_tr_b16 v[220:221], v8 offset:6208
    ds_read_b64_tr_b16 v[222:223], v8 offset:6976
    ds_read_b64_tr_b16 v[224:225], v8 offset:6272
    s_waitcnt lgkmcnt(13)
    v_mfma_f32_32x32x16_bf16 v[176:191], v[112:115], v[200:203], v[176:191]
    ds_read_b64_tr_b16 v[226:227], v8 offset:7040
    ds_read_b128 v[124:127], v6 offset:0
    ds_read_b64_tr_b16 v[228:229], v8 offset:9216
    s_waitcnt lgkmcnt(13)
    v_mfma_f32_32x32x16_bf16 v[144:159], v[204:207], v[116:119], v[144:159]
    ds_read_b64_tr_b16 v[230:231], v8 offset:9984
    ds_read_b64_tr_b16 v[232:233], v8 offset:9280
    ds_read_b64_tr_b16 v[234:235], v8 offset:10048
    s_waitcnt lgkmcnt(14)
    v_mfma_f32_32x32x16_bf16 v[160:175], v[208:211], v[116:119], v[160:175]
    ds_read_b64_tr_b16 v[236:237], v8 offset:9344
    ds_read_b64_tr_b16 v[238:239], v8 offset:10112
    s_waitcnt lgkmcnt(14)
    v_mfma_f32_32x32x16_bf16 v[176:191], v[116:119], v[212:215], v[176:191]
    v_add_u32 v8, 102400, v7
    s_barrier
    s_waitcnt lgkmcnt(11)
    v_mfma_f32_32x32x16_bf16 v[144:159], v[216:219], v[120:123], v[144:159]
    ds_read_b128 v[128:131], v3 offset:28672
    ds_read_b64_tr_b16 v[192:193], v8 offset:0
    ds_read_b64_tr_b16 v[194:195], v8 offset:768
    s_waitcnt lgkmcnt(12)
    v_mfma_f32_32x32x16_bf16 v[160:175], v[220:223], v[120:123], v[160:175]
    ds_read_b64_tr_b16 v[196:197], v8 offset:64
    ds_read_b64_tr_b16 v[198:199], v8 offset:832
    ds_read_b64_tr_b16 v[200:201], v8 offset:128
    s_waitcnt lgkmcnt(13)
    v_mfma_f32_32x32x16_bf16 v[176:191], v[120:123], v[224:227], v[176:191]
    ds_read_b64_tr_b16 v[202:203], v8 offset:896
    ds_read_b128 v[132:135], v4 offset:28672
    ds_read_b64_tr_b16 v[204:205], v8 offset:3072
    s_waitcnt lgkmcnt(13)
    v_mfma_f32_32x32x16_bf16 v[144:159], v[228:231], v[124:127], v[144:159]
    ds_read_b64_tr_b16 v[206:207], v8 offset:3840
    ds_read_b64_tr_b16 v[208:209], v8 offset:3136
    ds_read_b64_tr_b16 v[210:211], v8 offset:3904
    s_waitcnt lgkmcnt(14)
    v_mfma_f32_32x32x16_bf16 v[160:175], v[232:235], v[124:127], v[160:175]
    ds_read_b64_tr_b16 v[212:213], v8 offset:3200
    ds_read_b64_tr_b16 v[214:215], v8 offset:3968
    s_waitcnt lgkmcnt(14)
    v_mfma_f32_32x32x16_bf16 v[176:191], v[124:127], v[236:239], v[176:191]
    s_waitcnt lgkmcnt(11)
    v_mfma_f32_32x32x16_bf16 v[144:159], v[192:195], v[128:131], v[144:159]
    ds_read_b128 v[136:139], v5 offset:28672
    ds_read_b64_tr_b16 v[216:217], v8 offset:6144
    ds_read_b64_tr_b16 v[218:219], v8 offset:6912
    s_waitcnt lgkmcnt(12)
    v_mfma_f32_32x32x16_bf16 v[160:175], v[196:199], v[128:131], v[160:175]
    ds_read_b64_tr_b16 v[220:221], v8 offset:6208
    ds_read_b64_tr_b16 v[222:223], v8 offset:6976
    ds_read_b64_tr_b16 v[224:225], v8 offset:6272
    s_waitcnt lgkmcnt(13)
    v_mfma_f32_32x32x16_bf16 v[176:191], v[128:131], v[200:203], v[176:191]
    ds_read_b64_tr_b16 v[226:227], v8 offset:7040
    ds_read_b128 v[140:143], v6 offset:28672
    ds_read_b64_tr_b16 v[228:229], v8 offset:9216
    s_waitcnt lgkmcnt(13)
    v_mfma_f32_32x32x16_bf16 v[144:159], v[204:207], v[132:135], v[144:159]
    ds_read_b64_tr_b16 v[230:231], v8 offset:9984
    ds_read_b64_tr_b16 v[232:233], v8 offset:9280
    ds_read_b64_tr_b16 v[234:235], v8 offset:10048
    s_waitcnt lgkmcnt(14)
    v_mfma_f32_32x32x16_bf16 v[160:175], v[208:211], v[132:135], v[160:175]
    ds_read_b64_tr_b16 v[236:237], v8 offset:9344
    ds_read_b64_tr_b16 v[238:239], v8 offset:10112
    s_waitcnt lgkmcnt(14)
    v_mfma_f32_32x32x16_bf16 v[176:191], v[132:135], v[212:215], v[176:191]
    v_add_u32 v8, 143360, v7
    s_barrier
    s_waitcnt lgkmcnt(11)
    v_mfma_f32_32x32x16_bf16 v[144:159], v[216:219], v[136:139], v[144:159]
    ds_read_b64_tr_b16 v[192:193], v8 offset:0
    ds_read_b64_tr_b16 v[194:195], v8 offset:768
    ds_read_b64_tr_b16 v[196:197], v8 offset:64
    s_waitcnt lgkmcnt(12)
    v_mfma_f32_32x32x16_bf16 v[160:175], v[220:223], v[136:139], v[160:175]
    ds_read_b64_tr_b16 v[198:199], v8 offset:832
    ds_read_b64_tr_b16 v[200:201], v8 offset:128
    ds_read_b64_tr_b16 v[202:203], v8 offset:896
    s_waitcnt lgkmcnt(13)
    v_mfma_f32_32x32x16_bf16 v[176:191], v[136:139], v[224:227], v[176:191]
    ds_read_b64_tr_b16 v[204:205], v8 offset:3072
    ds_read_b64_tr_b16 v[206:207], v8 offset:3840
    ds_read_b64_tr_b16 v[208:209], v8 offset:3136
    s_waitcnt lgkmcnt(13)
    v_mfma_f32_32x32x16_bf16 v[144:159], v[228:231], v[140:143], v[144:159]
    ds_read_b64_tr_b16 v[210:211], v8 offset:3904
    ds_read_b64_tr_b16 v[212:213], v8 offset:3200
    ds_read_b64_tr_b16 v[214:215], v8 offset:3968
    s_waitcnt lgkmcnt(14)
    v_mfma_f32_32x32x16_bf16 v[160:175], v[232:235], v[140:143], v[160:175]
    s_waitcnt lgkmcnt(12)
    v_mfma_f32_32x32x16_bf16 v[176:191], v[140:143], v[236:239], v[176:191]
    s_nop 7
    v_pk_mul_f32 v[144:145], v[144:145], s[90:91]
    v_pk_mul_f32 v[146:147], v[146:147], s[90:91]
    v_pk_mul_f32 v[148:149], v[148:149], s[90:91]
    v_pk_mul_f32 v[150:151], v[150:151], s[90:91]
    v_pk_mul_f32 v[152:153], v[152:153], s[90:91]
    v_pk_mul_f32 v[154:155], v[154:155], s[90:91]
    v_pk_mul_f32 v[156:157], v[156:157], s[90:91]
    v_pk_mul_f32 v[158:159], v[158:159], s[90:91]
    v_cvt_pk_bf16_f32 v144, v144, v145
    v_cvt_pk_bf16_f32 v145, v146, v147
    v_cvt_pk_bf16_f32 v146, v148, v149
    v_cvt_pk_bf16_f32 v147, v150, v151
    v_cvt_pk_bf16_f32 v148, v152, v153
    v_cvt_pk_bf16_f32 v149, v154, v155
    v_cvt_pk_bf16_f32 v150, v156, v157
    v_cvt_pk_bf16_f32 v151, v158, v159
    buffer_store_dwordx4 v[144:147], v13, s[52:55], s81 offen sc1
    buffer_store_dwordx4 v[148:151], v13, s[52:55], s82 offen sc1
    v_pk_mul_f32 v[160:161], v[160:161], s[94:95]
    v_pk_mul_f32 v[162:163], v[162:163], s[94:95]
    v_pk_mul_f32 v[164:165], v[164:165], s[94:95]
    v_pk_mul_f32 v[166:167], v[166:167], s[94:95]
    v_pk_mul_f32 v[168:169], v[168:169], s[94:95]
    v_pk_mul_f32 v[170:171], v[170:171], s[94:95]
    v_pk_mul_f32 v[172:173], v[172:173], s[94:95]
    v_pk_mul_f32 v[174:175], v[174:175], s[94:95]
    v_cvt_pk_bf16_f32 v160, v160, v161
    v_cvt_pk_bf16_f32 v161, v162, v163
    v_cvt_pk_bf16_f32 v162, v164, v165
    v_cvt_pk_bf16_f32 v163, v166, v167
    v_cvt_pk_bf16_f32 v164, v168, v169
    v_cvt_pk_bf16_f32 v165, v170, v171
    v_cvt_pk_bf16_f32 v166, v172, v173
    v_cvt_pk_bf16_f32 v167, v174, v175
    buffer_store_dwordx4 v[160:163], v14, s[52:55], s83 offen sc1
    buffer_store_dwordx4 v[164:167], v14, s[52:55], s84 offen sc1
    v_cvt_pk_bf16_f32 v176, v176, v177
    v_cvt_pk_bf16_f32 v177, v178, v179
    v_cvt_pk_bf16_f32 v178, v180, v181
    v_cvt_pk_bf16_f32 v179, v182, v183
    v_cvt_pk_bf16_f32 v180, v184, v185
    v_cvt_pk_bf16_f32 v181, v186, v187
    v_cvt_pk_bf16_f32 v182, v188, v189
    v_cvt_pk_bf16_f32 v183, v190, v191
    buffer_store_dwordx4 v[176:179], v15, s[52:55], s92 offen sc1
    buffer_store_dwordx4 v[180:183], v15, s[52:55], s93 offen sc1
    s_branch LB
LA_NNN:
    s_waitcnt lgkmcnt(11)
    v_mfma_f32_32x32x16_bf16 v[144:159], v[16:19], v[192:195], 0
    ds_read_b128 v[24:27], v5 offset:28672
    ds_read_b64_tr_b16 v[216:217], v8 offset:6144
    ds_read_b64_tr_b16 v[218:219], v8 offset:6912
    s_waitcnt lgkmcnt(12)
    v_mfma_f32_32x32x16_bf16 v[160:175], v[16:19], v[196:199], 0
    ds_read_b64_tr_b16 v[220:221], v8 offset:6208
    ds_read_b64_tr_b16 v[222:223], v8 offset:6976
    ds_read_b64_tr_b16 v[224:225], v8 offset:6272
    s_waitcnt lgkmcnt(13)
    v_mfma_f32_32x32x16_bf16 v[176:191], v[16:19], v[200:203], 0
    ds_read_b64_tr_b16 v[226:227], v8 offset:7040
    ds_read_b128 v[28:31], v6 offset:28672
    ds_read_b64_tr_b16 v[228:229], v8 offset:9216
    s_waitcnt lgkmcnt(13)
    v_mfma_f32_32x32x16_bf16 v[144:159], v[20:23], v[204:207], v[144:159]
    ds_read_b64_tr_b16 v[230:231], v8 offset:9984
    ds_read_b64_tr_b16 v[232:233], v8 offset:9280
    ds_read_b64_tr_b16 v[234:235], v8 offset:10048
    s_waitcnt lgkmcnt(14)
    v_mfma_f32_32x32x16_bf16 v[160:175], v[20:23], v[208:211], v[160:175]
    ds_read_b64_tr_b16 v[236:237], v8 offset:9344
    ds_read_b64_tr_b16 v[238:239], v8 offset:10112
    s_waitcnt lgkmcnt(14)
    v_mfma_f32_32x32x16_bf16 v[176:191], v[20:23], v[212:215], v[176:191]
    v_add_u32 v3, 0xe000, v3
    v_add_u32 v4, 0xe000, v4
    v_add_u32 v5, 0xe000, v5
    v_add_u32 v6, 0xe000, v6
    v_add_u32 v8, 73728, v7
    s_barrier
    s_waitcnt lgkmcnt(11)
    v_mfma_f32_32x32x16_bf16 v[144:159], v[24:27], v[216:219], v[144:159]
    ds_read_b128 v[32:35], v3 offset:0
    ds_read_b64_tr_b16 v[192:193], v8 offset:0
    ds_read_b64_tr_b16 v[194:195], v8 offset:768
    s_waitcnt lgkmcnt(12)
    v_mfma_f32_32x32x16_bf16 v[160:175], v[24:27], v[220:223], v[160:175]
    ds_read_b64_tr_b16 v[196:197], v8 offset:64
    ds_read_b64_tr_b16 v[198:199], v8 offset:832
    ds_read_b64_tr_b16 v[200:201], v8 offset:128
    s_waitcnt lgkmcnt(13)
    v_mfma_f32_32x32x16_bf16 v[176:191], v[24:27], v[224:227], v[176:191]
    ds_read_b64_tr_b16 v[202:203], v8 offset:896
    ds_read_b128 v[36:39], v4 offset:0
    ds_read_b64_tr_b16 v[204:205], v8 offset:3072
    s_waitcnt lgkmcnt(13)
    v_mfma_f32_32x32x16_bf16 v[144:159], v[28:31], v[228:231], v[144:159]
    ds_read_b64_tr_b16 v[206:207], v8 offset:3840
    ds_read_b64_tr_b16 v[208:209], v8 offset:3136
    ds_read_b64_tr_b16 v[210:211], v8 offset:3904
    s_waitcnt lgkmcnt(14)
    v_mfma_f32_32x32x16_bf16 v[160:175], v[28:31], v[232:235], v[160:175]
    ds_read_b64_tr_b16 v[212:213], v8 offset:3200
    ds_read_b64_tr_b16 v[214:215], v8 offset:3968
    s_waitcnt lgkmcnt(14)
    v_mfma_f32_32x32x16_bf16 v[176:191], v[28:31], v[236:239], v[176:191]
    s_waitcnt lgkmcnt(11)
    v_mfma_f32_32x32x16_bf16 v[144:159], v[32:35], v[192:195], v[144:159]
    ds_read_b128 v[40:43], v5 offset:0
    ds_read_b64_tr_b16 v[216:217], v8 offset:6144
    ds_read_b64_tr_b16 v[218:219], v8 offset:6912
    s_waitcnt lgkmcnt(12)
    v_mfma_f32_32x32x16_bf16 v[160:175], v[32:35], v[196:199], v[160:175]
    ds_read_b64_tr_b16 v[220:221], v8 offset:6208
    ds_read_b64_tr_b16 v[222:223], v8 offset:6976
    ds_read_b64_tr_b16 v[224:225], v8 offset:6272
    s_waitcnt lgkmcnt(13)
    v_mfma_f32_32x32x16_bf16 v[176:191], v[32:35], v[200:203], v[176:191]
    ds_read_b64_tr_b16 v[226:227], v8 offset:7040
    ds_read_b128 v[44:47], v6 offset:0
    ds_read_b64_tr_b16 v[228:229], v8 offset:9216
    s_waitcnt lgkmcnt(13)
    v_mfma_f32_32x32x16_bf16 v[144:159], v[36:39], v[204:207], v[144:159]
    ds_read_b64_tr_b16 v[230:231], v8 offset:9984
    ds_read_b64_tr_b16 v[232:233], v8 offset:9280
    ds_read_b64_tr_b16 v[234:235], v8 offset:10048
    s_waitcnt lgkmcnt(14)
    v_mfma_f32_32x32x16_bf16 v[160:175], v[36:39], v[208:211], v[160:175]
    ds_read_b64_tr_b16 v[236:237], v8 offset:9344
    ds_read_b64_tr_b16 v[238:239], v8 offset:10112
    s_waitcnt lgkmcnt(14)
    v_mfma_f32_32x32x16_bf16 v[176:191], v[36:39], v[212:215], v[176:191]
    v_add_u32 v8, 102400, v7
    s_barrier
    s_waitcnt lgkmcnt(11)
    v_mfma_f32_32x32x16_bf16 v[144:159], v[40:43], v[216:219], v[144:159]
    ds_read_b128 v[48:51], v3 offset:28672
    ds_read_b64_tr_b16 v[192:193], v8 offset:0
    ds_read_b64_tr_b16 v[194:195], v8 offset:768
    s_waitcnt lgkmcnt(12)
    v_mfma_f32_32x32x16_bf16 v[160:175], v[40:43], v[220:223], v[160:175]
    ds_read_b64_tr_b16 v[196:197], v8 offset:64
    ds_read_b64_tr_b16 v[198:199], v8 offset:832
    ds_read_b64_tr_b16 v[200:201], v8 offset:128
    s_waitcnt lgkmcnt(13)
    v_mfma_f32_32x32x16_bf16 v[176:191], v[40:43], v[224:227], v[176:191]
    ds_read_b64_tr_b16 v[202:203], v8 offset:896
    ds_read_b128 v[52:55], v4 offset:28672
    ds_read_b64_tr_b16 v[204:205], v8 offset:3072
    s_waitcnt lgkmcnt(13)
    v_mfma_f32_32x32x16_bf16 v[144:159], v[44:47], v[228:231], v[144:159]
    ds_read_b64_tr_b16 v[206:207], v8 offset:3840
    ds_read_b64_tr_b16 v[208:209], v8 offset:3136
    ds_read_b64_tr_b16 v[210:211], v8 offset:3904
    s_waitcnt lgkmcnt(14)
    v_mfma_f32_32x32x16_bf16 v[160:175], v[44:47], v[232:235], v[160:175]
    ds_read_b64_tr_b16 v[212:213], v8 offset:3200
    ds_read_b64_tr_b16 v[214:215], v8 offset:3968
    s_waitcnt lgkmcnt(14)
    v_mfma_f32_32x32x16_bf16 v[176:191], v[44:47], v[236:239], v[176:191]
    s_waitcnt lgkmcnt(11)
    v_mfma_f32_32x32x16_bf16 v[144:159], v[48:51], v[192:195], v[144:159]
    ds_read_b128 v[56:59], v5 offset:28672
    ds_read_b64_tr_b16 v[216:217], v8 offset:6144
    ds_read_b64_tr_b16 v[218:219], v8 offset:6912
    s_waitcnt lgkmcnt(12)
    v_mfma_f32_32x32x16_bf16 v[160:175], v[48:51], v[196:199], v[160:175]
    ds_read_b64_tr_b16 v[220:221], v8 offset:6208
    ds_read_b64_tr_b16 v[222:223], v8 offset:6976
    ds_read_b64_tr_b16 v[224:225], v8 offset:6272
    s_waitcnt lgkmcnt(13)
    v_mfma_f32_32x32x16_bf16 v[176:191], v[48:51], v[200:203], v[176:191]
    ds_read_b64_tr_b16 v[226:227], v8 offset:7040
    ds_read_b128 v[60:63], v6 offset:28672
    ds_read_b64_tr_b16 v[228:229], v8 offset:9216
    s_waitcnt lgkmcnt(13)
    v_mfma_f32_32x32x16_bf16 v[144:159], v[52:55], v[204:207], v[144:159]
    ds_read_b64_tr_b16 v[230:231], v8 offset:9984
    ds_read_b64_tr_b16 v[232:233], v8 offset:9280
    ds_read_b64_tr_b16 v[234:235], v8 offset:10048
    s_waitcnt lgkmcnt(14)
    v_mfma_f32_32x32x16_bf16 v[160:175], v[52:55], v[208:211], v[160:175]
    ds_read_b64_tr_b16 v[236:237], v8 offset:9344
    ds_read_b64_tr_b16 v[238:239], v8 offset:10112
    s_waitcnt lgkmcnt(14)
    v_mfma_f32_32x32x16_bf16 v[176:191], v[52:55], v[212:215], v[176:191]
    v_add_u32 v3, 0xe000, v3
    v_add_u32 v4, 0xe000, v4
    v_add_u32 v5, 0xe000, v5
    v_add_u32 v6, 0xe000, v6
    v_add_u32 v8, 131072, v7
    s_barrier
    s_waitcnt lgkmcnt(11)
    v_mfma_f32_32x32x16_bf16 v[144:159], v[56:59], v[216:219], v[144:159]
    ds_read_b128 v[64:67], v3 offset:0
    ds_read_b64_tr_b16 v[192:193], v8 offset:0
    ds_read_b64_tr_b16 v[194:195], v8 offset:768
    s_waitcnt lgkmcnt(12)
    v_mfma_f32_32x32x16_bf16 v[160:175], v[56:59], v[220:223], v[160:175]
    ds_read_b64_tr_b16 v[196:197], v8 offset:64
    ds_read_b64_tr_b16 v[198:199], v8 offset:832
    ds_read_b64_tr_b16 v[200:201], v8 offset:128
    s_waitcnt lgkmcnt(13)
    v_mfma_f32_32x32x16_bf16 v[176:191], v[56:59], v[224:227], v[176:191]
    ds_read_b64_tr_b16 v[202:203], v8 offset:896
    ds_read_b128 v[68:71], v4 offset:0
    ds_read_b64_tr_b16 v[204:205], v8 offset:3072
    s_waitcnt lgkmcnt(13)
    v_mfma_f32_32x32x16_bf16 v[144:159], v[60:63], v[228:231], v[144:159]
    ds_read_b64_tr_b16 v[206:207], v8 offset:3840
    ds_read_b64_tr_b16 v[208:209], v8 offset:3136
    ds_read_b64_tr_b16 v[210:211], v8 offset:3904
    s_waitcnt lgkmcnt(14)
    v_mfma_f32_32x32x16_bf16 v[160:175], v[60:63], v[232:235], v[160:175]
    ds_read_b64_tr_b16 v[212:213], v8 offset:3200
    ds_read_b64_tr_b16 v[214:215], v8 offset:3968
    s_waitcnt lgkmcnt(14)
    v_mfma_f32_32x32x16_bf16 v[176:191], v[60:63], v[236:239], v[176:191]
    s_waitcnt lgkmcnt(11)
    v_mfma_f32_32x32x16_bf16 v[144:159], v[64:67], v[192:195], v[144:159]
    ds_read_b128 v[72:75], v5 offset:0
    ds_read_b64_tr_b16 v[216:217], v8 offset:6144
    ds_read_b64_tr_b16 v[218:219], v8 offset:6912
    s_waitcnt lgkmcnt(12)
    v_mfma_f32_32x32x16_bf16 v[160:175], v[64:67], v[196:199], v[160:175]
    ds_read_b64_tr_b16 v[220:221], v8 offset:6208
    ds_read_b64_tr_b16 v[222:223], v8 offset:6976
    ds_read_b64_tr_b16 v[224:225], v8 offset:6272
    s_waitcnt lgkmcnt(13)
    v_mfma_f32_32x32x16_bf16 v[176:191], v[64:67], v[200:203], v[176:191]
    ds_read_b64_tr_b16 v[226:227], v8 offset:7040
    ds_read_b128 v[76:79], v6 offset:0
    ds_read_b64_tr_b16 v[228:229], v8 offset:9216
    s_waitcnt lgkmcnt(13)
    v_mfma_f32_32x32x16_bf16 v[144:159], v[68:71], v[204:207], v[144:159]
    ds_read_b64_tr_b16 v[230:231], v8 offset:9984
    ds_read_b64_tr_b16 v[232:233], v8 offset:9280
    ds_read_b64_tr_b16 v[234:235], v8 offset:10048
    s_waitcnt lgkmcnt(14)
    v_mfma_f32_32x32x16_bf16 v[160:175], v[68:71], v[208:211], v[160:175]
    ds_read_b64_tr_b16 v[236:237], v8 offset:9344
    ds_read_b64_tr_b16 v[238:239], v8 offset:10112
    s_waitcnt lgkmcnt(14)
    v_mfma_f32_32x32x16_bf16 v[176:191], v[68:71], v[212:215], v[176:191]
    v_add_u32 v3, 0xfffe4000, v3
    v_add_u32 v4, 0xfffe4000, v4
    v_add_u32 v5, 0xfffe4000, v5
    v_add_u32 v6, 0xfffe4000, v6
    v_add_u32 v8, 16384, v7
    s_barrier
    s_waitcnt lgkmcnt(11)
    v_mfma_f32_32x32x16_bf16 v[144:159], v[72:75], v[216:219], v[144:159]
    ds_read_b128 v[80:83], v3 offset:0
    ds_read_b64_tr_b16 v[192:193], v8 offset:0
    ds_read_b64_tr_b16 v[194:195], v8 offset:768
    s_waitcnt lgkmcnt(12)
    v_mfma_f32_32x32x16_bf16 v[160:175], v[72:75], v[220:223], v[160:175]
    ds_read_b64_tr_b16 v[196:197], v8 offset:64
    ds_read_b64_tr_b16 v[198:199], v8 offset:832
    ds_read_b64_tr_b16 v[200:201], v8 offset:128
    s_waitcnt lgkmcnt(13)
    v_mfma_f32_32x32x16_bf16 v[176:191], v[72:75], v[224:227], v[176:191]
    ds_read_b64_tr_b16 v[202:203], v8 offset:896
    ds_read_b128 v[84:87], v4 offset:0
    ds_read_b64_tr_b16 v[204:205], v8 offset:3072
    s_waitcnt lgkmcnt(13)
    v_mfma_f32_32x32x16_bf16 v[144:159], v[76:79], v[228:231], v[144:159]
    ds_read_b64_tr_b16 v[206:207], v8 offset:3840
    ds_read_b64_tr_b16 v[208:209], v8 offset:3136
    ds_read_b64_tr_b16 v[210:211], v8 offset:3904
    s_waitcnt lgkmcnt(14)
    v_mfma_f32_32x32x16_bf16 v[160:175], v[76:79], v[232:235], v[160:175]
    ds_read_b64_tr_b16 v[212:213], v8 offset:3200
    ds_read_b64_tr_b16 v[214:215], v8 offset:3968
    s_waitcnt lgkmcnt(14)
    v_mfma_f32_32x32x16_bf16 v[176:191], v[76:79], v[236:239], v[176:191]
    s_waitcnt lgkmcnt(11)
    v_mfma_f32_32x32x16_bf16 v[144:159], v[80:83], v[192:195], v[144:159]
    ds_read_b128 v[88:91], v5 offset:0
    ds_read_b64_tr_b16 v[216:217], v8 offset:6144
    ds_read_b64_tr_b16 v[218:219], v8 offset:6912
    s_waitcnt lgkmcnt(12)
    v_mfma_f32_32x32x16_bf16 v[160:175], v[80:83], v[196:199], v[160:175]
    ds_read_b64_tr_b16 v[220:221], v8 offset:6208
    ds_read_b64_tr_b16 v[222:223], v8 offset:6976
    ds_read_b64_tr_b16 v[224:225], v8 offset:6272
    s_waitcnt lgkmcnt(13)
    v_mfma_f32_32x32x16_bf16 v[176:191], v[80:83], v[200:203], v[176:191]
    ds_read_b64_tr_b16 v[226:227], v8 offset:7040
    ds_read_b128 v[92:95], v6 offset:0
    ds_read_b64_tr_b16 v[228:229], v8 offset:9216
    s_waitcnt lgkmcnt(13)
    v_mfma_f32_32x32x16_bf16 v[144:159], v[84:87], v[204:207], v[144:159]
    ds_read_b64_tr_b16 v[230:231], v8 offset:9984
    ds_read_b64_tr_b16 v[232:233], v8 offset:9280
    ds_read_b64_tr_b16 v[234:235], v8 offset:10048
    s_waitcnt lgkmcnt(14)
    v_mfma_f32_32x32x16_bf16 v[160:175], v[84:87], v[208:211], v[160:175]
    ds_read_b64_tr_b16 v[236:237], v8 offset:9344
    ds_read_b64_tr_b16 v[238:239], v8 offset:10112
    s_waitcnt lgkmcnt(14)
    v_mfma_f32_32x32x16_bf16 v[176:191], v[84:87], v[212:215], v[176:191]
    v_add_u32 v8, 45056, v7
    s_barrier
    s_waitcnt lgkmcnt(11)
    v_mfma_f32_32x32x16_bf16 v[144:159], v[88:91], v[216:219], v[144:159]
    ds_read_b128 v[96:99], v3 offset:28672
    ds_read_b64_tr_b16 v[192:193], v8 offset:0
    ds_read_b64_tr_b16 v[194:195], v8 offset:768
    s_waitcnt lgkmcnt(12)
    v_mfma_f32_32x32x16_bf16 v[160:175], v[88:91], v[220:223], v[160:175]
    ds_read_b64_tr_b16 v[196:197], v8 offset:64
    ds_read_b64_tr_b16 v[198:199], v8 offset:832
    ds_read_b64_tr_b16 v[200:201], v8 offset:128
    s_waitcnt lgkmcnt(13)
    v_mfma_f32_32x32x16_bf16 v[176:191], v[88:91], v[224:227], v[176:191]
    ds_read_b64_tr_b16 v[202:203], v8 offset:896
    ds_read_b128 v[100:103], v4 offset:28672
    ds_read_b64_tr_b16 v[204:205], v8 offset:3072
    s_waitcnt lgkmcnt(13)
    v_mfma_f32_32x32x16_bf16 v[144:159], v[92:95], v[228:231], v[144:159]
    ds_read_b64_tr_b16 v[206:207], v8 offset:3840
    ds_read_b64_tr_b16 v[208:209], v8 offset:3136
    ds_read_b64_tr_b16 v[210:211], v8 offset:3904
    s_waitcnt lgkmcnt(14)
    v_mfma_f32_32x32x16_bf16 v[160:175], v[92:95], v[232:235], v[160:175]
    ds_read_b64_tr_b16 v[212:213], v8 offset:3200
    ds_read_b64_tr_b16 v[214:215], v8 offset:3968
    s_waitcnt lgkmcnt(14)
    v_mfma_f32_32x32x16_bf16 v[176:191], v[92:95], v[236:239], v[176:191]
    s_waitcnt lgkmcnt(11)
    v_mfma_f32_32x32x16_bf16 v[144:159], v[96:99], v[192:195], v[144:159]
    ds_read_b128 v[104:107], v5 offset:28672
    ds_read_b64_tr_b16 v[216:217], v8 offset:6144
    ds_read_b64_tr_b16 v[218:219], v8 offset:6912
    s_waitcnt lgkmcnt(12)
    v_mfma_f32_32x32x16_bf16 v[160:175], v[96:99], v[196:199], v[160:175]
    ds_read_b64_tr_b16 v[220:221], v8 offset:6208
    ds_read_b64_tr_b16 v[222:223], v8 offset:6976
    ds_read_b64_tr_b16 v[224:225], v8 offset:6272
    s_waitcnt lgkmcnt(13)
    v_mfma_f32_32x32x16_bf16 v[176:191], v[96:99], v[200:203], v[176:191]
    ds_read_b64_tr_b16 v[226:227], v8 offset:7040
    ds_read_b128 v[108:111], v6 offset:28672
    ds_read_b64_tr_b16 v[228:229], v8 offset:9216
    s_waitcnt lgkmcnt(13)
    v_mfma_f32_32x32x16_bf16 v[144:159], v[100:103], v[204:207], v[144:159]
    ds_read_b64_tr_b16 v[230:231], v8 offset:9984
    ds_read_b64_tr_b16 v[232:233], v8 offset:9280
    ds_read_b64_tr_b16 v[234:235], v8 offset:10048
    s_waitcnt lgkmcnt(14)
    v_mfma_f32_32x32x16_bf16 v[160:175], v[100:103], v[208:211], v[160:175]
    ds_read_b64_tr_b16 v[236:237], v8 offset:9344
    ds_read_b64_tr_b16 v[238:239], v8 offset:10112
    s_waitcnt lgkmcnt(14)
    v_mfma_f32_32x32x16_bf16 v[176:191], v[100:103], v[212:215], v[176:191]
    v_add_u32 v3, 0xe000, v3
    v_add_u32 v4, 0xe000, v4
    v_add_u32 v5, 0xe000, v5
    v_add_u32 v6, 0xe000, v6
    v_add_u32 v8, 73728, v7
    s_barrier
    s_waitcnt lgkmcnt(11)
    v_mfma_f32_32x32x16_bf16 v[144:159], v[104:107], v[216:219], v[144:159]
    ds_read_b128 v[112:115], v3 offset:0
    ds_read_b64_tr_b16 v[192:193], v8 offset:0
    ds_read_b64_tr_b16 v[194:195], v8 offset:768
    s_waitcnt lgkmcnt(12)
    v_mfma_f32_32x32x16_bf16 v[160:175], v[104:107], v[220:223], v[160:175]
    ds_read_b64_tr_b16 v[196:197], v8 offset:64
    ds_read_b64_tr_b16 v[198:199], v8 offset:832
    ds_read_b64_tr_b16 v[200:201], v8 offset:128
    s_waitcnt lgkmcnt(13)
    v_mfma_f32_32x32x16_bf16 v[176:191], v[104:107], v[224:227], v[176:191]
    ds_read_b64_tr_b16 v[202:203], v8 offset:896
    ds_read_b128 v[116:119], v4 offset:0
    ds_read_b64_tr_b16 v[204:205], v8 offset:3072
    s_waitcnt lgkmcnt(13)
    v_mfma_f32_32x32x16_bf16 v[144:159], v[108:111], v[228:231], v[144:159]
    ds_read_b64_tr_b16 v[206:207], v8 offset:3840
    ds_read_b64_tr_b16 v[208:209], v8 offset:3136
    ds_read_b64_tr_b16 v[210:211], v8 offset:3904
    s_waitcnt lgkmcnt(14)
    v_mfma_f32_32x32x16_bf16 v[160:175], v[108:111], v[232:235], v[160:175]
    ds_read_b64_tr_b16 v[212:213], v8 offset:3200
    ds_read_b64_tr_b16 v[214:215], v8 offset:3968
    s_waitcnt lgkmcnt(14)
    v_mfma_f32_32x32x16_bf16 v[176:191], v[108:111], v[236:239], v[176:191]
    s_waitcnt lgkmcnt(11)
    v_mfma_f32_32x32x16_bf16 v[144:159], v[112:115], v[192:195], v[144:159]
    ds_read_b128 v[120:123], v5 offset:0
    ds_read_b64_tr_b16 v[216:217], v8 offset:6144
    ds_read_b64_tr_b16 v[218:219], v8 offset:6912
    s_waitcnt lgkmcnt(12)
    v_mfma_f32_32x32x16_bf16 v[160:175], v[112:115], v[196:199], v[160:175]
    ds_read_b64_tr_b16 v[220:221], v8 offset:6208
    ds_read_b64_tr_b16 v[222:223], v8 offset:6976
    ds_read_b64_tr_b16 v[224:225], v8 offset:6272
    s_waitcnt lgkmcnt(13)
    v_mfma_f32_32x32x16_bf16 v[176:191], v[112:115], v[200:203], v[176:191]
    ds_read_b64_tr_b16 v[226:227], v8 offset:7040
    ds_read_b128 v[124:127], v6 offset:0
    ds_read_b64_tr_b16 v[228:229], v8 offset:9216
    s_waitcnt lgkmcnt(13)
    v_mfma_f32_32x32x16_bf16 v[144:159], v[116:119], v[204:207], v[144:159]
    ds_read_b64_tr_b16 v[230:231], v8 offset:9984
    ds_read_b64_tr_b16 v[232:233], v8 offset:9280
    ds_read_b64_tr_b16 v[234:235], v8 offset:10048
    s_waitcnt lgkmcnt(14)
    v_mfma_f32_32x32x16_bf16 v[160:175], v[116:119], v[208:211], v[160:175]
    ds_read_b64_tr_b16 v[236:237], v8 offset:9344
    ds_read_b64_tr_b16 v[238:239], v8 offset:10112
    s_waitcnt lgkmcnt(14)
    v_mfma_f32_32x32x16_bf16 v[176:191], v[116:119], v[212:215], v[176:191]
    v_add_u32 v8, 102400, v7
    s_barrier
    s_waitcnt lgkmcnt(11)
    v_mfma_f32_32x32x16_bf16 v[144:159], v[120:123], v[216:219], v[144:159]
    ds_read_b128 v[128:131], v3 offset:28672
    ds_read_b64_tr_b16 v[192:193], v8 offset:0
    ds_read_b64_tr_b16 v[194:195], v8 offset:768
    s_waitcnt lgkmcnt(12)
    v_mfma_f32_32x32x16_bf16 v[160:175], v[120:123], v[220:223], v[160:175]
    ds_read_b64_tr_b16 v[196:197], v8 offset:64
    ds_read_b64_tr_b16 v[198:199], v8 offset:832
    ds_read_b64_tr_b16 v[200:201], v8 offset:128
    s_waitcnt lgkmcnt(13)
    v_mfma_f32_32x32x16_bf16 v[176:191], v[120:123], v[224:227], v[176:191]
    ds_read_b64_tr_b16 v[202:203], v8 offset:896
    ds_read_b128 v[132:135], v4 offset:28672
    ds_read_b64_tr_b16 v[204:205], v8 offset:3072
    s_waitcnt lgkmcnt(13)
    v_mfma_f32_32x32x16_bf16 v[144:159], v[124:127], v[228:231], v[144:159]
    ds_read_b64_tr_b16 v[206:207], v8 offset:3840
    ds_read_b64_tr_b16 v[208:209], v8 offset:3136
    ds_read_b64_tr_b16 v[210:211], v8 offset:3904
    s_waitcnt lgkmcnt(14)
    v_mfma_f32_32x32x16_bf16 v[160:175], v[124:127], v[232:235], v[160:175]
    ds_read_b64_tr_b16 v[212:213], v8 offset:3200
    ds_read_b64_tr_b16 v[214:215], v8 offset:3968
    s_waitcnt lgkmcnt(14)
    v_mfma_f32_32x32x16_bf16 v[176:191], v[124:127], v[236:239], v[176:191]
    s_waitcnt lgkmcnt(11)
    v_mfma_f32_32x32x16_bf16 v[144:159], v[128:131], v[192:195], v[144:159]
    ds_read_b128 v[136:139], v5 offset:28672
    ds_read_b64_tr_b16 v[216:217], v8 offset:6144
    ds_read_b64_tr_b16 v[218:219], v8 offset:6912
    s_waitcnt lgkmcnt(12)
    v_mfma_f32_32x32x16_bf16 v[160:175], v[128:131], v[196:199], v[160:175]
    ds_read_b64_tr_b16 v[220:221], v8 offset:6208
    ds_read_b64_tr_b16 v[222:223], v8 offset:6976
    ds_read_b64_tr_b16 v[224:225], v8 offset:6272
    s_waitcnt lgkmcnt(13)
    v_mfma_f32_32x32x16_bf16 v[176:191], v[128:131], v[200:203], v[176:191]
    ds_read_b64_tr_b16 v[226:227], v8 offset:7040
    ds_read_b128 v[140:143], v6 offset:28672
    ds_read_b64_tr_b16 v[228:229], v8 offset:9216
    s_waitcnt lgkmcnt(13)
    v_mfma_f32_32x32x16_bf16 v[144:159], v[132:135], v[204:207], v[144:159]
    ds_read_b64_tr_b16 v[230:231], v8 offset:9984
    ds_read_b64_tr_b16 v[232:233], v8 offset:9280
    ds_read_b64_tr_b16 v[234:235], v8 offset:10048
    s_waitcnt lgkmcnt(14)
    v_mfma_f32_32x32x16_bf16 v[160:175], v[132:135], v[208:211], v[160:175]
    ds_read_b64_tr_b16 v[236:237], v8 offset:9344
    ds_read_b64_tr_b16 v[238:239], v8 offset:10112
    s_waitcnt lgkmcnt(14)
    v_mfma_f32_32x32x16_bf16 v[176:191], v[132:135], v[212:215], v[176:191]
    v_add_u32 v8, 143360, v7
    s_barrier
    s_waitcnt lgkmcnt(11)
    v_mfma_f32_32x32x16_bf16 v[144:159], v[136:139], v[216:219], v[144:159]
    ds_read_b64_tr_b16 v[192:193], v8 offset:0
    ds_read_b64_tr_b16 v[194:195], v8 offset:768
    ds_read_b64_tr_b16 v[196:197], v8 offset:64
    s_waitcnt lgkmcnt(12)
    v_mfma_f32_32x32x16_bf16 v[160:175], v[136:139], v[220:223], v[160:175]
    ds_read_b64_tr_b16 v[198:199], v8 offset:832
    ds_read_b64_tr_b16 v[200:201], v8 offset:128
    ds_read_b64_tr_b16 v[202:203], v8 offset:896
    s_waitcnt lgkmcnt(13)
    v_mfma_f32_32x32x16_bf16 v[176:191], v[136:139], v[224:227], v[176:191]
    ds_read_b64_tr_b16 v[204:205], v8 offset:3072
    ds_read_b64_tr_b16 v[206:207], v8 offset:3840
    ds_read_b64_tr_b16 v[208:209], v8 offset:3136
    s_waitcnt lgkmcnt(13)
    v_mfma_f32_32x32x16_bf16 v[144:159], v[140:143], v[228:231], v[144:159]
    ds_read_b64_tr_b16 v[210:211], v8 offset:3904
    ds_read_b64_tr_b16 v[212:213], v8 offset:3200
    ds_read_b64_tr_b16 v[214:215], v8 offset:3968
    s_waitcnt lgkmcnt(14)
    v_mfma_f32_32x32x16_bf16 v[160:175], v[140:143], v[232:235], v[160:175]
    s_waitcnt lgkmcnt(12)
    v_mfma_f32_32x32x16_bf16 v[176:191], v[140:143], v[236:239], v[176:191]
    s_nop 7
    s_nop 1
    v_cvt_pk_bf16_f32 v144, v144, v145
    v_cvt_pk_bf16_f32 v145, v146, v147
    v_cvt_pk_bf16_f32 v146, v148, v149
    v_cvt_pk_bf16_f32 v147, v150, v151
    v_cvt_pk_bf16_f32 v148, v152, v153
    v_cvt_pk_bf16_f32 v149, v154, v155
    v_cvt_pk_bf16_f32 v150, v156, v157
    v_cvt_pk_bf16_f32 v151, v158, v159
    buffer_store_dwordx4 v[144:147], v13, s[52:55], s81 offen sc1
    buffer_store_dwordx4 v[148:151], v13, s[52:55], s82 offen sc1
    v_cvt_pk_bf16_f32 v160, v160, v161
    v_cvt_pk_bf16_f32 v161, v162, v163
    v_cvt_pk_bf16_f32 v162, v164, v165
    v_cvt_pk_bf16_f32 v163, v166, v167
    v_cvt_pk_bf16_f32 v164, v168, v169
    v_cvt_pk_bf16_f32 v165, v170, v171
    v_cvt_pk_bf16_f32 v166, v172, v173
    v_cvt_pk_bf16_f32 v167, v174, v175
    buffer_store_dwordx4 v[160:163], v14, s[52:55], s83 offen sc1
    buffer_store_dwordx4 v[164:167], v14, s[52:55], s84 offen sc1
    v_cvt_pk_bf16_f32 v176, v176, v177
    v_cvt_pk_bf16_f32 v177, v178, v179
    v_cvt_pk_bf16_f32 v178, v180, v181
    v_cvt_pk_bf16_f32 v179, v182, v183
    v_cvt_pk_bf16_f32 v180, v184, v185
    v_cvt_pk_bf16_f32 v181, v186, v187
    v_cvt_pk_bf16_f32 v182, v188, v189
    v_cvt_pk_bf16_f32 v183, v190, v191
    buffer_store_dwordx4 v[176:179], v15, s[52:55], s92 offen sc1
    buffer_store_dwordx4 v[180:183], v15, s[52:55], s93 offen sc1
    s_cmp_eq_u32 s7, 15
    s_cbranch_scc1 Lgate
LB:
    v_mfma_f32_32x32x16_bf16 v[144:159], v[240:243], v[252:255], 0
    v_mfma_f32_32x32x16_bf16 v[160:175], v[244:247], v[252:255], 0
    v_mfma_f32_32x32x16_bf16 v[176:191], v[248:251], v[252:255], 0
    s_waitcnt vmcnt(0)
    v_mov_b32 v9, s13
    s_mov_b64 exec, 1
    buffer_store_dword v9, off, s[52:55], s87 sc1
    s_mov_b64 exec, -1
    s_waitcnt lgkmcnt(10)
    v_mfma_f32_32x32x16_bf16 v[144:159], v[192:195], v[16:19], v[144:159]
    ds_read_b64_tr_b16 v[216:217], v8 offset:6144
    ds_read_b64_tr_b16 v[218:219], v8 offset:6912
    ds_read_b64_tr_b16 v[220:221], v8 offset:6208
    s_waitcnt lgkmcnt(11)
    v_mfma_f32_32x32x16_bf16 v[160:175], v[196:199], v[16:19], v[160:175]
    ds_read_b64_tr_b16 v[222:223], v8 offset:6976
    ds_read_b64_tr_b16 v[224:225], v8 offset:6272
    ds_read_b64_tr_b16 v[226:227], v8 offset:7040
    s_waitcnt lgkmcnt(12)
    v_mfma_f32_32x32x16_bf16 v[176:191], v[200:203], v[16:19], v[176:191]
    ds_read_b64_tr_b16 v[228:229], v8 offset:9216
    ds_read_b64_tr_b16 v[230:231], v8 offset:9984
    ds_read_b64_tr_b16 v[232:233], v8 offset:9280
    s_waitcnt lgkmcnt(13)
    v_mfma_f32_32x32x16_bf16 v[144:159], v[204:207], v[20:23], v[144:159]
    ds_read_b64_tr_b16 v[234:235], v8 offset:10048
    ds_read_b64_tr_b16 v[236:237], v8 offset:9344
    ds_read_b64_tr_b16 v[238:239], v8 offset:10112
    s_waitcnt lgkmcnt(14)
    v_mfma_f32_32x32x16_bf16 v[160:175], v[208:211], v[20:23], v[160:175]
    s_waitcnt lgkmcnt(12)
    v_mfma_f32_32x32x16_bf16 v[176:191], v[212:215], v[20:23], v[176:191]
    v_add_u32 v8, 114688, v7
    s_waitcnt lgkmcnt(10)
    v_mfma_f32_32x32x16_bf16 v[144:159], v[216:219], v[24:27], v[144:159]
    ds_read_b64_tr_b16 v[192:193], v8 offset:0
    ds_read_b64_tr_b16 v[194:195], v8 offset:768
    ds_read_b64_tr_b16 v[196:197], v8 offset:64
    s_waitcnt lgkmcnt(11)
    v_mfma_f32_32x32x16_bf16 v[160:175], v[220:223], v[24:27], v[160:175]
    ds_read_b64_tr_b16 v[198:199], v8 offset:832
    ds_read_b64_tr_b16 v[200:201], v8 offset:128
    ds_read_b64_tr_b16 v[202:203], v8 offset:896
    s_waitcnt lgkmcnt(12)
    v_mfma_f32_32x32x16_bf16 v[176:191], v[224:227], v[24:27], v[176:191]
    ds_read_b64_tr_b16 v[204:205], v8 offset:3072
    ds_read_b64_tr_b16 v[206:207], v8 offset:3840
    ds_read_b64_tr_b16 v[208:209], v8 offset:3136
    s_waitcnt lgkmcnt(13)
    v_mfma_f32_32x32x16_bf16 v[144:159], v[228:231], v[28:31], v[144:159]
    ds_read_b64_tr_b16 v[210:211], v8 offset:3904
    ds_read_b64_tr_b16 v[212:213], v8 offset:3200
    ds_read_b64_tr_b16 v[214:215], v8 offset:3968
    s_waitcnt lgkmcnt(14)
    v_mfma_f32_32x32x16_bf16 v[160:175], v[232:235], v[28:31], v[160:175]
    s_waitcnt lgkmcnt(12)
    v_mfma_f32_32x32x16_bf16 v[176:191], v[236:239], v[28:31], v[176:191]
    s_waitcnt lgkmcnt(10)
    v_mfma_f32_32x32x16_bf16 v[144:159], v[192:195], v[32:35], v[144:159]
    ds_read_b64_tr_b16 v[216:217], v8 offset:6144
    ds_read_b64_tr_b16 v[218:219], v8 offset:6912
    ds_read_b64_tr_b16 v[220:221], v8 offset:6208
    s_waitcnt lgkmcnt(11)
    v_mfma_f32_32x32x16_bf16 v[160:175], v[196:199], v[32:35], v[160:175]
    ds_read_b64_tr_b16 v[222:223], v8 offset:6976
    ds_read_b64_tr_b16 v[224:225], v8 offset:6272
    ds_read_b64_tr_b16 v[226:227], v8 offset:7040
    s_waitcnt lgkmcnt(12)
    v_mfma_f32_32x32x16_bf16 v[176:191], v[200:203], v[32:35], v[176:191]
    ds_read_b64_tr_b16 v[228:229], v8 offset:9216
    ds_read_b64_tr_b16 v[230:231], v8 offset:9984
    ds_read_b64_tr_b16 v[232:233], v8 offset:9280
    s_waitcnt lgkmcnt(13)
    v_mfma_f32_32x32x16_bf16 v[144:159], v[204:207], v[36:39], v[144:159]
    ds_read_b64_tr_b16 v[234:235], v8 offset:10048
    ds_read_b64_tr_b16 v[236:237], v8 offset:9344
    ds_read_b64_tr_b16 v[238:239], v8 offset:10112
    s_waitcnt lgkmcnt(14)
    v_mfma_f32_32x32x16_bf16 v[160:175], v[208:211], v[36:39], v[160:175]
    s_waitcnt lgkmcnt(12)
    v_mfma_f32_32x32x16_bf16 v[176:191], v[212:215], v[36:39], v[176:191]
    v_add_u32 v8, 126976, v7
    s_barrier
    s_waitcnt lgkmcnt(10)
    v_mfma_f32_32x32x16_bf16 v[144:159], v[216:219], v[40:43], v[144:159]
    ds_read_b64_tr_b16 v[192:193], v8 offset:0
    ds_read_b64_tr_b16 v[194:195], v8 offset:768
    ds_read_b64_tr_b16 v[196:197], v8 offset:64
    s_waitcnt lgkmcnt(11)
    v_mfma_f32_32x32x16_bf16 v[160:175], v[220:223], v[40:43], v[160:175]
    ds_read_b64_tr_b16 v[198:199], v8 offset:832
    ds_read_b64_tr_b16 v[200:201], v8 offset:128
    ds_read_b64_tr_b16 v[202:203], v8 offset:896
    s_waitcnt lgkmcnt(12)
    v_mfma_f32_32x32x16_bf16 v[176:191], v[224:227], v[40:43], v[176:191]
    ds_read_b64_tr_b16 v[204:205], v8 offset:3072
    ds_read_b64_tr_b16 v[206:207], v8 offset:3840
    ds_read_b64_tr_b16 v[208:209], v8 offset:3136
    s_waitcnt lgkmcnt(13)
    v_mfma_f32_32x32x16_bf16 v[144:159], v[228:231], v[44:47], v[144:159]
    ds_read_b64_tr_b16 v[210:211], v8 offset:3904
    ds_read_b64_tr_b16 v[212:213], v8 offset:3200
    ds_read_b64_tr_b16 v[214:215], v8 offset:3968
    s_waitcnt lgkmcnt(14)
    v_mfma_f32_32x32x16_bf16 v[160:175], v[232:235], v[44:47], v[160:175]
    s_waitcnt lgkmcnt(12)
    v_mfma_f32_32x32x16_bf16 v[176:191], v[236:239], v[44:47], v[176:191]
    s_waitcnt lgkmcnt(10)
    v_mfma_f32_32x32x16_bf16 v[144:159], v[192:195], v[48:51], v[144:159]
    ds_read_b64_tr_b16 v[216:217], v8 offset:6144
    ds_read_b64_tr_b16 v[218:219], v8 offset:6912
    ds_read_b64_tr_b16 v[220:221], v8 offset:6208
    s_waitcnt lgkmcnt(11)
    v_mfma_f32_32x32x16_bf16 v[160:175], v[196:199], v[48:51], v[160:175]
    ds_read_b64_tr_b16 v[222:223], v8 offset:6976
    ds_read_b64_tr_b16 v[224:225], v8 offset:6272
    ds_read_b64_tr_b16 v[226:227], v8 offset:7040
    s_waitcnt lgkmcnt(12)
    v_mfma_f32_32x32x16_bf16 v[176:191], v[200:203], v[48:51], v[176:191]
    ds_read_b64_tr_b16 v[228:229], v8 offset:9216
    ds_read_b64_tr_b16 v[230:231], v8 offset:9984
    ds_read_b64_tr_b16 v[232:233], v8 offset:9280
    s_waitcnt lgkmcnt(13)
    v_mfma_f32_32x32x16_bf16 v[144:159], v[204:207], v[52:55], v[144:159]
    ds_read_b64_tr_b16 v[234:235], v8 offset:10048
    ds_read_b64_tr_b16 v[236:237], v8 offset:9344
    ds_read_b64_tr_b16 v[238:239], v8 offset:10112
    s_waitcnt lgkmcnt(14)
    v_mfma_f32_32x32x16_bf16 v[160:175], v[208:211], v[52:55], v[160:175]
    s_waitcnt lgkmcnt(12)
    v_mfma_f32_32x32x16_bf16 v[176:191], v[212:215], v[52:55], v[176:191]
    v_add_u32 v8, 0, v7
    s_waitcnt lgkmcnt(10)
    v_mfma_f32_32x32x16_bf16 v[144:159], v[216:219], v[56:59], v[144:159]
    ds_read_b64_tr_b16 v[192:193], v8 offset:0
    ds_read_b64_tr_b16 v[194:195], v8 offset:768
    ds_read_b64_tr_b16 v[196:197], v8 offset:64
    s_waitcnt lgkmcnt(11)
    v_mfma_f32_32x32x16_bf16 v[160:175], v[220:223], v[56:59], v[160:175]
    ds_read_b64_tr_b16 v[198:199], v8 offset:832
    ds_read_b64_tr_b16 v[200:201], v8 offset:128
    ds_read_b64_tr_b16 v[202:203], v8 offset:896
    s_waitcnt lgkmcnt(12)
    v_mfma_f32_32x32x16_bf16 v[176:191], v[224:227], v[56:59], v[176:191]
    ds_read_b64_tr_b16 v[204:205], v8 offset:3072
    ds_read_b64_tr_b16 v[206:207], v8 offset:3840
    ds_read_b64_tr_b16 v[208:209], v8 offset:3136
    s_waitcnt lgkmcnt(13)
    v_mfma_f32_32x32x16_bf16 v[144:159], v[228:231], v[60:63], v[144:159]
    ds_read_b64_tr_b16 v[210:211], v8 offset:3904
    ds_read_b64_tr_b16 v[212:213], v8 offset:3200
    ds_read_b64_tr_b16 v[214:215], v8 offset:3968
    s_waitcnt lgkmcnt(14)
    v_mfma_f32_32x32x16_bf16 v[160:175], v[232:235], v[60:63], v[160:175]
    s_waitcnt lgkmcnt(12)
    v_mfma_f32_32x32x16_bf16 v[176:191], v[236:239], v[60:63], v[176:191]
    s_waitcnt lgkmcnt(10)
    v_mfma_f32_32x32x16_bf16 v[144:159], v[192:195], v[64:67], v[144:159]
    ds_read_b64_tr_b16 v[216:217], v8 offset:6144
    ds_read_b64_tr_b16 v[218:219], v8 offset:6912
    ds_read_b64_tr_b16 v[220:221], v8 offset:6208
    s_waitcnt lgkmcnt(11)
    v_mfma_f32_32x32x16_bf16 v[160:175], v[196:199], v[64:67], v[160:175]
    ds_read_b64_tr_b16 v[222:223], v8 offset:6976
    ds_read_b64_tr_b16 v[224:225], v8 offset:6272
    ds_read_b64_tr_b16 v[226:227], v8 offset:7040
    s_waitcnt lgkmcnt(12)
    v_mfma_f32_32x32x16_bf16 v[176:191], v[200:203], v[64:67], v[176:191]
    ds_read_b64_tr_b16 v[228:229], v8 offset:9216
    ds_read_b64_tr_b16 v[230:231], v8 offset:9984
    ds_read_b64_tr_b16 v[232:233], v8 offset:9280
    s_waitcnt lgkmcnt(13)
    v_mfma_f32_32x32x16_bf16 v[144:159], v[204:207], v[68:71], v[144:159]
    ds_read_b64_tr_b16 v[234:235], v8 offset:10048
    ds_read_b64_tr_b16 v[236:237], v8 offset:9344
    ds_read_b64_tr_b16 v[238:239], v8 offset:10112
    s_waitcnt lgkmcnt(14)
    v_mfma_f32_32x32x16_bf16 v[160:175], v[208:211], v[68:71], v[160:175]
    s_waitcnt lgkmcnt(12)
    v_mfma_f32_32x32x16_bf16 v[176:191], v[212:215], v[68:71], v[176:191]
    v_add_u32 v8, 12288, v7
    s_waitcnt lgkmcnt(10)
    v_mfma_f32_32x32x16_bf16 v[144:159], v[216:219], v[72:75], v[144:159]
    ds_read_b64_tr_b16 v[192:193], v8 offset:0
    ds_read_b64_tr_b16 v[194:195], v8 offset:768
    ds_read_b64_tr_b16 v[196:197], v8 offset:64
    s_waitcnt lgkmcnt(11)
    v_mfma_f32_32x32x16_bf16 v[160:175], v[220:223], v[72:75], v[160:175]
    ds_read_b64_tr_b16 v[198:199], v8 offset:832
    ds_read_b64_tr_b16 v[200:201], v8 offset:128
    ds_read_b64_tr_b16 v[202:203], v8 offset:896
    s_waitcnt lgkmcnt(12)
    v_mfma_f32_32x32x16_bf16 v[176:191], v[224:227], v[72:75], v[176:191]
    ds_read_b64_tr_b16 v[204:205], v8 offset:3072
    ds_read_b64_tr_b16 v[206:207], v8 offset:3840
    ds_read_b64_tr_b16 v[208:209], v8 offset:3136
    s_waitcnt lgkmcnt(13)
    v_mfma_f32_32x32x16_bf16 v[144:159], v[228:231], v[76:79], v[144:159]
    ds_read_b64_tr_b16 v[210:211], v8 offset:3904
    ds_read_b64_tr_b16 v[212:213], v8 offset:3200
    ds_read_b64_tr_b16 v[214:215], v8 offset:3968
    s_waitcnt lgkmcnt(14)
    v_mfma_f32_32x32x16_bf16 v[160:175], v[232:235], v[76:79], v[160:175]
    s_waitcnt lgkmcnt(12)
    v_mfma_f32_32x32x16_bf16 v[176:191], v[236:239], v[76:79], v[176:191]
    s_waitcnt lgkmcnt(10)
    v_mfma_f32_32x32x16_bf16 v[144:159], v[192:195], v[80:83], v[144:159]
    ds_read_b64_tr_b16 v[216:217], v8 offset:6144
    ds_read_b64_tr_b16 v[218:219], v8 offset:6912
    ds_read_b64_tr_b16 v[220:221], v8 offset:6208
    s_waitcnt lgkmcnt(11)
    v_mfma_f32_32x32x16_bf16 v[160:175], v[196:199], v[80:83], v[160:175]
    ds_read_b64_tr_b16 v[222:223], v8 offset:6976
    ds_read_b64_tr_b16 v[224:225], v8 offset:6272
    ds_read_b64_tr_b16 v[226:227], v8 offset:7040
    s_waitcnt lgkmcnt(12)
    v_mfma_f32_32x32x16_bf16 v[176:191], v[200:203], v[80:83], v[176:191]
    ds_read_b64_tr_b16 v[228:229], v8 offset:9216
    ds_read_b64_tr_b16 v[230:231], v8 offset:9984
    ds_read_b64_tr_b16 v[232:233], v8 offset:9280
    s_waitcnt lgkmcnt(13)
    v_mfma_f32_32x32x16_bf16 v[144:159], v[204:207], v[84:87], v[144:159]
    ds_read_b64_tr_b16 v[234:235], v8 offset:10048
    ds_read_b64_tr_b16 v[236:237], v8 offset:9344
    ds_read_b64_tr_b16 v[238:239], v8 offset:10112
    s_waitcnt lgkmcnt(14)
    v_mfma_f32_32x32x16_bf16 v[160:175], v[208:211], v[84:87], v[160:175]
    s_waitcnt lgkmcnt(12)
    v_mfma_f32_32x32x16_bf16 v[176:191], v[212:215], v[84:87], v[176:191]
    v_add_u32 v8, 28672, v7
    s_barrier
    s_waitcnt lgkmcnt(10)
    v_mfma_f32_32x32x16_bf16 v[144:159], v[216:219], v[88:91], v[144:159]
    ds_read_b64_tr_b16 v[192:193], v8 offset:0
    ds_read_b64_tr_b16 v[194:195], v8 offset:768
    ds_read_b64_tr_b16 v[196:197], v8 offset:64
    s_waitcnt lgkmcnt(11)
    v_mfma_f32_32x32x16_bf16 v[160:175], v[220:223], v[88:91], v[160:175]
    ds_read_b64_tr_b16 v[198:199], v8 offset:832
    ds_read_b64_tr_b16 v[200:201], v8 offset:128
    ds_read_b64_tr_b16 v[202:203], v8 offset:896
    s_waitcnt lgkmcnt(12)
    v_mfma_f32_32x32x16_bf16 v[176:191], v[224:227], v[88:91], v[176:191]
    ds_read_b64_tr_b16 v[204:205], v8 offset:3072
    ds_read_b64_tr_b16 v[206:207], v8 offset:3840
    ds_read_b64_tr_b16 v[208:209], v8 offset:3136
    s_waitcnt lgkmcnt(13)
    v_mfma_f32_32x32x16_bf16 v[144:159], v[228:231], v[92:95], v[144:159]
    ds_read_b64_tr_b16 v[210:211], v8 offset:3904
    ds_read_b64_tr_b16 v[212:213], v8 offset:3200
    ds_read_b64_tr_b16 v[214:215], v8 offset:3968
    s_waitcnt lgkmcnt(14)
    v_mfma_f32_32x32x16_bf16 v[160:175], v[232:235], v[92:95], v[160:175]
    s_waitcnt lgkmcnt(12)
    v_mfma_f32_32x32x16_bf16 v[176:191], v[236:239], v[92:95], v[176:191]
    s_waitcnt lgkmcnt(10)
    v_mfma_f32_32x32x16_bf16 v[144:159], v[192:195], v[96:99], v[144:159]
    ds_read_b64_tr_b16 v[216:217], v8 offset:6144
    ds_read_b64_tr_b16 v[218:219], v8 offset:6912
    ds_read_b64_tr_b16 v[220:221], v8 offset:6208
    s_waitcnt lgkmcnt(11)
    v_mfma_f32_32x32x16_bf16 v[160:175], v[196:199], v[96:99], v[160:175]
    ds_read_b64_tr_b16 v[222:223], v8 offset:6976
    ds_read_b64_tr_b16 v[224:225], v8 offset:6272
    ds_read_b64_tr_b16 v[226:227], v8 offset:7040
    s_waitcnt lgkmcnt(12)
    v_mfma_f32_32x32x16_bf16 v[176:191], v[200:203], v[96:99], v[176:191]
    ds_read_b64_tr_b16 v[228:229], v8 offset:9216
    ds_read_b64_tr_b16 v[230:231], v8 offset:9984
    ds_read_b64_tr_b16 v[232:233], v8 offset:9280
    s_waitcnt lgkmcnt(13)
    v_mfma_f32_32x32x16_bf16 v[144:159], v[204:207], v[100:103], v[144:159]
    ds_read_b64_tr_b16 v[234:235], v8 offset:10048
    ds_read_b64_tr_b16 v[236:237], v8 offset:9344
    ds_read_b64_tr_b16 v[238:239], v8 offset:10112
    s_waitcnt lgkmcnt(14)
    v_mfma_f32_32x32x16_bf16 v[160:175], v[208:211], v[100:103], v[160:175]
    s_waitcnt lgkmcnt(12)
    v_mfma_f32_32x32x16_bf16 v[176:191], v[212:215], v[100:103], v[176:191]
    v_add_u32 v8, 40960, v7
    s_waitcnt lgkmcnt(10)
    v_mfma_f32_32x32x16_bf16 v[144:159], v[216:219], v[104:107], v[144:159]
    ds_read_b64_tr_b16 v[192:193], v8 offset:0
    ds_read_b64_tr_b16 v[194:195], v8 offset:768
    ds_read_b64_tr_b16 v[196:197], v8 offset:64
    s_waitcnt lgkmcnt(11)
    v_mfma_f32_32x32x16_bf16 v[160:175], v[220:223], v[104:107], v[160:175]
    ds_read_b64_tr_b16 v[198:199], v8 offset:832
    ds_read_b64_tr_b16 v[200:201], v8 offset:128
    ds_read_b64_tr_b16 v[202:203], v8 offset:896
    s_waitcnt lgkmcnt(12)
    v_mfma_f32_32x32x16_bf16 v[176:191], v[224:227], v[104:107], v[176:191]
    ds_read_b64_tr_b16 v[204:205], v8 offset:3072
    ds_read_b64_tr_b16 v[206:207], v8 offset:3840
    ds_read_b64_tr_b16 v[208:209], v8 offset:3136
    s_waitcnt lgkmcnt(13)
    v_mfma_f32_32x32x16_bf16 v[144:159], v[228:231], v[108:111], v[144:159]
    ds_read_b64_tr_b16 v[210:211], v8 offset:3904
    ds_read_b64_tr_b16 v[212:213], v8 offset:3200
    ds_read_b64_tr_b16 v[214:215], v8 offset:3968
    s_waitcnt lgkmcnt(14)
    v_mfma_f32_32x32x16_bf16 v[160:175], v[232:235], v[108:111], v[160:175]
    s_waitcnt lgkmcnt(12)
    v_mfma_f32_32x32x16_bf16 v[176:191], v[236:239], v[108:111], v[176:191]
    s_waitcnt lgkmcnt(10)
    v_mfma_f32_32x32x16_bf16 v[144:159], v[192:195], v[112:115], v[144:159]
    ds_read_b64_tr_b16 v[216:217], v8 offset:6144
    ds_read_b64_tr_b16 v[218:219], v8 offset:6912
    ds_read_b64_tr_b16 v[220:221], v8 offset:6208
    s_waitcnt lgkmcnt(11)
    v_mfma_f32_32x32x16_bf16 v[160:175], v[196:199], v[112:115], v[160:175]
    ds_read_b64_tr_b16 v[222:223], v8 offset:6976
    ds_read_b64_tr_b16 v[224:225], v8 offset:6272
    ds_read_b64_tr_b16 v[226:227], v8 offset:7040
    s_waitcnt lgkmcnt(12)
    v_mfma_f32_32x32x16_bf16 v[176:191], v[200:203], v[112:115], v[176:191]
    ds_read_b64_tr_b16 v[228:229], v8 offset:9216
    ds_read_b64_tr_b16 v[230:231], v8 offset:9984
    ds_read_b64_tr_b16 v[232:233], v8 offset:9280
    s_waitcnt lgkmcnt(13)
    v_mfma_f32_32x32x16_bf16 v[144:159], v[204:207], v[116:119], v[144:159]
    ds_read_b64_tr_b16 v[234:235], v8 offset:10048
    ds_read_b64_tr_b16 v[236:237], v8 offset:9344
    ds_read_b64_tr_b16 v[238:239], v8 offset:10112
    s_waitcnt lgkmcnt(14)
    v_mfma_f32_32x32x16_bf16 v[160:175], v[208:211], v[116:119], v[160:175]
    s_waitcnt lgkmcnt(12)
    v_mfma_f32_32x32x16_bf16 v[176:191], v[212:215], v[116:119], v[176:191]
    v_add_u32 v8, 57344, v7
    s_waitcnt lgkmcnt(10)
    v_mfma_f32_32x32x16_bf16 v[144:159], v[216:219], v[120:123], v[144:159]
    ds_read_b64_tr_b16 v[192:193], v8 offset:0
    ds_read_b64_tr_b16 v[194:195], v8 offset:768
    ds_read_b64_tr_b16 v[196:197], v8 offset:64
    s_waitcnt lgkmcnt(11)
    v_mfma_f32_32x32x16_bf16 v[160:175], v[220:223], v[120:123], v[160:175]
    ds_read_b64_tr_b16 v[198:199], v8 offset:832
    ds_read_b64_tr_b16 v[200:201], v8 offset:128
    ds_read_b64_tr_b16 v[202:203], v8 offset:896
    s_waitcnt lgkmcnt(12)
    v_mfma_f32_32x32x16_bf16 v[176:191], v[224:227], v[120:123], v[176:191]
    ds_read_b64_tr_b16 v[204:205], v8 offset:3072
    ds_read_b64_tr_b16 v[206:207], v8 offset:3840
    ds_read_b64_tr_b16 v[208:209], v8 offset:3136
    s_waitcnt lgkmcnt(13)
    v_mfma_f32_32x32x16_bf16 v[144:159], v[228:231], v[124:127], v[144:159]
    ds_read_b64_tr_b16 v[210:211], v8 offset:3904
    ds_read_b64_tr_b16 v[212:213], v8 offset:3200
    ds_read_b64_tr_b16 v[214:215], v8 offset:3968
    s_waitcnt lgkmcnt(14)
    v_mfma_f32_32x32x16_bf16 v[160:175], v[232:235], v[124:127], v[160:175]
    s_waitcnt lgkmcnt(12)
    v_mfma_f32_32x32x16_bf16 v[176:191], v[236:239], v[124:127], v[176:191]
    s_waitcnt lgkmcnt(10)
    v_mfma_f32_32x32x16_bf16 v[144:159], v[192:195], v[128:131], v[144:159]
    ds_read_b64_tr_b16 v[216:217], v8 offset:6144
    ds_read_b64_tr_b16 v[218:219], v8 offset:6912
    ds_read_b64_tr_b16 v[220:221], v8 offset:6208
    s_waitcnt lgkmcnt(11)
    v_mfma_f32_32x32x16_bf16 v[160:175], v[196:199], v[128:131], v[160:175]
    ds_read_b64_tr_b16 v[222:223], v8 offset:6976
    ds_read_b64_tr_b16 v[224:225], v8 offset:6272
    ds_read_b64_tr_b16 v[226:227], v8 offset:7040
    s_waitcnt lgkmcnt(12)
    v_mfma_f32_32x32x16_bf16 v[176:191], v[200:203], v[128:131], v[176:191]
    ds_read_b64_tr_b16 v[228:229], v8 offset:9216
    ds_read_b64_tr_b16 v[230:231], v8 offset:9984
    ds_read_b64_tr_b16 v[232:233], v8 offset:9280
    s_waitcnt lgkmcnt(13)
    v_mfma_f32_32x32x16_bf16 v[144:159], v[204:207], v[132:135], v[144:159]
    ds_read_b64_tr_b16 v[234:235], v8 offset:10048
    ds_read_b64_tr_b16 v[236:237], v8 offset:9344
    ds_read_b64_tr_b16 v[238:239], v8 offset:10112
    s_waitcnt lgkmcnt(14)
    v_mfma_f32_32x32x16_bf16 v[160:175], v[208:211], v[132:135], v[160:175]
    s_waitcnt lgkmcnt(12)
    v_mfma_f32_32x32x16_bf16 v[176:191], v[212:215], v[132:135], v[176:191]
    s_waitcnt lgkmcnt(10)
    v_mfma_f32_32x32x16_bf16 v[144:159], v[216:219], v[136:139], v[144:159]
    s_waitcnt lgkmcnt(8)
    v_mfma_f32_32x32x16_bf16 v[160:175], v[220:223], v[136:139], v[160:175]
    s_waitcnt lgkmcnt(6)
    v_mfma_f32_32x32x16_bf16 v[176:191], v[224:227], v[136:139], v[176:191]
    s_waitcnt lgkmcnt(4)
    v_mfma_f32_32x32x16_bf16 v[144:159], v[228:231], v[140:143], v[144:159]
    s_waitcnt lgkmcnt(2)
    v_mfma_f32_32x32x16_bf16 v[160:175], v[232:235], v[140:143], v[160:175]
    s_waitcnt lgkmcnt(0)
    v_mfma_f32_32x32x16_bf16 v[176:191], v[236:239], v[140:143], v[176:191]
    s_nop 7
    v_max_f32 v144, 0, v144
    v_max_f32 v145, 0, v145
    v_max_f32 v146, 0, v146
    v_max_f32 v147, 0, v147
    v_max_f32 v148, 0, v148
    v_max_f32 v149, 0, v149
    v_max_f32 v150, 0, v150
    v_max_f32 v151, 0, v151
    v_max_f32 v152, 0, v152
    v_max_f32 v153, 0, v153
    v_max_f32 v154, 0, v154
    v_max_f32 v155, 0, v155
    v_max_f32 v156, 0, v156
    v_max_f32 v157, 0, v157
    v_max_f32 v158, 0, v158
    v_max_f32 v159, 0, v159
    v_pk_mul_f32 v[144:145], v[144:145], v[144:145]
    v_pk_mul_f32 v[146:147], v[146:147], v[146:147]
    v_pk_mul_f32 v[148:149], v[148:149], v[148:149]
    v_pk_mul_f32 v[150:151], v[150:151], v[150:151]
    v_pk_mul_f32 v[152:153], v[152:153], v[152:153]
    v_pk_mul_f32 v[154:155], v[154:155], v[154:155]
    v_pk_mul_f32 v[156:157], v[156:157], v[156:157]
    v_pk_mul_f32 v[158:159], v[158:159], v[158:159]
    v_cvt_pk_bf16_f32 v144, v144, v145
    v_cvt_pk_bf16_f32 v145, v146, v147
    v_cvt_pk_bf16_f32 v146, v148, v149
    v_cvt_pk_bf16_f32 v147, v150, v151
    v_cvt_pk_bf16_f32 v148, v152, v153
    v_cvt_pk_bf16_f32 v149, v154, v155
    v_cvt_pk_bf16_f32 v150, v156, v157
    v_cvt_pk_bf16_f32 v151, v158, v159
    s_cmp_eq_u32 s7, 14
    s_cbranch_scc1 Latt
    v_max_f32 v160, 0, v160
    v_max_f32 v161, 0, v161
    v_max_f32 v162, 0, v162
    v_max_f32 v163, 0, v163
    v_max_f32 v164, 0, v164
    v_max_f32 v165, 0, v165
    v_max_f32 v166, 0, v166
    v_max_f32 v167, 0, v167
    v_max_f32 v168, 0, v168
    v_max_f32 v169, 0, v169
    v_max_f32 v170, 0, v170
    v_max_f32 v171, 0, v171
    v_max_f32 v172, 0, v172
    v_max_f32 v173, 0, v173
    v_max_f32 v174, 0, v174
    v_max_f32 v175, 0, v175
    v_pk_mul_f32 v[160:161], v[160:161], v[160:161]
    v_pk_mul_f32 v[162:163], v[162:163], v[162:163]
    v_pk_mul_f32 v[164:165], v[164:165], v[164:165]
    v_pk_mul_f32 v[166:167], v[166:167], v[166:167]
    v_pk_mul_f32 v[168:169], v[168:169], v[168:169]
    v_pk_mul_f32 v[170:171], v[170:171], v[170:171]
    v_pk_mul_f32 v[172:173], v[172:173], v[172:173]
    v_pk_mul_f32 v[174:175], v[174:175], v[174:175]
    v_cvt_pk_bf16_f32 v160, v160, v161
    v_cvt_pk_bf16_f32 v161, v162, v163
    v_cvt_pk_bf16_f32 v162, v164, v165
    v_cvt_pk_bf16_f32 v163, v166, v167
    v_cvt_pk_bf16_f32 v164, v168, v169
    v_cvt_pk_bf16_f32 v165, v170, v171
    v_cvt_pk_bf16_f32 v166, v172, v173
    v_cvt_pk_bf16_f32 v167, v174, v175
    v_max_f32 v176, 0, v176
    v_max_f32 v177, 0, v177
    v_max_f32 v178, 0, v178
    v_max_f32 v179, 0, v179
    v_max_f32 v180, 0, v180
    v_max_f32 v181, 0, v181
    v_max_f32 v182, 0, v182
    v_max_f32 v183, 0, v183
    v_max_f32 v184, 0, v184
    v_max_f32 v185, 0, v185
    v_max_f32 v186, 0, v186
    v_max_f32 v187, 0, v187
    v_max_f32 v188, 0, v188
    v_max_f32 v189, 0, v189
    v_max_f32 v190, 0, v190
    v_max_f32 v191, 0, v191
    v_pk_mul_f32 v[176:177], v[176:177], v[176:177]
    v_pk_mul_f32 v[178:179], v[178:179], v[178:179]
    v_pk_mul_f32 v[180:181], v[180:181], v[180:181]
    v_pk_mul_f32 v[182:183], v[182:183], v[182:183]
    v_pk_mul_f32 v[184:185], v[184:185], v[184:185]
    v_pk_mul_f32 v[186:187], v[186:187], v[186:187]
    v_pk_mul_f32 v[188:189], v[188:189], v[188:189]
    v_pk_mul_f32 v[190:191], v[190:191], v[190:191]
    v_cvt_pk_bf16_f32 v176, v176, v177
    v_cvt_pk_bf16_f32 v177, v178, v179
    v_cvt_pk_bf16_f32 v178, v180, v181
    v_cvt_pk_bf16_f32 v179, v182, v183
    v_cvt_pk_bf16_f32 v180, v184, v185
    v_cvt_pk_bf16_f32 v181, v186, v187
    v_cvt_pk_bf16_f32 v182, v188, v189
    v_cvt_pk_bf16_f32 v183, v190, v191
    s_branch Latt
Lgate:
    s_waitcnt lgkmcnt(0)
    v_lshlrev_b32 v11, 4, v2
    v_add_u32 v11, 155648, v11
    s_add_u32 s14, s8, 0
    s_and_b32 s14, s14, 7
    s_lshl_b32 s14, s14, 7
    v_add_u32 v9, s14, v11
    ds_read_b128 v[192:195], v9 offset:0
    ds_read_b128 v[196:199], v9 offset:32
    ds_read_b128 v[200:203], v9 offset:64
    ds_read_b128 v[204:207], v9 offset:96
    s_add_u32 s14, s8, 1
    s_and_b32 s14, s14, 7
    s_lshl_b32 s14, s14, 7
    v_add_u32 v9, s14, v11
    ds_read_b128 v[208:211], v9 offset:0
    ds_read_b128 v[212:215], v9 offset:32
    ds_read_b128 v[216:219], v9 offset:64
    ds_read_b128 v[220:223], v9 offset:96
    s_add_u32 s14, s8, 2
    s_and_b32 s14, s14, 7
    s_lshl_b32 s14, s14, 7
    v_add_u32 v9, s14, v11
    ds_read_b128 v[224:227], v9 offset:0
    ds_read_b128 v[228:231], v9 offset:32
    ds_read_b128 v[232:235], v9 offset:64
    ds_read_b128 v[236:239], v9 offset:96
    s_waitcnt vmcnt(0)
    v_mov_b32 v10, s13
    s_mov_b64 exec, 1
    buffer_store_dword v10, off, s[52:55], s87 sc1
    s_mov_b64 exec, -1
    s_add_u32 s14, s8, 3
    s_and_b32 s14, s14, 7
    s_lshl_b32 s14, s14, 7
    v_add_u32 v9, s14, v11
    ds_read_b128 v[240:243], v9 offset:0
    ds_read_b128 v[244:247], v9 offset:32
    ds_read_b128 v[248:251], v9 offset:64
    ds_read_b128 v[252:255], v9 offset:96
    s_waitcnt lgkmcnt(12)
    v_mfma_f32_32x32x16_bf16 v[144:159], v[192:195], v[16:19], 0
    v_mfma_f32_32x32x16_bf16 v[160:175], v[196:199], v[20:23], 0
    v_mfma_f32_32x32x16_bf16 v[144:159], v[200:203], v[24:27], v[144:159]
    v_mfma_f32_32x32x16_bf16 v[160:175], v[204:207], v[28:31], v[160:175]
    s_add_u32 s14, s8, 4
    s_and_b32 s14, s14, 7
    s_lshl_b32 s14, s14, 7
    v_add_u32 v9, s14, v11
    ds_read_b128 v[192:195], v9 offset:0
    ds_read_b128 v[196:199], v9 offset:32
    ds_read_b128 v[200:203], v9 offset:64
    ds_read_b128 v[204:207], v9 offset:96
    s_waitcnt lgkmcnt(12)
    v_mfma_f32_32x32x16_bf16 v[144:159], v[208:211], v[32:35], v[144:159]
    v_mfma_f32_32x32x16_bf16 v[160:175], v[212:215], v[36:39], v[160:175]
    v_mfma_f32_32x32x16_bf16 v[144:159], v[216:219], v[40:43], v[144:159]
    v_mfma_f32_32x32x16_bf16 v[160:175], v[220:223], v[44:47], v[160:175]
    s_add_u32 s14, s8, 5
    s_and_b32 s14, s14, 7
    s_lshl_b32 s14, s14, 7
    v_add_u32 v9, s14, v11
    ds_read_b128 v[208:211], v9 offset:0
    ds_read_b128 v[212:215], v9 offset:32
    ds_read_b128 v[216:219], v9 offset:64
    ds_read_b128 v[220:223], v9 offset:96
    s_waitcnt lgkmcnt(12)
    v_mfma_f32_32x32x16_bf16 v[144:159], v[224:227], v[48:51], v[144:159]
    v_mfma_f32_32x32x16_bf16 v[160:175], v[228:231], v[52:55], v[160:175]
    v_mfma_f32_32x32x16_bf16 v[144:159], v[232:235], v[56:59], v[144:159]
    v_mfma_f32_32x32x16_bf16 v[160:175], v[236:239], v[60:63], v[160:175]
    s_add_u32 s14, s8, 6
    s_and_b32 s14, s14, 7
    s_lshl_b32 s14, s14, 7
    v_add_u32 v9, s14, v11
    ds_read_b128 v[224:227], v9 offset:0
    ds_read_b128 v[228:231], v9 offset:32
    ds_read_b128 v[232:235], v9 offset:64
    ds_read_b128 v[236:239], v9 offset:96
    s_waitcnt lgkmcnt(12)
    v_mfma_f32_32x32x16_bf16 v[144:159], v[240:243], v[64:67], v[144:159]
    v_mfma_f32_32x32x16_bf16 v[160:175], v[244:247], v[68:71], v[160:175]
    v_mfma_f32_32x32x16_bf16 v[144:159], v[248:251], v[72:75], v[144:159]
    v_mfma_f32_32x32x16_bf16 v[160:175], v[252:255], v[76:79], v[160:175]
    s_add_u32 s14, s8, 7
    s_and_b32 s14, s14, 7
    s_lshl_b32 s14, s14, 7
    v_add_u32 v9, s14, v11
    ds_read_b128 v[240:243], v9 offset:0
    ds_read_b128 v[244:247], v9 offset:32
    ds_read_b128 v[248:251], v9 offset:64
    ds_read_b128 v[252:255], v9 offset:96
    s_waitcnt lgkmcnt(12)
    v_mfma_f32_32x32x16_bf16 v[144:159], v[192:195], v[80:83], v[144:159]
    v_mfma_f32_32x32x16_bf16 v[160:175], v[196:199], v[84:87], v[160:175]
    v_mfma_f32_32x32x16_bf16 v[144:159], v[200:203], v[88:91], v[144:159]
    v_mfma_f32_32x32x16_bf16 v[160:175], v[204:207], v[92:95], v[160:175]
    s_waitcnt lgkmcnt(8)
    v_mfma_f32_32x32x16_bf16 v[144:159], v[208:211], v[96:99], v[144:159]
    v_mfma_f32_32x32x16_bf16 v[160:175], v[212:215], v[100:103], v[160:175]
    v_mfma_f32_32x32x16_bf16 v[144:159], v[216:219], v[104:107], v[144:159]
    v_mfma_f32_32x32x16_bf16 v[160:175], v[220:223], v[108:111], v[160:175]
    s_waitcnt lgkmcnt(4)
    v_mfma_f32_32x32x16_bf16 v[144:159], v[224:227], v[112:115], v[144:159]
    v_mfma_f32_32x32x16_bf16 v[160:175], v[228:231], v[116:119], v[160:175]
    v_mfma_f32_32x32x16_bf16 v[144:159], v[232:235], v[120:123], v[144:159]
    v_mfma_f32_32x32x16_bf16 v[160:175], v[236:239], v[124:127], v[160:175]
    s_waitcnt lgkmcnt(0)
    v_mfma_f32_32x32x16_bf16 v[144:159], v[240:243], v[128:131], v[144:159]
    v_mfma_f32_32x32x16_bf16 v[160:175], v[244:247], v[132:135], v[160:175]
    v_mfma_f32_32x32x16_bf16 v[144:159], v[248:251], v[136:139], v[144:159]
    v_mfma_f32_32x32x16_bf16 v[160:175], v[252:255], v[140:143], v[160:175]
    s_nop 7
    s_nop 7
    v_add_f32 v144, v144, v160
    v_mul_f32 v9, 0xbfb8aa3b, v144
    v_exp_f32 v9, v9
    s_lshl_b32 s14, s80, 7
    s_add_u32 s14, s14, 14680064
    v_add_f32 v9, 1.0, v9
    v_rcp_f32 v9, v9
    v_lshlrev_b32 v10, 2, v1
    s_nop 0
    buffer_store_dword v9, v10, s[52:55], s14 offen sc1
    s_waitcnt vmcnt(0)
    s_barrier
    s_barrier
Latt:
    v_mov_b32 v48, 0
    v_mov_b32 v49, 0
    v_mov_b32 v50, 0
    v_mov_b32 v51, 0
    v_mov_b32 v52, 0
    v_mov_b32 v53, 0
    v_mov_b32 v54, 0
    v_mov_b32 v55, 0
    v_mov_b32 v56, 0
    v_mov_b32 v57, 0
    v_mov_b32 v58, 0
    v_mov_b32 v59, 0
    v_mov_b32 v60, 0
    v_mov_b32 v61, 0
    v_mov_b32 v62, 0
    v_mov_b32 v63, 0
    v_mov_b32 v64, 0
    v_mov_b32 v65, 0
    v_mov_b32 v66, 0
    v_mov_b32 v67, 0
    v_mov_b32 v68, 0
    v_mov_b32 v69, 0
    v_mov_b32 v70, 0
    v_mov_b32 v71, 0
    v_mov_b32 v72, 0
    v_mov_b32 v73, 0
    v_mov_b32 v74, 0
    v_mov_b32 v75, 0
    v_mov_b32 v76, 0
    v_mov_b32 v77, 0
    v_mov_b32 v78, 0
    v_mov_b32 v79, 0
    v_and_b32 v9, 27, v0
    v_cmp_eq_u32 vcc, 16, v9
    v_mov_b32 v10, 0x3f803f80
    v_mov_b32 v112, 0xdddddddd
    v_add_u32 v113, 65536, v12
    v_cndmask_b32 v96, 0, v10, vcc
    v_mov_b32 v97, v96
    v_mov_b32 v98, v96
    v_mov_b32 v99, v96
    v_mov_b32 v100, v96
    v_mov_b32 v101, v96
    v_mov_b32 v102, v96
    v_mov_b32 v103, v96
    v_mov_b32 v104, v96
    v_mov_b32 v105, v96
    v_mov_b32 v106, v96
    v_mov_b32 v107, v96
    v_mov_b32 v108, v96
    v_mov_b32 v109, v96
    v_mov_b32 v110, v96
    v_mov_b32 v111, v96
    v_and_b32 v9, 15, v0
    v_lshl_add_u32 v9, v2, 4, v9
    v_lshlrev_b32 v9, 4, v9
    v_add_u32 v114, 66560, v9
    s_lshl_b32 s14, s99, 13
    s_add_u32 s14, s14, 137216
    v_add_u32 v9, s14, v12
    s_lshl_b32 s14, s10, 2
    s_add_u32 s80, s14, s99
    s_lshl_b32 s14, s80, 8
    s_add_u32 s15, s14, 14811196
    s_add_u32 s14, s14, 14680064
    v_lshl_add_u32 v116, v1, 2, s14
    v_and_b32 v10, 1, v0
    v_lshl_add_u32 v115, v10, 7, s15
    s_lshl_b32 s14, s80, 2
    s_lshr_b32 s15, s9, 3
    s_add_u32 s14, s14, s15
    s_lshl_b32 s14, s14, 5
    s_and_b32 s15, s9, 7
    s_add_u32 s14, s14, s15
    s_lshl_b32 s14, s14, 2
    s_add_u32 s89, s14, 14876672
    s_lshl_b32 s14, s80, 5
    s_add_u32 s14, s14, s9
    s_lshl_b32 s81, s14, 11
    s_add_u32 s81, s81, 12582912
    s_mov_b32 s98, 0
    s_barrier
    ds_read_b128 v[80:83], v9
    ds_read_b128 v[92:95], v113 offset:63488
    ds_read_b128 v[84:87], v9 offset:1024
    ds_read_b128 v[120:123], v113 offset:61440
    ds_read_b128 v[88:91], v113 offset:59392
    s_mov_b64 exec, s[96:97]
    ds_read_b128 v[96:99], v114 offset:63488
    ds_read_b128 v[100:103], v114 offset:64000
    s_mov_b64 exec, -1
    s_waitcnt lgkmcnt(5)
    v_mfma_f32_32x32x16_bf16 v[16:31], v[92:95], v[80:83], 0
    s_waitcnt lgkmcnt(4)
    v_mfma_f32_32x32x16_bf16 v[32:47], v[92:95], v[84:87], 0
    s_waitcnt lgkmcnt(3)
    s_nop 7
    s_nop 1
    v_exp_f32 v16, v16
    v_exp_f32 v17, v17
    v_exp_f32 v18, v18
    v_mfma_f32_32x32x16_bf16 v[192:207], v[120:123], v[80:83], 0
    v_exp_f32 v19, v19
    v_exp_f32 v20, v20
    v_exp_f32 v21, v21
    v_mfma_f32_32x32x16_bf16 v[208:223], v[120:123], v[84:87], 0
    s_waitcnt lgkmcnt(0)
    v_exp_f32 v22, v22
    v_exp_f32 v23, v23
    v_exp_f32 v24, v24
    v_exp_f32 v25, v25
    v_exp_f32 v26, v26
    v_exp_f32 v27, v27
    v_exp_f32 v28, v28
    v_exp_f32 v29, v29
    v_exp_f32 v30, v30
    v_exp_f32 v31, v31
    v_exp_f32 v32, v32
    v_exp_f32 v33, v33
    v_exp_f32 v34, v34
    v_exp_f32 v35, v35
    v_exp_f32 v36, v36
    v_exp_f32 v37, v37
    v_exp_f32 v38, v38
    v_exp_f32 v39, v39
    v_exp_f32 v40, v40
    v_exp_f32 v41, v41
    v_exp_f32 v42, v42
    v_exp_f32 v43, v43
    v_exp_f32 v44, v44
    v_exp_f32 v45, v45
    v_exp_f32 v46, v46
    v_exp_f32 v47, v47
    v_smfmac_f32_32x32x32_bf16 v[48:63], v[96:99], v[16:23], v112
    v_exp_f32 v192, v192
    v_exp_f32 v193, v193
    v_exp_f32 v194, v194
    v_smfmac_f32_32x32x32_bf16 v[64:79], v[96:99], v[32:39], v112
    s_mov_b64 exec, s[96:97]
    ds_read_b128 v[104:107], v114 offset:61440
    ds_read_b128 v[108:111], v114 offset:61952
    s_mov_b64 exec, -1
    v_exp_f32 v195, v195
    v_exp_f32 v196, v196
    v_exp_f32 v197, v197
    v_smfmac_f32_32x32x32_bf16 v[48:63], v[100:103], v[24:31], v112
    v_exp_f32 v198, v198
    v_exp_f32 v199, v199
    v_exp_f32 v200, v200
    v_smfmac_f32_32x32x32_bf16 v[64:79], v[100:103], v[40:47], v112
    s_waitcnt lgkmcnt(2)
    v_exp_f32 v201, v201
    v_exp_f32 v202, v202
    v_exp_f32 v203, v203
    v_mfma_f32_32x32x16_bf16 v[16:31], v[88:91], v[80:83], 0
    v_exp_f32 v204, v204
    v_exp_f32 v205, v205
    v_exp_f32 v206, v206
    v_mfma_f32_32x32x16_bf16 v[32:47], v[88:91], v[84:87], 0
    s_waitcnt lgkmcnt(0)
    ds_read_b128 v[88:91], v113 offset:57344
    v_exp_f32 v207, v207
    v_exp_f32 v208, v208
    v_exp_f32 v209, v209
    v_exp_f32 v210, v210
    v_exp_f32 v211, v211
    v_exp_f32 v212, v212
    v_exp_f32 v213, v213
    v_exp_f32 v214, v214
    v_exp_f32 v215, v215
    v_exp_f32 v216, v216
    v_exp_f32 v217, v217
    v_exp_f32 v218, v218
    v_exp_f32 v219, v219
    v_exp_f32 v220, v220
    v_exp_f32 v221, v221
    v_exp_f32 v222, v222
    v_exp_f32 v223, v223
    v_smfmac_f32_32x32x32_bf16 v[48:63], v[104:107], v[192:199], v112
    v_exp_f32 v16, v16
    v_exp_f32 v17, v17
    v_exp_f32 v18, v18
    v_smfmac_f32_32x32x32_bf16 v[64:79], v[104:107], v[208:215], v112
    s_mov_b64 exec, s[96:97]
    ds_read_b128 v[96:99], v114 offset:59392
    ds_read_b128 v[100:103], v114 offset:59904
    s_mov_b64 exec, -1
    v_exp_f32 v19, v19
    v_exp_f32 v20, v20
    v_exp_f32 v21, v21
    v_smfmac_f32_32x32x32_bf16 v[48:63], v[108:111], v[200:207], v112
    v_exp_f32 v22, v22
    v_exp_f32 v23, v23
    v_exp_f32 v24, v24
    v_smfmac_f32_32x32x32_bf16 v[64:79], v[108:111], v[216:223], v112
    s_waitcnt lgkmcnt(2)
    v_exp_f32 v25, v25
    v_exp_f32 v26, v26
    v_exp_f32 v27, v27
    v_mfma_f32_32x32x16_bf16 v[192:207], v[88:91], v[80:83], 0
    v_exp_f32 v28, v28
    v_exp_f32 v29, v29
    v_exp_f32 v30, v30
    v_mfma_f32_32x32x16_bf16 v[208:223], v[88:91], v[84:87], 0
    s_waitcnt lgkmcnt(0)
    ds_read_b128 v[88:91], v113 offset:55296
    v_exp_f32 v31, v31
    v_exp_f32 v32, v32
    v_exp_f32 v33, v33
    v_exp_f32 v34, v34
    v_exp_f32 v35, v35
    v_exp_f32 v36, v36
    v_exp_f32 v37, v37
    buffer_store_dwordx4 v[144:147], v12, s[40:43], s85 offen offset:0 sc1
    v_exp_f32 v38, v38
    v_exp_f32 v39, v39
    v_exp_f32 v40, v40
    v_exp_f32 v41, v41
    v_exp_f32 v42, v42
    v_exp_f32 v43, v43
    v_exp_f32 v44, v44
    v_exp_f32 v45, v45
    v_exp_f32 v46, v46
    v_exp_f32 v47, v47
    v_smfmac_f32_32x32x32_bf16 v[48:63], v[96:99], v[16:23], v112
    v_exp_f32 v192, v192
    v_exp_f32 v193, v193
    v_exp_f32 v194, v194
    v_smfmac_f32_32x32x32_bf16 v[64:79], v[96:99], v[32:39], v112
    s_mov_b64 exec, s[96:97]
    ds_read_b128 v[104:107], v114 offset:57344
    ds_read_b128 v[108:111], v114 offset:57856
    s_mov_b64 exec, -1
    v_exp_f32 v195, v195
    v_exp_f32 v196, v196
    v_exp_f32 v197, v197
    v_smfmac_f32_32x32x32_bf16 v[48:63], v[100:103], v[24:31], v112
    v_exp_f32 v198, v198
    v_exp_f32 v199, v199
    v_exp_f32 v200, v200
    v_smfmac_f32_32x32x32_bf16 v[64:79], v[100:103], v[40:47], v112
    s_waitcnt lgkmcnt(2)
    v_exp_f32 v201, v201
    v_exp_f32 v202, v202
    v_exp_f32 v203, v203
    v_mfma_f32_32x32x16_bf16 v[16:31], v[88:91], v[80:83], 0
    v_exp_f32 v204, v204
    v_exp_f32 v205, v205
    v_exp_f32 v206, v206
    v_mfma_f32_32x32x16_bf16 v[32:47], v[88:91], v[84:87], 0
    s_waitcnt lgkmcnt(0)
    ds_read_b128 v[88:91], v113 offset:53248
    v_exp_f32 v207, v207
    v_exp_f32 v208, v208
    v_exp_f32 v209, v209
    v_exp_f32 v210, v210
    v_exp_f32 v211, v211
    v_exp_f32 v212, v212
    v_exp_f32 v213, v213
    buffer_store_dwordx4 v[148:151], v12, s[40:43], s85 offen offset:1024 sc1
    v_exp_f32 v214, v214
    v_exp_f32 v215, v215
    v_exp_f32 v216, v216
    v_exp_f32 v217, v217
    v_exp_f32 v218, v218
    v_exp_f32 v219, v219
    v_exp_f32 v220, v220
    v_exp_f32 v221, v221
    v_exp_f32 v222, v222
    v_exp_f32 v223, v223
    v_smfmac_f32_32x32x32_bf16 v[48:63], v[104:107], v[192:199], v112
    v_exp_f32 v16, v16
    v_exp_f32 v17, v17
    v_exp_f32 v18, v18
    v_smfmac_f32_32x32x32_bf16 v[64:79], v[104:107], v[208:215], v112
    s_mov_b64 exec, s[96:97]
    ds_read_b128 v[96:99], v114 offset:55296
    ds_read_b128 v[100:103], v114 offset:55808
    s_mov_b64 exec, -1
    v_exp_f32 v19, v19
    v_exp_f32 v20, v20
    v_exp_f32 v21, v21
    v_smfmac_f32_32x32x32_bf16 v[48:63], v[108:111], v[200:207], v112
    v_exp_f32 v22, v22
    v_exp_f32 v23, v23
    v_exp_f32 v24, v24
    v_smfmac_f32_32x32x32_bf16 v[64:79], v[108:111], v[216:223], v112
    s_waitcnt lgkmcnt(2)
    v_exp_f32 v25, v25
    v_exp_f32 v26, v26
    v_exp_f32 v27, v27
    v_mfma_f32_32x32x16_bf16 v[192:207], v[88:91], v[80:83], 0
    v_exp_f32 v28, v28
    v_exp_f32 v29, v29
    v_exp_f32 v30, v30
    v_mfma_f32_32x32x16_bf16 v[208:223], v[88:91], v[84:87], 0
    s_waitcnt lgkmcnt(0)
    ds_read_b128 v[88:91], v113 offset:51200
    v_exp_f32 v31, v31
    v_exp_f32 v32, v32
    v_exp_f32 v33, v33
    v_exp_f32 v34, v34
    v_exp_f32 v35, v35
    v_exp_f32 v36, v36
    v_exp_f32 v37, v37
    buffer_store_dwordx4 v[160:163], v12, s[44:47], s85 offen offset:2048 sc1
    v_exp_f32 v38, v38
    v_exp_f32 v39, v39
    v_exp_f32 v40, v40
    v_exp_f32 v41, v41
    v_exp_f32 v42, v42
    v_exp_f32 v43, v43
    v_exp_f32 v44, v44
    v_exp_f32 v45, v45
    v_exp_f32 v46, v46
    v_exp_f32 v47, v47
    v_smfmac_f32_32x32x32_bf16 v[48:63], v[96:99], v[16:23], v112
    v_exp_f32 v192, v192
    v_exp_f32 v193, v193
    v_exp_f32 v194, v194
    v_smfmac_f32_32x32x32_bf16 v[64:79], v[96:99], v[32:39], v112
    s_mov_b64 exec, s[96:97]
    ds_read_b128 v[104:107], v114 offset:53248
    ds_read_b128 v[108:111], v114 offset:53760
    s_mov_b64 exec, -1
    v_exp_f32 v195, v195
    v_exp_f32 v196, v196
    v_exp_f32 v197, v197
    v_smfmac_f32_32x32x32_bf16 v[48:63], v[100:103], v[24:31], v112
    v_exp_f32 v198, v198
    v_exp_f32 v199, v199
    v_exp_f32 v200, v200
    v_smfmac_f32_32x32x32_bf16 v[64:79], v[100:103], v[40:47], v112
    s_waitcnt lgkmcnt(2)
    v_exp_f32 v201, v201
    v_exp_f32 v202, v202
    v_exp_f32 v203, v203
    v_mfma_f32_32x32x16_bf16 v[16:31], v[88:91], v[80:83], 0
    v_exp_f32 v204, v204
    v_exp_f32 v205, v205
    v_exp_f32 v206, v206
    v_mfma_f32_32x32x16_bf16 v[32:47], v[88:91], v[84:87], 0
    s_waitcnt lgkmcnt(0)
    ds_read_b128 v[88:91], v113 offset:49152
    v_exp_f32 v207, v207
    v_exp_f32 v208, v208
    v_exp_f32 v209, v209
    v_exp_f32 v210, v210
    v_exp_f32 v211, v211
    v_exp_f32 v212, v212
    v_exp_f32 v213, v213
    buffer_store_dwordx4 v[164:167], v12, s[44:47], s85 offen offset:3072 sc1
    v_exp_f32 v214, v214
    v_exp_f32 v215, v215
    v_exp_f32 v216, v216
    v_exp_f32 v217, v217
    v_exp_f32 v218, v218
    v_exp_f32 v219, v219
    v_exp_f32 v220, v220
    v_exp_f32 v221, v221
    v_exp_f32 v222, v222
    v_exp_f32 v223, v223
    v_smfmac_f32_32x32x32_bf16 v[48:63], v[104:107], v[192:199], v112
    v_exp_f32 v16, v16
    v_exp_f32 v17, v17
    v_exp_f32 v18, v18
    v_smfmac_f32_32x32x32_bf16 v[64:79], v[104:107], v[208:215], v112
    s_mov_b64 exec, s[96:97]
    ds_read_b128 v[96:99], v114 offset:51200
    ds_read_b128 v[100:103], v114 offset:51712
    s_mov_b64 exec, -1
    v_exp_f32 v19, v19
    v_exp_f32 v20, v20
    v_exp_f32 v21, v21
    v_smfmac_f32_32x32x32_bf16 v[48:63], v[108:111], v[200:207], v112
    v_exp_f32 v22, v22
    v_exp_f32 v23, v23
    v_exp_f32 v24, v24
    v_smfmac_f32_32x32x32_bf16 v[64:79], v[108:111], v[216:223], v112
    s_waitcnt lgkmcnt(2)
    v_exp_f32 v25, v25
    v_exp_f32 v26, v26
    v_exp_f32 v27, v27
    v_mfma_f32_32x32x16_bf16 v[192:207], v[88:91], v[80:83], 0
    v_exp_f32 v28, v28
    v_exp_f32 v29, v29
    v_exp_f32 v30, v30
    v_mfma_f32_32x32x16_bf16 v[208:223], v[88:91], v[84:87], 0
    s_barrier
    s_waitcnt lgkmcnt(0)
    ds_read_b128 v[88:91], v113 offset:47104
    v_exp_f32 v31, v31
    v_exp_f32 v32, v32
    v_exp_f32 v33, v33
    v_exp_f32 v34, v34
    v_exp_f32 v35, v35
    v_exp_f32 v36, v36
    v_exp_f32 v37, v37
    buffer_store_dwordx4 v[176:179], v12, s[44:47], s86 offen offset:0 sc1
    v_exp_f32 v38, v38
    v_exp_f32 v39, v39
    v_exp_f32 v40, v40
    v_exp_f32 v41, v41
    v_exp_f32 v42, v42
    v_exp_f32 v43, v43
    v_exp_f32 v44, v44
    v_exp_f32 v45, v45
    v_exp_f32 v46, v46
    v_exp_f32 v47, v47
    v_smfmac_f32_32x32x32_bf16 v[48:63], v[96:99], v[16:23], v112
    v_exp_f32 v192, v192
    v_exp_f32 v193, v193
    v_exp_f32 v194, v194
    v_smfmac_f32_32x32x32_bf16 v[64:79], v[96:99], v[32:39], v112
    s_mov_b64 exec, s[96:97]
    ds_read_b128 v[104:107], v114 offset:49152
    ds_read_b128 v[108:111], v114 offset:49664
    s_mov_b64 exec, -1
    v_exp_f32 v195, v195
    v_exp_f32 v196, v196
    v_exp_f32 v197, v197
    v_smfmac_f32_32x32x32_bf16 v[48:63], v[100:103], v[24:31], v112
    v_exp_f32 v198, v198
    v_exp_f32 v199, v199
    v_exp_f32 v200, v200
    v_smfmac_f32_32x32x32_bf16 v[64:79], v[100:103], v[40:47], v112
    s_waitcnt lgkmcnt(2)
    v_exp_f32 v201, v201
    v_exp_f32 v202, v202
    v_exp_f32 v203, v203
    v_mfma_f32_32x32x16_bf16 v[16:31], v[88:91], v[80:83], 0
    v_exp_f32 v204, v204
    v_exp_f32 v205, v205
    v_exp_f32 v206, v206
    v_mfma_f32_32x32x16_bf16 v[32:47], v[88:91], v[84:87], 0
    s_waitcnt lgkmcnt(0)
    ds_read_b128 v[88:91], v113 offset:45056
    v_exp_f32 v207, v207
    v_exp_f32 v208, v208
    v_exp_f32 v209, v209
    v_exp_f32 v210, v210
    v_exp_f32 v211, v211
    v_exp_f32 v212, v212
    v_exp_f32 v213, v213
    buffer_store_dwordx4 v[180:183], v12, s[44:47], s86 offen offset:1024 sc1
    v_exp_f32 v214, v214
    v_exp_f32 v215, v215
    v_exp_f32 v216, v216
    v_exp_f32 v217, v217
    v_exp_f32 v218, v218
    v_exp_f32 v219, v219
    v_exp_f32 v220, v220
    v_exp_f32 v221, v221
    v_exp_f32 v222, v222
    v_exp_f32 v223, v223
    v_smfmac_f32_32x32x32_bf16 v[48:63], v[104:107], v[192:199], v112
    v_exp_f32 v16, v16
    v_exp_f32 v17, v17
    v_exp_f32 v18, v18
    v_smfmac_f32_32x32x32_bf16 v[64:79], v[104:107], v[208:215], v112
    s_mov_b64 exec, s[96:97]
    ds_read_b128 v[96:99], v114 offset:47104
    ds_read_b128 v[100:103], v114 offset:47616
    s_mov_b64 exec, -1
    v_exp_f32 v19, v19
    v_exp_f32 v20, v20
    v_exp_f32 v21, v21
    v_smfmac_f32_32x32x32_bf16 v[48:63], v[108:111], v[200:207], v112
    v_exp_f32 v22, v22
    v_exp_f32 v23, v23
    v_exp_f32 v24, v24
    v_smfmac_f32_32x32x32_bf16 v[64:79], v[108:111], v[216:223], v112
    s_waitcnt lgkmcnt(2)
    v_exp_f32 v25, v25
    v_exp_f32 v26, v26
    v_exp_f32 v27, v27
    v_mfma_f32_32x32x16_bf16 v[192:207], v[88:91], v[80:83], 0
    v_exp_f32 v28, v28
    v_exp_f32 v29, v29
    v_exp_f32 v30, v30
    v_mfma_f32_32x32x16_bf16 v[208:223], v[88:91], v[84:87], 0
    s_waitcnt lgkmcnt(0)
    ds_read_b128 v[88:91], v113 offset:43008
    v_exp_f32 v31, v31
    v_exp_f32 v32, v32
    v_exp_f32 v33, v33
    v_exp_f32 v34, v34
    v_exp_f32 v35, v35
    v_exp_f32 v36, v36
    v_exp_f32 v37, v37
    v_exp_f32 v38, v38
    v_exp_f32 v39, v39
    v_exp_f32 v40, v40
    v_exp_f32 v41, v41
    v_exp_f32 v42, v42
    v_exp_f32 v43, v43
    v_exp_f32 v44, v44
    v_exp_f32 v45, v45
    v_exp_f32 v46, v46
    v_exp_f32 v47, v47
    v_smfmac_f32_32x32x32_bf16 v[48:63], v[96:99], v[16:23], v112
    v_exp_f32 v192, v192
    v_exp_f32 v193, v193
    v_exp_f32 v194, v194
    v_smfmac_f32_32x32x32_bf16 v[64:79], v[96:99], v[32:39], v112
    s_mov_b64 exec, s[96:97]
    ds_read_b128 v[104:107], v114 offset:45056
    ds_read_b128 v[108:111], v114 offset:45568
    s_mov_b64 exec, -1
    v_exp_f32 v195, v195
    v_exp_f32 v196, v196
    v_exp_f32 v197, v197
    v_smfmac_f32_32x32x32_bf16 v[48:63], v[100:103], v[24:31], v112
    v_exp_f32 v198, v198
    v_exp_f32 v199, v199
    v_exp_f32 v200, v200
    v_smfmac_f32_32x32x32_bf16 v[64:79], v[100:103], v[40:47], v112
    s_waitcnt lgkmcnt(2)
    v_exp_f32 v201, v201
    v_exp_f32 v202, v202
    v_exp_f32 v203, v203
    v_mfma_f32_32x32x16_bf16 v[16:31], v[88:91], v[80:83], 0
    v_exp_f32 v204, v204
    v_exp_f32 v205, v205
    v_exp_f32 v206, v206
    v_mfma_f32_32x32x16_bf16 v[32:47], v[88:91], v[84:87], 0
    s_waitcnt lgkmcnt(0)
    ds_read_b128 v[88:91], v113 offset:40960
    v_exp_f32 v207, v207
    v_exp_f32 v208, v208
    v_exp_f32 v209, v209
    v_exp_f32 v210, v210
    v_exp_f32 v211, v211
    v_exp_f32 v212, v212
    v_exp_f32 v213, v213
    v_exp_f32 v214, v214
    v_exp_f32 v215, v215
    v_exp_f32 v216, v216
    v_exp_f32 v217, v217
    v_exp_f32 v218, v218
    v_exp_f32 v219, v219
    v_exp_f32 v220, v220
    v_exp_f32 v221, v221
    v_exp_f32 v222, v222
    v_exp_f32 v223, v223
    v_smfmac_f32_32x32x32_bf16 v[48:63], v[104:107], v[192:199], v112
    v_exp_f32 v16, v16
    v_exp_f32 v17, v17
    v_exp_f32 v18, v18
    v_smfmac_f32_32x32x32_bf16 v[64:79], v[104:107], v[208:215], v112
    s_mov_b64 exec, s[96:97]
    ds_read_b128 v[96:99], v114 offset:43008
    ds_read_b128 v[100:103], v114 offset:43520
    s_mov_b64 exec, -1
    v_exp_f32 v19, v19
    v_exp_f32 v20, v20
    v_exp_f32 v21, v21
    v_smfmac_f32_32x32x32_bf16 v[48:63], v[108:111], v[200:207], v112
    v_exp_f32 v22, v22
    v_exp_f32 v23, v23
    v_exp_f32 v24, v24
    v_smfmac_f32_32x32x32_bf16 v[64:79], v[108:111], v[216:223], v112
    s_waitcnt lgkmcnt(2)
    v_exp_f32 v25, v25
    v_exp_f32 v26, v26
    v_exp_f32 v27, v27
    v_mfma_f32_32x32x16_bf16 v[192:207], v[88:91], v[80:83], 0
    v_exp_f32 v28, v28
    v_exp_f32 v29, v29
    v_exp_f32 v30, v30
    v_mfma_f32_32x32x16_bf16 v[208:223], v[88:91], v[84:87], 0
    s_waitcnt lgkmcnt(0)
    ds_read_b128 v[88:91], v113 offset:38912
    v_exp_f32 v31, v31
    v_exp_f32 v32, v32
    v_exp_f32 v33, v33
    v_exp_f32 v34, v34
    v_exp_f32 v35, v35
    v_exp_f32 v36, v36
    v_exp_f32 v37, v37
    s_waitcnt vmcnt(0)
    v_mov_b32 v9, s13
    s_mov_b64 exec, 1
    buffer_store_dword v9, off, s[52:55], s88 sc1
    s_mov_b64 exec, -1
    v_exp_f32 v38, v38
    v_exp_f32 v39, v39
    v_exp_f32 v40, v40
    v_exp_f32 v41, v41
    v_exp_f32 v42, v42
    v_exp_f32 v43, v43
    v_exp_f32 v44, v44
    v_exp_f32 v45, v45
    v_exp_f32 v46, v46
    v_exp_f32 v47, v47
    v_smfmac_f32_32x32x32_bf16 v[48:63], v[96:99], v[16:23], v112
    v_exp_f32 v192, v192
    v_exp_f32 v193, v193
    v_exp_f32 v194, v194
    v_smfmac_f32_32x32x32_bf16 v[64:79], v[96:99], v[32:39], v112
    s_mov_b64 exec, s[96:97]
    ds_read_b128 v[104:107], v114 offset:40960
    ds_read_b128 v[108:111], v114 offset:41472
    s_mov_b64 exec, -1
    v_exp_f32 v195, v195
    v_exp_f32 v196, v196
    v_exp_f32 v197, v197
    v_smfmac_f32_32x32x32_bf16 v[48:63], v[100:103], v[24:31], v112
    v_exp_f32 v198, v198
    v_exp_f32 v199, v199
    v_exp_f32 v200, v200
    v_smfmac_f32_32x32x32_bf16 v[64:79], v[100:103], v[40:47], v112
    s_waitcnt lgkmcnt(2)
    v_exp_f32 v201, v201
    v_exp_f32 v202, v202
    v_exp_f32 v203, v203
    v_mfma_f32_32x32x16_bf16 v[16:31], v[88:91], v[80:83], 0
    v_exp_f32 v204, v204
    v_exp_f32 v205, v205
    v_exp_f32 v206, v206
    v_mfma_f32_32x32x16_bf16 v[32:47], v[88:91], v[84:87], 0
    s_waitcnt lgkmcnt(0)
    ds_read_b128 v[88:91], v113 offset:36864
    v_exp_f32 v207, v207
    v_exp_f32 v208, v208
    v_exp_f32 v209, v209
    v_exp_f32 v210, v210
    v_exp_f32 v211, v211
    v_exp_f32 v212, v212
    v_exp_f32 v213, v213
    v_exp_f32 v214, v214
    v_exp_f32 v215, v215
    v_exp_f32 v216, v216
    v_exp_f32 v217, v217
    v_exp_f32 v218, v218
    v_exp_f32 v219, v219
    v_exp_f32 v220, v220
    v_exp_f32 v221, v221
    v_exp_f32 v222, v222
    v_exp_f32 v223, v223
    v_smfmac_f32_32x32x32_bf16 v[48:63], v[104:107], v[192:199], v112
    v_exp_f32 v16, v16
    v_exp_f32 v17, v17
    v_exp_f32 v18, v18
    v_smfmac_f32_32x32x32_bf16 v[64:79], v[104:107], v[208:215], v112
    s_mov_b64 exec, s[96:97]
    ds_read_b128 v[96:99], v114 offset:38912
    ds_read_b128 v[100:103], v114 offset:39424
    s_mov_b64 exec, -1
    v_exp_f32 v19, v19
    v_exp_f32 v20, v20
    v_exp_f32 v21, v21
    v_smfmac_f32_32x32x32_bf16 v[48:63], v[108:111], v[200:207], v112
    v_exp_f32 v22, v22
    v_exp_f32 v23, v23
    v_exp_f32 v24, v24
    v_smfmac_f32_32x32x32_bf16 v[64:79], v[108:111], v[216:223], v112
    s_waitcnt lgkmcnt(2)
    v_exp_f32 v25, v25
    v_exp_f32 v26, v26
    v_exp_f32 v27, v27
    v_mfma_f32_32x32x16_bf16 v[192:207], v[88:91], v[80:83], 0
    v_exp_f32 v28, v28
    v_exp_f32 v29, v29
    v_exp_f32 v30, v30
    v_mfma_f32_32x32x16_bf16 v[208:223], v[88:91], v[84:87], 0
    s_waitcnt lgkmcnt(0)
    ds_read_b128 v[88:91], v113 offset:34816
    v_exp_f32 v31, v31
    v_exp_f32 v32, v32
    v_exp_f32 v33, v33
    v_exp_f32 v34, v34
    v_exp_f32 v35, v35
    v_exp_f32 v36, v36
    v_exp_f32 v37, v37
    v_exp_f32 v38, v38
    v_exp_f32 v39, v39
    v_exp_f32 v40, v40
    v_exp_f32 v41, v41
    v_exp_f32 v42, v42
    v_exp_f32 v43, v43
    v_exp_f32 v44, v44
    v_exp_f32 v45, v45
    v_exp_f32 v46, v46
    v_exp_f32 v47, v47
    v_smfmac_f32_32x32x32_bf16 v[48:63], v[96:99], v[16:23], v112
    v_exp_f32 v192, v192
    v_exp_f32 v193, v193
    v_exp_f32 v194, v194
    v_smfmac_f32_32x32x32_bf16 v[64:79], v[96:99], v[32:39], v112
    s_mov_b64 exec, s[96:97]
    ds_read_b128 v[104:107], v114 offset:36864
    ds_read_b128 v[108:111], v114 offset:37376
    s_mov_b64 exec, -1
    v_exp_f32 v195, v195
    v_exp_f32 v196, v196
    v_exp_f32 v197, v197
    v_smfmac_f32_32x32x32_bf16 v[48:63], v[100:103], v[24:31], v112
    v_exp_f32 v198, v198
    v_exp_f32 v199, v199
    v_exp_f32 v200, v200
    v_smfmac_f32_32x32x32_bf16 v[64:79], v[100:103], v[40:47], v112
    s_waitcnt lgkmcnt(2)
    v_exp_f32 v201, v201
    v_exp_f32 v202, v202
    v_exp_f32 v203, v203
    v_mfma_f32_32x32x16_bf16 v[16:31], v[88:91], v[80:83], 0
    v_exp_f32 v204, v204
    v_exp_f32 v205, v205
    v_exp_f32 v206, v206
    v_mfma_f32_32x32x16_bf16 v[32:47], v[88:91], v[84:87], 0
    s_waitcnt lgkmcnt(0)
    ds_read_b128 v[88:91], v113 offset:32768
    v_exp_f32 v207, v207
    v_exp_f32 v208, v208
    v_exp_f32 v209, v209
    v_exp_f32 v210, v210
    v_exp_f32 v211, v211
    v_exp_f32 v212, v212
    v_exp_f32 v213, v213
    v_exp_f32 v214, v214
    v_exp_f32 v215, v215
    v_exp_f32 v216, v216
    v_exp_f32 v217, v217
    v_exp_f32 v218, v218
    v_exp_f32 v219, v219
    v_exp_f32 v220, v220
    v_exp_f32 v221, v221
    v_exp_f32 v222, v222
    v_exp_f32 v223, v223
    v_smfmac_f32_32x32x32_bf16 v[48:63], v[104:107], v[192:199], v112
    v_exp_f32 v16, v16
    v_exp_f32 v17, v17
    v_exp_f32 v18, v18
    v_smfmac_f32_32x32x32_bf16 v[64:79], v[104:107], v[208:215], v112
    s_mov_b64 exec, s[96:97]
    ds_read_b128 v[96:99], v114 offset:34816
    ds_read_b128 v[100:103], v114 offset:35328
    s_mov_b64 exec, -1
    v_exp_f32 v19, v19
    v_exp_f32 v20, v20
    v_exp_f32 v21, v21
    v_smfmac_f32_32x32x32_bf16 v[48:63], v[108:111], v[200:207], v112
    v_exp_f32 v22, v22
    v_exp_f32 v23, v23
    v_exp_f32 v24, v24
    v_smfmac_f32_32x32x32_bf16 v[64:79], v[108:111], v[216:223], v112
    s_waitcnt lgkmcnt(2)
    v_exp_f32 v25, v25
    v_exp_f32 v26, v26
    v_exp_f32 v27, v27
    v_mfma_f32_32x32x16_bf16 v[192:207], v[88:91], v[80:83], 0
    v_exp_f32 v28, v28
    v_exp_f32 v29, v29
    v_exp_f32 v30, v30
    v_mfma_f32_32x32x16_bf16 v[208:223], v[88:91], v[84:87], 0
    s_barrier
    s_waitcnt lgkmcnt(0)
    ds_read_b128 v[88:91], v113 offset:30720
    v_exp_f32 v31, v31
    v_exp_f32 v32, v32
    v_exp_f32 v33, v33
    v_exp_f32 v34, v34
    v_exp_f32 v35, v35
    v_exp_f32 v36, v36
    v_exp_f32 v37, v37
    v_exp_f32 v38, v38
    v_exp_f32 v39, v39
    v_exp_f32 v40, v40
    v_exp_f32 v41, v41
    v_exp_f32 v42, v42
    v_exp_f32 v43, v43
    v_exp_f32 v44, v44
    v_exp_f32 v45, v45
    v_exp_f32 v46, v46
    v_exp_f32 v47, v47
    v_smfmac_f32_32x32x32_bf16 v[48:63], v[96:99], v[16:23], v112
    v_exp_f32 v192, v192
    v_exp_f32 v193, v193
    v_exp_f32 v194, v194
    v_smfmac_f32_32x32x32_bf16 v[64:79], v[96:99], v[32:39], v112
    s_mov_b64 exec, s[96:97]
    ds_read_b128 v[104:107], v114 offset:32768
    ds_read_b128 v[108:111], v114 offset:33280
    s_mov_b64 exec, -1
    v_exp_f32 v195, v195
    v_exp_f32 v196, v196
    v_exp_f32 v197, v197
    v_smfmac_f32_32x32x32_bf16 v[48:63], v[100:103], v[24:31], v112
    v_exp_f32 v198, v198
    v_exp_f32 v199, v199
    v_exp_f32 v200, v200
    v_smfmac_f32_32x32x32_bf16 v[64:79], v[100:103], v[40:47], v112
    s_waitcnt lgkmcnt(2)
    v_exp_f32 v201, v201
    v_exp_f32 v202, v202
    v_exp_f32 v203, v203
    v_mfma_f32_32x32x16_bf16 v[16:31], v[88:91], v[80:83], 0
    v_exp_f32 v204, v204
    v_exp_f32 v205, v205
    v_exp_f32 v206, v206
    v_mfma_f32_32x32x16_bf16 v[32:47], v[88:91], v[84:87], 0
    s_waitcnt lgkmcnt(0)
    ds_read_b128 v[88:91], v113 offset:28672
    v_exp_f32 v207, v207
    v_exp_f32 v208, v208
    v_exp_f32 v209, v209
    v_exp_f32 v210, v210
    v_exp_f32 v211, v211
    v_exp_f32 v212, v212
    v_exp_f32 v213, v213
    v_exp_f32 v214, v214
    v_exp_f32 v215, v215
    v_exp_f32 v216, v216
    v_exp_f32 v217, v217
    v_exp_f32 v218, v218
    v_exp_f32 v219, v219
    v_exp_f32 v220, v220
    v_exp_f32 v221, v221
    v_exp_f32 v222, v222
    v_exp_f32 v223, v223
    v_smfmac_f32_32x32x32_bf16 v[48:63], v[104:107], v[192:199], v112
    v_exp_f32 v16, v16
    v_exp_f32 v17, v17
    v_exp_f32 v18, v18
    v_smfmac_f32_32x32x32_bf16 v[64:79], v[104:107], v[208:215], v112
    s_mov_b64 exec, s[96:97]
    ds_read_b128 v[96:99], v114 offset:30720
    ds_read_b128 v[100:103], v114 offset:31232
    s_mov_b64 exec, -1
    v_exp_f32 v19, v19
    v_exp_f32 v20, v20
    v_exp_f32 v21, v21
    v_smfmac_f32_32x32x32_bf16 v[48:63], v[108:111], v[200:207], v112
    v_exp_f32 v22, v22
    v_exp_f32 v23, v23
    v_exp_f32 v24, v24
    v_smfmac_f32_32x32x32_bf16 v[64:79], v[108:111], v[216:223], v112
    s_waitcnt lgkmcnt(2)
    v_exp_f32 v25, v25
    v_exp_f32 v26, v26
    v_exp_f32 v27, v27
    v_mfma_f32_32x32x16_bf16 v[192:207], v[88:91], v[80:83], 0
    v_exp_f32 v28, v28
    v_exp_f32 v29, v29
    v_exp_f32 v30, v30
    v_mfma_f32_32x32x16_bf16 v[208:223], v[88:91], v[84:87], 0
    s_waitcnt lgkmcnt(0)
    ds_read_b128 v[88:91], v113 offset:26624
    v_exp_f32 v31, v31
    v_exp_f32 v32, v32
    v_exp_f32 v33, v33
    v_exp_f32 v34, v34
    v_exp_f32 v35, v35
    v_exp_f32 v36, v36
    v_exp_f32 v37, v37
    v_exp_f32 v38, v38
    v_exp_f32 v39, v39
    v_exp_f32 v40, v40
    v_exp_f32 v41, v41
    v_exp_f32 v42, v42
    v_exp_f32 v43, v43
    v_exp_f32 v44, v44
    v_exp_f32 v45, v45
    v_exp_f32 v46, v46
    v_exp_f32 v47, v47
    v_smfmac_f32_32x32x32_bf16 v[48:63], v[96:99], v[16:23], v112
    v_exp_f32 v192, v192
    v_exp_f32 v193, v193
    v_exp_f32 v194, v194
    v_smfmac_f32_32x32x32_bf16 v[64:79], v[96:99], v[32:39], v112
    s_mov_b64 exec, s[96:97]
    ds_read_b128 v[104:107], v114 offset:28672
    ds_read_b128 v[108:111], v114 offset:29184
    s_mov_b64 exec, -1
    v_exp_f32 v195, v195
    v_exp_f32 v196, v196
    v_exp_f32 v197, v197
    v_smfmac_f32_32x32x32_bf16 v[48:63], v[100:103], v[24:31], v112
    v_exp_f32 v198, v198
    v_exp_f32 v199, v199
    v_exp_f32 v200, v200
    v_smfmac_f32_32x32x32_bf16 v[64:79], v[100:103], v[40:47], v112
    s_waitcnt lgkmcnt(2)
    v_exp_f32 v201, v201
    v_exp_f32 v202, v202
    v_exp_f32 v203, v203
    v_mfma_f32_32x32x16_bf16 v[16:31], v[88:91], v[80:83], 0
    v_exp_f32 v204, v204
    v_exp_f32 v205, v205
    v_exp_f32 v206, v206
    v_mfma_f32_32x32x16_bf16 v[32:47], v[88:91], v[84:87], 0
    s_waitcnt lgkmcnt(0)
    ds_read_b128 v[88:91], v113 offset:24576
    v_exp_f32 v207, v207
    v_exp_f32 v208, v208
    v_exp_f32 v209, v209
    v_exp_f32 v210, v210
    v_exp_f32 v211, v211
    v_exp_f32 v212, v212
    v_exp_f32 v213, v213
    v_exp_f32 v214, v214
    v_exp_f32 v215, v215
    v_exp_f32 v216, v216
    v_exp_f32 v217, v217
    v_exp_f32 v218, v218
    v_exp_f32 v219, v219
    v_exp_f32 v220, v220
    v_exp_f32 v221, v221
    v_exp_f32 v222, v222
    v_exp_f32 v223, v223
    v_smfmac_f32_32x32x32_bf16 v[48:63], v[104:107], v[192:199], v112
    v_exp_f32 v16, v16
    v_exp_f32 v17, v17
    v_exp_f32 v18, v18
    v_smfmac_f32_32x32x32_bf16 v[64:79], v[104:107], v[208:215], v112
    s_mov_b64 exec, s[96:97]
    ds_read_b128 v[96:99], v114 offset:26624
    ds_read_b128 v[100:103], v114 offset:27136
    s_mov_b64 exec, -1
    v_exp_f32 v19, v19
    v_exp_f32 v20, v20
    v_exp_f32 v21, v21
    v_smfmac_f32_32x32x32_bf16 v[48:63], v[108:111], v[200:207], v112
    v_exp_f32 v22, v22
    v_exp_f32 v23, v23
    v_exp_f32 v24, v24
    v_smfmac_f32_32x32x32_bf16 v[64:79], v[108:111], v[216:223], v112
    s_waitcnt lgkmcnt(2)
    v_exp_f32 v25, v25
    v_exp_f32 v26, v26
    v_exp_f32 v27, v27
    v_mfma_f32_32x32x16_bf16 v[192:207], v[88:91], v[80:83], 0
    v_exp_f32 v28, v28
    v_exp_f32 v29, v29
    v_exp_f32 v30, v30
    v_mfma_f32_32x32x16_bf16 v[208:223], v[88:91], v[84:87], 0
    s_waitcnt lgkmcnt(0)
    ds_read_b128 v[88:91], v113 offset:22528
    v_exp_f32 v31, v31
    v_exp_f32 v32, v32
    v_exp_f32 v33, v33
    v_exp_f32 v34, v34
    v_exp_f32 v35, v35
    v_exp_f32 v36, v36
    v_exp_f32 v37, v37
    v_exp_f32 v38, v38
    v_exp_f32 v39, v39
    v_exp_f32 v40, v40
    v_exp_f32 v41, v41
    v_exp_f32 v42, v42
    v_exp_f32 v43, v43
    v_exp_f32 v44, v44
    v_exp_f32 v45, v45
    v_exp_f32 v46, v46
    v_exp_f32 v47, v47
    v_smfmac_f32_32x32x32_bf16 v[48:63], v[96:99], v[16:23], v112
    v_exp_f32 v192, v192
    v_exp_f32 v193, v193
    v_exp_f32 v194, v194
    v_smfmac_f32_32x32x32_bf16 v[64:79], v[96:99], v[32:39], v112
    s_mov_b64 exec, s[96:97]
    ds_read_b128 v[104:107], v114 offset:24576
    ds_read_b128 v[108:111], v114 offset:25088
    s_mov_b64 exec, -1
    v_exp_f32 v195, v195
    v_exp_f32 v196, v196
    v_exp_f32 v197, v197
    v_smfmac_f32_32x32x32_bf16 v[48:63], v[100:103], v[24:31], v112
    v_exp_f32 v198, v198
    v_exp_f32 v199, v199
    v_exp_f32 v200, v200
    v_smfmac_f32_32x32x32_bf16 v[64:79], v[100:103], v[40:47], v112
    s_waitcnt lgkmcnt(2)
    v_exp_f32 v201, v201
    v_exp_f32 v202, v202
    v_exp_f32 v203, v203
    v_mfma_f32_32x32x16_bf16 v[16:31], v[88:91], v[80:83], 0
    v_exp_f32 v204, v204
    v_exp_f32 v205, v205
    v_exp_f32 v206, v206
    v_mfma_f32_32x32x16_bf16 v[32:47], v[88:91], v[84:87], 0
    s_waitcnt lgkmcnt(0)
    ds_read_b128 v[88:91], v113 offset:20480
    v_exp_f32 v207, v207
    v_exp_f32 v208, v208
    v_exp_f32 v209, v209
    v_exp_f32 v210, v210
    v_exp_f32 v211, v211
    v_exp_f32 v212, v212
    v_exp_f32 v213, v213
    v_exp_f32 v214, v214
    v_exp_f32 v215, v215
    v_exp_f32 v216, v216
    v_exp_f32 v217, v217
    v_exp_f32 v218, v218
    v_exp_f32 v219, v219
    v_exp_f32 v220, v220
    v_exp_f32 v221, v221
    v_exp_f32 v222, v222
    v_exp_f32 v223, v223
    v_smfmac_f32_32x32x32_bf16 v[48:63], v[104:107], v[192:199], v112
    v_exp_f32 v16, v16
    v_exp_f32 v17, v17
    v_exp_f32 v18, v18
    v_smfmac_f32_32x32x32_bf16 v[64:79], v[104:107], v[208:215], v112
    s_mov_b64 exec, s[96:97]
    ds_read_b128 v[96:99], v114 offset:22528
    ds_read_b128 v[100:103], v114 offset:23040
    s_mov_b64 exec, -1
    v_exp_f32 v19, v19
    v_exp_f32 v20, v20
    v_exp_f32 v21, v21
    v_smfmac_f32_32x32x32_bf16 v[48:63], v[108:111], v[200:207], v112
    v_exp_f32 v22, v22
    v_exp_f32 v23, v23
    v_exp_f32 v24, v24
    v_smfmac_f32_32x32x32_bf16 v[64:79], v[108:111], v[216:223], v112
    s_waitcnt lgkmcnt(2)
    v_exp_f32 v25, v25
    v_exp_f32 v26, v26
    v_exp_f32 v27, v27
    v_mfma_f32_32x32x16_bf16 v[192:207], v[88:91], v[80:83], 0
    v_exp_f32 v28, v28
    v_exp_f32 v29, v29
    v_exp_f32 v30, v30
    v_mfma_f32_32x32x16_bf16 v[208:223], v[88:91], v[84:87], 0
    s_waitcnt lgkmcnt(0)
    ds_read_b128 v[88:91], v113 offset:18432
    v_exp_f32 v31, v31
    v_exp_f32 v32, v32
    v_exp_f32 v33, v33
    v_exp_f32 v34, v34
    v_exp_f32 v35, v35
    v_exp_f32 v36, v36
    v_exp_f32 v37, v37
    v_exp_f32 v38, v38
    v_exp_f32 v39, v39
    v_exp_f32 v40, v40
    v_exp_f32 v41, v41
    v_exp_f32 v42, v42
    v_exp_f32 v43, v43
    v_exp_f32 v44, v44
    v_exp_f32 v45, v45
    v_exp_f32 v46, v46
    v_exp_f32 v47, v47
    v_smfmac_f32_32x32x32_bf16 v[48:63], v[96:99], v[16:23], v112
    v_exp_f32 v192, v192
    v_exp_f32 v193, v193
    v_exp_f32 v194, v194
    v_smfmac_f32_32x32x32_bf16 v[64:79], v[96:99], v[32:39], v112
    s_mov_b64 exec, s[96:97]
    ds_read_b128 v[104:107], v114 offset:20480
    ds_read_b128 v[108:111], v114 offset:20992
    s_mov_b64 exec, -1
    v_exp_f32 v195, v195
    v_exp_f32 v196, v196
    v_exp_f32 v197, v197
    v_smfmac_f32_32x32x32_bf16 v[48:63], v[100:103], v[24:31], v112
    v_exp_f32 v198, v198
    v_exp_f32 v199, v199
    v_exp_f32 v200, v200
    v_smfmac_f32_32x32x32_bf16 v[64:79], v[100:103], v[40:47], v112
    s_waitcnt lgkmcnt(2)
    v_exp_f32 v201, v201
    v_exp_f32 v202, v202
    v_exp_f32 v203, v203
    v_mfma_f32_32x32x16_bf16 v[16:31], v[88:91], v[80:83], 0
    v_exp_f32 v204, v204
    v_exp_f32 v205, v205
    v_exp_f32 v206, v206
    v_mfma_f32_32x32x16_bf16 v[32:47], v[88:91], v[84:87], 0
    s_waitcnt lgkmcnt(0)
    ds_read_b128 v[88:91], v113 offset:16384
    v_exp_f32 v207, v207
    v_exp_f32 v208, v208
    v_exp_f32 v209, v209
    v_exp_f32 v210, v210
    v_exp_f32 v211, v211
    v_exp_f32 v212, v212
    v_exp_f32 v213, v213
    v_exp_f32 v214, v214
    v_exp_f32 v215, v215
    v_exp_f32 v216, v216
    v_exp_f32 v217, v217
    v_exp_f32 v218, v218
    v_exp_f32 v219, v219
    v_exp_f32 v220, v220
    v_exp_f32 v221, v221
    v_exp_f32 v222, v222
    v_exp_f32 v223, v223
    v_smfmac_f32_32x32x32_bf16 v[48:63], v[104:107], v[192:199], v112
    v_exp_f32 v16, v16
    v_exp_f32 v17, v17
    v_exp_f32 v18, v18
    v_smfmac_f32_32x32x32_bf16 v[64:79], v[104:107], v[208:215], v112
    s_mov_b64 exec, s[96:97]
    ds_read_b128 v[96:99], v114 offset:18432
    ds_read_b128 v[100:103], v114 offset:18944
    s_mov_b64 exec, -1
    v_exp_f32 v19, v19
    v_exp_f32 v20, v20
    v_exp_f32 v21, v21
    v_smfmac_f32_32x32x32_bf16 v[48:63], v[108:111], v[200:207], v112
    v_exp_f32 v22, v22
    v_exp_f32 v23, v23
    v_exp_f32 v24, v24
    v_smfmac_f32_32x32x32_bf16 v[64:79], v[108:111], v[216:223], v112
    s_waitcnt lgkmcnt(2)
    v_exp_f32 v25, v25
    v_exp_f32 v26, v26
    v_exp_f32 v27, v27
    v_mfma_f32_32x32x16_bf16 v[192:207], v[88:91], v[80:83], 0
    v_exp_f32 v28, v28
    v_exp_f32 v29, v29
    v_exp_f32 v30, v30
    v_mfma_f32_32x32x16_bf16 v[208:223], v[88:91], v[84:87], 0
    s_waitcnt lgkmcnt(0)
    ds_read_b128 v[88:91], v113 offset:14336
    v_exp_f32 v31, v31
    v_exp_f32 v32, v32
    v_exp_f32 v33, v33
    v_exp_f32 v34, v34
    v_exp_f32 v35, v35
    v_exp_f32 v36, v36
    v_exp_f32 v37, v37
    v_exp_f32 v38, v38
    v_exp_f32 v39, v39
    v_exp_f32 v40, v40
    v_exp_f32 v41, v41
    v_exp_f32 v42, v42
    v_exp_f32 v43, v43
    v_exp_f32 v44, v44
    v_exp_f32 v45, v45
    v_exp_f32 v46, v46
    v_exp_f32 v47, v47
    v_smfmac_f32_32x32x32_bf16 v[48:63], v[96:99], v[16:23], v112
    v_exp_f32 v192, v192
    v_exp_f32 v193, v193
    v_exp_f32 v194, v194
    v_smfmac_f32_32x32x32_bf16 v[64:79], v[96:99], v[32:39], v112
    s_mov_b64 exec, s[96:97]
    ds_read_b128 v[104:107], v114 offset:16384
    ds_read_b128 v[108:111], v114 offset:16896
    s_mov_b64 exec, -1
    v_exp_f32 v195, v195
    v_exp_f32 v196, v196
    v_exp_f32 v197, v197
    v_smfmac_f32_32x32x32_bf16 v[48:63], v[100:103], v[24:31], v112
    v_exp_f32 v198, v198
    v_exp_f32 v199, v199
    v_exp_f32 v200, v200
    v_smfmac_f32_32x32x32_bf16 v[64:79], v[100:103], v[40:47], v112
    s_waitcnt lgkmcnt(2)
    v_exp_f32 v201, v201
    v_exp_f32 v202, v202
    v_exp_f32 v203, v203
    v_mfma_f32_32x32x16_bf16 v[16:31], v[88:91], v[80:83], 0
    v_exp_f32 v204, v204
    v_exp_f32 v205, v205
    v_exp_f32 v206, v206
    v_mfma_f32_32x32x16_bf16 v[32:47], v[88:91], v[84:87], 0
    s_waitcnt lgkmcnt(0)
    ds_read_b128 v[88:91], v113 offset:12288
    v_exp_f32 v207, v207
    v_exp_f32 v208, v208
    v_exp_f32 v209, v209
    v_exp_f32 v210, v210
    v_exp_f32 v211, v211
    v_exp_f32 v212, v212
    v_exp_f32 v213, v213
    v_exp_f32 v214, v214
    v_exp_f32 v215, v215
    v_exp_f32 v216, v216
    v_exp_f32 v217, v217
    v_exp_f32 v218, v218
    v_exp_f32 v219, v219
    v_exp_f32 v220, v220
    v_exp_f32 v221, v221
    v_exp_f32 v222, v222
    v_exp_f32 v223, v223
    v_smfmac_f32_32x32x32_bf16 v[48:63], v[104:107], v[192:199], v112
    v_exp_f32 v16, v16
    v_exp_f32 v17, v17
    v_exp_f32 v18, v18
    v_smfmac_f32_32x32x32_bf16 v[64:79], v[104:107], v[208:215], v112
    s_mov_b64 exec, s[96:97]
    ds_read_b128 v[96:99], v114 offset:14336
    ds_read_b128 v[100:103], v114 offset:14848
    s_mov_b64 exec, -1
    v_exp_f32 v19, v19
    v_exp_f32 v20, v20
    v_exp_f32 v21, v21
    v_smfmac_f32_32x32x32_bf16 v[48:63], v[108:111], v[200:207], v112
    v_exp_f32 v22, v22
    v_exp_f32 v23, v23
    v_exp_f32 v24, v24
    v_smfmac_f32_32x32x32_bf16 v[64:79], v[108:111], v[216:223], v112
    s_waitcnt lgkmcnt(2)
    v_exp_f32 v25, v25
    v_exp_f32 v26, v26
    v_exp_f32 v27, v27
    v_mfma_f32_32x32x16_bf16 v[192:207], v[88:91], v[80:83], 0
    v_exp_f32 v28, v28
    v_exp_f32 v29, v29
    v_exp_f32 v30, v30
    v_mfma_f32_32x32x16_bf16 v[208:223], v[88:91], v[84:87], 0
    s_waitcnt lgkmcnt(0)
    ds_read_b128 v[88:91], v113 offset:10240
    v_exp_f32 v31, v31
    v_exp_f32 v32, v32
    v_exp_f32 v33, v33
    v_exp_f32 v34, v34
    v_exp_f32 v35, v35
    v_exp_f32 v36, v36
    v_exp_f32 v37, v37
    v_exp_f32 v38, v38
    v_exp_f32 v39, v39
    v_exp_f32 v40, v40
    v_exp_f32 v41, v41
    v_exp_f32 v42, v42
    v_exp_f32 v43, v43
    v_exp_f32 v44, v44
    v_exp_f32 v45, v45
    v_exp_f32 v46, v46
    v_exp_f32 v47, v47
    v_smfmac_f32_32x32x32_bf16 v[48:63], v[96:99], v[16:23], v112
    v_exp_f32 v192, v192
    v_exp_f32 v193, v193
    v_exp_f32 v194, v194
    v_smfmac_f32_32x32x32_bf16 v[64:79], v[96:99], v[32:39], v112
    s_mov_b64 exec, s[96:97]
    ds_read_b128 v[104:107], v114 offset:12288
    ds_read_b128 v[108:111], v114 offset:12800
    s_mov_b64 exec, -1
    v_exp_f32 v195, v195
    v_exp_f32 v196, v196
    v_exp_f32 v197, v197
    v_smfmac_f32_32x32x32_bf16 v[48:63], v[100:103], v[24:31], v112
    v_exp_f32 v198, v198
    v_exp_f32 v199, v199
    v_exp_f32 v200, v200
    v_smfmac_f32_32x32x32_bf16 v[64:79], v[100:103], v[40:47], v112
    s_waitcnt lgkmcnt(2)
    v_exp_f32 v201, v201
    v_exp_f32 v202, v202
    v_exp_f32 v203, v203
    v_mfma_f32_32x32x16_bf16 v[16:31], v[88:91], v[80:83], 0
    v_exp_f32 v204, v204
    v_exp_f32 v205, v205
    v_exp_f32 v206, v206
    v_mfma_f32_32x32x16_bf16 v[32:47], v[88:91], v[84:87], 0
    s_waitcnt lgkmcnt(0)
    ds_read_b128 v[88:91], v113 offset:8192
    v_exp_f32 v207, v207
    v_exp_f32 v208, v208
    v_exp_f32 v209, v209
    v_exp_f32 v210, v210
    v_exp_f32 v211, v211
    v_exp_f32 v212, v212
    v_exp_f32 v213, v213
    v_exp_f32 v214, v214
    v_exp_f32 v215, v215
    v_exp_f32 v216, v216
    v_exp_f32 v217, v217
    v_exp_f32 v218, v218
    v_exp_f32 v219, v219
    v_exp_f32 v220, v220
    v_exp_f32 v221, v221
    v_exp_f32 v222, v222
    v_exp_f32 v223, v223
    v_smfmac_f32_32x32x32_bf16 v[48:63], v[104:107], v[192:199], v112
    v_exp_f32 v16, v16
    v_exp_f32 v17, v17
    v_exp_f32 v18, v18
    v_smfmac_f32_32x32x32_bf16 v[64:79], v[104:107], v[208:215], v112
    s_mov_b64 exec, s[96:97]
    ds_read_b128 v[96:99], v114 offset:10240
    ds_read_b128 v[100:103], v114 offset:10752
    s_mov_b64 exec, -1
    v_exp_f32 v19, v19
    v_exp_f32 v20, v20
    v_exp_f32 v21, v21
    v_smfmac_f32_32x32x32_bf16 v[48:63], v[108:111], v[200:207], v112
    v_exp_f32 v22, v22
    v_exp_f32 v23, v23
    v_exp_f32 v24, v24
    v_smfmac_f32_32x32x32_bf16 v[64:79], v[108:111], v[216:223], v112
    s_waitcnt lgkmcnt(2)
    v_exp_f32 v25, v25
    v_exp_f32 v26, v26
    v_exp_f32 v27, v27
    v_mfma_f32_32x32x16_bf16 v[192:207], v[88:91], v[80:83], 0
    v_exp_f32 v28, v28
    v_exp_f32 v29, v29
    v_exp_f32 v30, v30
    v_mfma_f32_32x32x16_bf16 v[208:223], v[88:91], v[84:87], 0
    s_waitcnt lgkmcnt(0)
    ds_read_b128 v[88:91], v113 offset:6144
    v_exp_f32 v31, v31
    v_exp_f32 v32, v32
    v_exp_f32 v33, v33
    v_exp_f32 v34, v34
    v_exp_f32 v35, v35
    v_exp_f32 v36, v36
    v_exp_f32 v37, v37
    v_exp_f32 v38, v38
    v_exp_f32 v39, v39
    v_exp_f32 v40, v40
    v_exp_f32 v41, v41
    v_exp_f32 v42, v42
    v_exp_f32 v43, v43
    v_exp_f32 v44, v44
    v_exp_f32 v45, v45
    v_exp_f32 v46, v46
    v_exp_f32 v47, v47
    v_smfmac_f32_32x32x32_bf16 v[48:63], v[96:99], v[16:23], v112
    v_exp_f32 v192, v192
    v_exp_f32 v193, v193
    v_exp_f32 v194, v194
    v_smfmac_f32_32x32x32_bf16 v[64:79], v[96:99], v[32:39], v112
    s_mov_b64 exec, s[96:97]
    ds_read_b128 v[104:107], v114 offset:8192
    ds_read_b128 v[108:111], v114 offset:8704
    s_mov_b64 exec, -1
    v_exp_f32 v195, v195
    v_exp_f32 v196, v196
    v_exp_f32 v197, v197
    v_smfmac_f32_32x32x32_bf16 v[48:63], v[100:103], v[24:31], v112
    v_exp_f32 v198, v198
    v_exp_f32 v199, v199
    v_exp_f32 v200, v200
    v_smfmac_f32_32x32x32_bf16 v[64:79], v[100:103], v[40:47], v112
    s_waitcnt lgkmcnt(2)
    v_exp_f32 v201, v201
    v_exp_f32 v202, v202
    v_exp_f32 v203, v203
    v_mfma_f32_32x32x16_bf16 v[16:31], v[88:91], v[80:83], 0
    v_exp_f32 v204, v204
    v_exp_f32 v205, v205
    v_exp_f32 v206, v206
    v_mfma_f32_32x32x16_bf16 v[32:47], v[88:91], v[84:87], 0
    s_waitcnt lgkmcnt(0)
    ds_read_b128 v[88:91], v113 offset:4096
    v_exp_f32 v207, v207
    v_exp_f32 v208, v208
    v_exp_f32 v209, v209
    v_exp_f32 v210, v210
    v_exp_f32 v211, v211
    v_exp_f32 v212, v212
    v_exp_f32 v213, v213
    v_exp_f32 v214, v214
    v_exp_f32 v215, v215
    v_exp_f32 v216, v216
    v_exp_f32 v217, v217
    v_exp_f32 v218, v218
    v_exp_f32 v219, v219
    v_exp_f32 v220, v220
    v_exp_f32 v221, v221
    v_exp_f32 v222, v222
    v_exp_f32 v223, v223
    v_smfmac_f32_32x32x32_bf16 v[48:63], v[104:107], v[192:199], v112
    v_exp_f32 v16, v16
    v_exp_f32 v17, v17
    v_exp_f32 v18, v18
    v_smfmac_f32_32x32x32_bf16 v[64:79], v[104:107], v[208:215], v112
    s_mov_b64 exec, s[96:97]
    ds_read_b128 v[96:99], v114 offset:6144
    ds_read_b128 v[100:103], v114 offset:6656
    s_mov_b64 exec, -1
    v_exp_f32 v19, v19
    v_exp_f32 v20, v20
    v_exp_f32 v21, v21
    v_smfmac_f32_32x32x32_bf16 v[48:63], v[108:111], v[200:207], v112
    v_exp_f32 v22, v22
    v_exp_f32 v23, v23
    v_exp_f32 v24, v24
    v_smfmac_f32_32x32x32_bf16 v[64:79], v[108:111], v[216:223], v112
    s_waitcnt lgkmcnt(2)
    v_exp_f32 v25, v25
    v_exp_f32 v26, v26
    v_exp_f32 v27, v27
    v_mfma_f32_32x32x16_bf16 v[192:207], v[88:91], v[80:83], 0
    v_exp_f32 v28, v28
    v_exp_f32 v29, v29
    v_exp_f32 v30, v30
    v_mfma_f32_32x32x16_bf16 v[208:223], v[88:91], v[84:87], 0
    s_waitcnt lgkmcnt(0)
    ds_read_b128 v[88:91], v113 offset:2048
    v_exp_f32 v31, v31
    v_exp_f32 v32, v32
    v_exp_f32 v33, v33
    v_exp_f32 v34, v34
    v_exp_f32 v35, v35
    v_exp_f32 v36, v36
    v_exp_f32 v37, v37
    v_exp_f32 v38, v38
    v_exp_f32 v39, v39
    v_exp_f32 v40, v40
    v_exp_f32 v41, v41
    v_exp_f32 v42, v42
    v_exp_f32 v43, v43
    v_exp_f32 v44, v44
    v_exp_f32 v45, v45
    v_exp_f32 v46, v46
    v_exp_f32 v47, v47
    v_smfmac_f32_32x32x32_bf16 v[48:63], v[96:99], v[16:23], v112
    v_exp_f32 v192, v192
    v_exp_f32 v193, v193
    v_exp_f32 v194, v194
    v_smfmac_f32_32x32x32_bf16 v[64:79], v[96:99], v[32:39], v112
    s_mov_b64 exec, s[96:97]
    ds_read_b128 v[104:107], v114 offset:4096
    ds_read_b128 v[108:111], v114 offset:4608
    s_mov_b64 exec, -1
    v_exp_f32 v195, v195
    v_exp_f32 v196, v196
    v_exp_f32 v197, v197
    v_smfmac_f32_32x32x32_bf16 v[48:63], v[100:103], v[24:31], v112
    v_exp_f32 v198, v198
    v_exp_f32 v199, v199
    v_exp_f32 v200, v200
    v_smfmac_f32_32x32x32_bf16 v[64:79], v[100:103], v[40:47], v112
    s_waitcnt lgkmcnt(2)
    v_exp_f32 v201, v201
    v_exp_f32 v202, v202
    v_exp_f32 v203, v203
    v_mfma_f32_32x32x16_bf16 v[16:31], v[88:91], v[80:83], 0
    v_exp_f32 v204, v204
    v_exp_f32 v205, v205
    v_exp_f32 v206, v206
    v_mfma_f32_32x32x16_bf16 v[32:47], v[88:91], v[84:87], 0
    s_waitcnt lgkmcnt(0)
    ds_read_b128 v[88:91], v113 offset:0
    v_exp_f32 v207, v207
    v_exp_f32 v208, v208
    v_exp_f32 v209, v209
    v_exp_f32 v210, v210
    v_exp_f32 v211, v211
    v_exp_f32 v212, v212
    v_exp_f32 v213, v213
    v_exp_f32 v214, v214
    v_exp_f32 v215, v215
    v_exp_f32 v216, v216
    v_exp_f32 v217, v217
    v_exp_f32 v218, v218
    v_exp_f32 v219, v219
    v_add_u32 v113, 0xffff0000, v113
    v_exp_f32 v220, v220
    v_exp_f32 v221, v221
    v_exp_f32 v222, v222
    v_exp_f32 v223, v223
    v_smfmac_f32_32x32x32_bf16 v[48:63], v[104:107], v[192:199], v112
    v_exp_f32 v16, v16
    v_exp_f32 v17, v17
    v_exp_f32 v18, v18
    v_smfmac_f32_32x32x32_bf16 v[64:79], v[104:107], v[208:215], v112
    s_mov_b64 exec, s[96:97]
    ds_read_b128 v[96:99], v114 offset:2048
    ds_read_b128 v[100:103], v114 offset:2560
    s_mov_b64 exec, -1
    v_exp_f32 v19, v19
    v_exp_f32 v20, v20
    v_exp_f32 v21, v21
    v_smfmac_f32_32x32x32_bf16 v[48:63], v[108:111], v[200:207], v112
    v_exp_f32 v22, v22
    v_exp_f32 v23, v23
    v_exp_f32 v24, v24
    v_smfmac_f32_32x32x32_bf16 v[64:79], v[108:111], v[216:223], v112
    s_waitcnt lgkmcnt(2)
    v_exp_f32 v25, v25
    v_exp_f32 v26, v26
    v_exp_f32 v27, v27
    v_mfma_f32_32x32x16_bf16 v[192:207], v[88:91], v[80:83], 0
    v_exp_f32 v28, v28
    v_exp_f32 v29, v29
    v_exp_f32 v30, v30
    v_mfma_f32_32x32x16_bf16 v[208:223], v[88:91], v[84:87], 0
    s_waitcnt lgkmcnt(0)
    ds_read_b128 v[88:91], v113 offset:63488
    v_exp_f32 v31, v31
    v_exp_f32 v32, v32
    v_exp_f32 v33, v33
    v_exp_f32 v34, v34
    v_exp_f32 v35, v35
    v_exp_f32 v36, v36
    v_exp_f32 v37, v37
    v_exp_f32 v38, v38
    v_exp_f32 v39, v39
    v_exp_f32 v40, v40
    v_exp_f32 v41, v41
    v_exp_f32 v42, v42
    v_exp_f32 v43, v43
    v_exp_f32 v44, v44
    v_exp_f32 v45, v45
    v_exp_f32 v46, v46
    v_exp_f32 v47, v47
    v_smfmac_f32_32x32x32_bf16 v[48:63], v[96:99], v[16:23], v112
    v_exp_f32 v192, v192
    v_exp_f32 v193, v193
    v_exp_f32 v194, v194
    v_smfmac_f32_32x32x32_bf16 v[64:79], v[96:99], v[32:39], v112
    s_mov_b64 exec, s[96:97]
    ds_read_b128 v[104:107], v114 offset:0
    ds_read_b128 v[108:111], v114 offset:512
    s_mov_b64 exec, -1
    v_exp_f32 v195, v195
    v_exp_f32 v196, v196
    v_exp_f32 v197, v197
    v_smfmac_f32_32x32x32_bf16 v[48:63], v[100:103], v[24:31], v112
    v_exp_f32 v198, v198
    v_exp_f32 v199, v199
    v_exp_f32 v200, v200
    v_smfmac_f32_32x32x32_bf16 v[64:79], v[100:103], v[40:47], v112
    s_waitcnt lgkmcnt(2)
    v_exp_f32 v201, v201
    v_exp_f32 v202, v202
    v_exp_f32 v203, v203
    v_mfma_f32_32x32x16_bf16 v[16:31], v[88:91], v[80:83], 0
    v_exp_f32 v204, v204
    v_exp_f32 v205, v205
    v_exp_f32 v206, v206
    v_mfma_f32_32x32x16_bf16 v[32:47], v[88:91], v[84:87], 0
    s_waitcnt lgkmcnt(0)
    ds_read_b128 v[88:91], v113 offset:61440
    v_exp_f32 v207, v207
    v_exp_f32 v208, v208
    v_exp_f32 v209, v209
    v_exp_f32 v210, v210
    v_exp_f32 v211, v211
    v_exp_f32 v212, v212
    v_exp_f32 v213, v213
    v_exp_f32 v214, v214
    v_exp_f32 v215, v215
    v_exp_f32 v216, v216
    v_exp_f32 v217, v217
    v_exp_f32 v218, v218
    v_exp_f32 v219, v219
    v_add_u32 v114, 0xffff0000, v114
    v_exp_f32 v220, v220
    v_exp_f32 v221, v221
    v_exp_f32 v222, v222
    v_exp_f32 v223, v223
    v_smfmac_f32_32x32x32_bf16 v[48:63], v[104:107], v[192:199], v112
    v_exp_f32 v16, v16
    v_exp_f32 v17, v17
    v_exp_f32 v18, v18
    v_smfmac_f32_32x32x32_bf16 v[64:79], v[104:107], v[208:215], v112
    s_mov_b64 exec, s[96:97]
    ds_read_b128 v[96:99], v114 offset:63488
    ds_read_b128 v[100:103], v114 offset:64000
    s_mov_b64 exec, -1
    v_exp_f32 v19, v19
    v_exp_f32 v20, v20
    v_exp_f32 v21, v21
    v_smfmac_f32_32x32x32_bf16 v[48:63], v[108:111], v[200:207], v112
    v_exp_f32 v22, v22
    v_exp_f32 v23, v23
    v_exp_f32 v24, v24
    v_smfmac_f32_32x32x32_bf16 v[64:79], v[108:111], v[216:223], v112
    s_waitcnt lgkmcnt(2)
    v_exp_f32 v25, v25
    v_exp_f32 v26, v26
    v_exp_f32 v27, v27
    v_mfma_f32_32x32x16_bf16 v[192:207], v[88:91], v[80:83], 0
    v_exp_f32 v28, v28
    v_exp_f32 v29, v29
    v_exp_f32 v30, v30
    v_mfma_f32_32x32x16_bf16 v[208:223], v[88:91], v[84:87], 0
    s_waitcnt lgkmcnt(0)
    ds_read_b128 v[88:91], v113 offset:59392
    v_exp_f32 v31, v31
    v_exp_f32 v32, v32
    v_exp_f32 v33, v33
    v_exp_f32 v34, v34
    v_exp_f32 v35, v35
    v_exp_f32 v36, v36
    v_exp_f32 v37, v37
    v_exp_f32 v38, v38
    v_exp_f32 v39, v39
    v_exp_f32 v40, v40
    v_exp_f32 v41, v41
    v_exp_f32 v42, v42
    v_exp_f32 v43, v43
    v_exp_f32 v44, v44
    v_exp_f32 v45, v45
    v_exp_f32 v46, v46
    v_exp_f32 v47, v47
    v_smfmac_f32_32x32x32_bf16 v[48:63], v[96:99], v[16:23], v112
    v_exp_f32 v192, v192
    v_exp_f32 v193, v193
    v_exp_f32 v194, v194
    v_smfmac_f32_32x32x32_bf16 v[64:79], v[96:99], v[32:39], v112
    s_mov_b64 exec, s[96:97]
    ds_read_b128 v[104:107], v114 offset:61440
    ds_read_b128 v[108:111], v114 offset:61952
    s_mov_b64 exec, -1
    v_exp_f32 v195, v195
    v_exp_f32 v196, v196
    v_exp_f32 v197, v197
    v_smfmac_f32_32x32x32_bf16 v[48:63], v[100:103], v[24:31], v112
    v_exp_f32 v198, v198
    v_exp_f32 v199, v199
    v_exp_f32 v200, v200
    v_smfmac_f32_32x32x32_bf16 v[64:79], v[100:103], v[40:47], v112
    s_waitcnt lgkmcnt(2)
    v_exp_f32 v201, v201
    v_exp_f32 v202, v202
    v_exp_f32 v203, v203
    v_mfma_f32_32x32x16_bf16 v[16:31], v[88:91], v[80:83], 0
    v_exp_f32 v204, v204
    v_exp_f32 v205, v205
    v_exp_f32 v206, v206
    v_mfma_f32_32x32x16_bf16 v[32:47], v[88:91], v[84:87], 0
    s_waitcnt lgkmcnt(0)
    ds_read_b128 v[88:91], v113 offset:57344
    v_exp_f32 v207, v207
    v_exp_f32 v208, v208
    v_exp_f32 v209, v209
    v_exp_f32 v210, v210
    v_exp_f32 v211, v211
    v_exp_f32 v212, v212
    v_exp_f32 v213, v213
    v_exp_f32 v214, v214
    v_exp_f32 v215, v215
    v_exp_f32 v216, v216
    v_exp_f32 v217, v217
    v_exp_f32 v218, v218
    v_exp_f32 v219, v219
    v_exp_f32 v220, v220
    v_exp_f32 v221, v221
    v_exp_f32 v222, v222
    v_exp_f32 v223, v223
    v_smfmac_f32_32x32x32_bf16 v[48:63], v[104:107], v[192:199], v112
    v_exp_f32 v16, v16
    v_exp_f32 v17, v17
    v_exp_f32 v18, v18
    v_smfmac_f32_32x32x32_bf16 v[64:79], v[104:107], v[208:215], v112
    s_mov_b64 exec, s[96:97]
    ds_read_b128 v[96:99], v114 offset:59392
    ds_read_b128 v[100:103], v114 offset:59904
    s_mov_b64 exec, -1
    v_exp_f32 v19, v19
    v_exp_f32 v20, v20
    v_exp_f32 v21, v21
    v_smfmac_f32_32x32x32_bf16 v[48:63], v[108:111], v[200:207], v112
    v_exp_f32 v22, v22
    v_exp_f32 v23, v23
    v_exp_f32 v24, v24
    v_smfmac_f32_32x32x32_bf16 v[64:79], v[108:111], v[216:223], v112
    s_waitcnt lgkmcnt(2)
    v_exp_f32 v25, v25
    v_exp_f32 v26, v26
    v_exp_f32 v27, v27
    v_mfma_f32_32x32x16_bf16 v[192:207], v[88:91], v[80:83], 0
    v_exp_f32 v28, v28
    v_exp_f32 v29, v29
    v_exp_f32 v30, v30
    v_mfma_f32_32x32x16_bf16 v[208:223], v[88:91], v[84:87], 0
    s_waitcnt lgkmcnt(0)
    ds_read_b128 v[88:91], v113 offset:55296
    v_exp_f32 v31, v31
    v_exp_f32 v32, v32
    v_exp_f32 v33, v33
    v_exp_f32 v34, v34
    v_exp_f32 v35, v35
    v_exp_f32 v36, v36
    v_exp_f32 v37, v37
    v_exp_f32 v38, v38
    v_exp_f32 v39, v39
    v_exp_f32 v40, v40
    v_exp_f32 v41, v41
    v_exp_f32 v42, v42
    v_exp_f32 v43, v43
    v_exp_f32 v44, v44
    v_exp_f32 v45, v45
    v_exp_f32 v46, v46
    v_exp_f32 v47, v47
    v_smfmac_f32_32x32x32_bf16 v[48:63], v[96:99], v[16:23], v112
    v_exp_f32 v192, v192
    v_exp_f32 v193, v193
    v_exp_f32 v194, v194
    v_smfmac_f32_32x32x32_bf16 v[64:79], v[96:99], v[32:39], v112
    s_mov_b64 exec, s[96:97]
    ds_read_b128 v[104:107], v114 offset:57344
    ds_read_b128 v[108:111], v114 offset:57856
    s_mov_b64 exec, -1
    v_exp_f32 v195, v195
    v_exp_f32 v196, v196
    v_exp_f32 v197, v197
    v_smfmac_f32_32x32x32_bf16 v[48:63], v[100:103], v[24:31], v112
    v_exp_f32 v198, v198
    v_exp_f32 v199, v199
    v_exp_f32 v200, v200
    v_smfmac_f32_32x32x32_bf16 v[64:79], v[100:103], v[40:47], v112
    s_waitcnt lgkmcnt(2)
    v_exp_f32 v201, v201
    v_exp_f32 v202, v202
    v_exp_f32 v203, v203
    v_mfma_f32_32x32x16_bf16 v[16:31], v[88:91], v[80:83], 0
    v_exp_f32 v204, v204
    v_exp_f32 v205, v205
    v_exp_f32 v206, v206
    v_mfma_f32_32x32x16_bf16 v[32:47], v[88:91], v[84:87], 0
    s_waitcnt lgkmcnt(0)
    ds_read_b128 v[88:91], v113 offset:53248
    v_exp_f32 v207, v207
    v_exp_f32 v208, v208
    v_exp_f32 v209, v209
    v_exp_f32 v210, v210
    v_exp_f32 v211, v211
    v_exp_f32 v212, v212
    v_exp_f32 v213, v213
    v_exp_f32 v214, v214
    v_exp_f32 v215, v215
    v_exp_f32 v216, v216
    v_exp_f32 v217, v217
    v_exp_f32 v218, v218
    v_exp_f32 v219, v219
    v_exp_f32 v220, v220
    v_exp_f32 v221, v221
    v_exp_f32 v222, v222
    v_exp_f32 v223, v223
    v_smfmac_f32_32x32x32_bf16 v[48:63], v[104:107], v[192:199], v112
    v_exp_f32 v16, v16
    v_exp_f32 v17, v17
    v_exp_f32 v18, v18
    v_smfmac_f32_32x32x32_bf16 v[64:79], v[104:107], v[208:215], v112
    s_mov_b64 exec, s[96:97]
    ds_read_b128 v[96:99], v114 offset:55296
    ds_read_b128 v[100:103], v114 offset:55808
    s_mov_b64 exec, -1
    v_exp_f32 v19, v19
    v_exp_f32 v20, v20
    v_exp_f32 v21, v21
    v_smfmac_f32_32x32x32_bf16 v[48:63], v[108:111], v[200:207], v112
    v_exp_f32 v22, v22
    v_exp_f32 v23, v23
    v_exp_f32 v24, v24
    v_smfmac_f32_32x32x32_bf16 v[64:79], v[108:111], v[216:223], v112
    s_waitcnt lgkmcnt(2)
    v_exp_f32 v25, v25
    v_exp_f32 v26, v26
    v_exp_f32 v27, v27
    v_mfma_f32_32x32x16_bf16 v[192:207], v[88:91], v[80:83], 0
    v_exp_f32 v28, v28
    v_exp_f32 v29, v29
    v_exp_f32 v30, v30
    v_mfma_f32_32x32x16_bf16 v[208:223], v[88:91], v[84:87], 0
    s_waitcnt lgkmcnt(0)
    ds_read_b128 v[88:91], v113 offset:51200
    v_exp_f32 v31, v31
    v_exp_f32 v32, v32
    v_exp_f32 v33, v33
    v_exp_f32 v34, v34
    v_exp_f32 v35, v35
    v_exp_f32 v36, v36
    v_exp_f32 v37, v37
    v_exp_f32 v38, v38
    v_exp_f32 v39, v39
    v_exp_f32 v40, v40
    v_exp_f32 v41, v41
    v_exp_f32 v42, v42
    v_exp_f32 v43, v43
    v_exp_f32 v44, v44
    v_exp_f32 v45, v45
    v_exp_f32 v46, v46
    v_exp_f32 v47, v47
    v_smfmac_f32_32x32x32_bf16 v[48:63], v[96:99], v[16:23], v112
    v_exp_f32 v192, v192
    v_exp_f32 v193, v193
    v_exp_f32 v194, v194
    v_smfmac_f32_32x32x32_bf16 v[64:79], v[96:99], v[32:39], v112
    s_mov_b64 exec, s[96:97]
    ds_read_b128 v[104:107], v114 offset:53248
    ds_read_b128 v[108:111], v114 offset:53760
    s_mov_b64 exec, -1
    v_exp_f32 v195, v195
    v_exp_f32 v196, v196
    v_exp_f32 v197, v197
    v_smfmac_f32_32x32x32_bf16 v[48:63], v[100:103], v[24:31], v112
    v_exp_f32 v198, v198
    v_exp_f32 v199, v199
    v_exp_f32 v200, v200
    v_smfmac_f32_32x32x32_bf16 v[64:79], v[100:103], v[40:47], v112
    s_waitcnt lgkmcnt(2)
    v_exp_f32 v201, v201
    v_exp_f32 v202, v202
    v_exp_f32 v203, v203
    v_mfma_f32_32x32x16_bf16 v[16:31], v[88:91], v[80:83], 0
    v_exp_f32 v204, v204
    v_exp_f32 v205, v205
    v_exp_f32 v206, v206
    v_mfma_f32_32x32x16_bf16 v[32:47], v[88:91], v[84:87], 0
    s_waitcnt lgkmcnt(0)
    ds_read_b128 v[88:91], v113 offset:49152
    v_exp_f32 v207, v207
    v_exp_f32 v208, v208
    v_exp_f32 v209, v209
    v_exp_f32 v210, v210
    v_exp_f32 v211, v211
    v_exp_f32 v212, v212
    v_exp_f32 v213, v213
    v_exp_f32 v214, v214
    v_exp_f32 v215, v215
    v_exp_f32 v216, v216
    v_exp_f32 v217, v217
    v_exp_f32 v218, v218
    v_exp_f32 v219, v219
    v_exp_f32 v220, v220
    v_exp_f32 v221, v221
    v_exp_f32 v222, v222
    v_exp_f32 v223, v223
    v_smfmac_f32_32x32x32_bf16 v[48:63], v[104:107], v[192:199], v112
    v_exp_f32 v16, v16
    v_exp_f32 v17, v17
    v_exp_f32 v18, v18
    v_smfmac_f32_32x32x32_bf16 v[64:79], v[104:107], v[208:215], v112
    s_mov_b64 exec, s[96:97]
    ds_read_b128 v[96:99], v114 offset:51200
    ds_read_b128 v[100:103], v114 offset:51712
    s_mov_b64 exec, -1
    v_exp_f32 v19, v19
    v_exp_f32 v20, v20
    v_exp_f32 v21, v21
    v_smfmac_f32_32x32x32_bf16 v[48:63], v[108:111], v[200:207], v112
    v_exp_f32 v22, v22
    v_exp_f32 v23, v23
    v_exp_f32 v24, v24
    v_smfmac_f32_32x32x32_bf16 v[64:79], v[108:111], v[216:223], v112
    s_waitcnt lgkmcnt(2)
    v_exp_f32 v25, v25
    v_exp_f32 v26, v26
    v_exp_f32 v27, v27
    v_mfma_f32_32x32x16_bf16 v[192:207], v[88:91], v[80:83], 0
    v_exp_f32 v28, v28
    v_exp_f32 v29, v29
    v_exp_f32 v30, v30
    v_mfma_f32_32x32x16_bf16 v[208:223], v[88:91], v[84:87], 0
    s_waitcnt lgkmcnt(0)
    ds_read_b128 v[88:91], v113 offset:47104
    v_exp_f32 v31, v31
    v_exp_f32 v32, v32
    v_exp_f32 v33, v33
    v_exp_f32 v34, v34
    v_exp_f32 v35, v35
    v_exp_f32 v36, v36
    v_exp_f32 v37, v37
    v_exp_f32 v38, v38
    v_exp_f32 v39, v39
    v_exp_f32 v40, v40
    v_exp_f32 v41, v41
    v_exp_f32 v42, v42
    v_exp_f32 v43, v43
    v_exp_f32 v44, v44
    v_exp_f32 v45, v45
    v_exp_f32 v46, v46
    v_exp_f32 v47, v47
    v_smfmac_f32_32x32x32_bf16 v[48:63], v[96:99], v[16:23], v112
    v_exp_f32 v192, v192
    v_exp_f32 v193, v193
    v_exp_f32 v194, v194
    v_smfmac_f32_32x32x32_bf16 v[64:79], v[96:99], v[32:39], v112
    s_mov_b64 exec, s[96:97]
    ds_read_b128 v[104:107], v114 offset:49152
    ds_read_b128 v[108:111], v114 offset:49664
    s_mov_b64 exec, -1
    v_exp_f32 v195, v195
    v_exp_f32 v196, v196
    v_exp_f32 v197, v197
    v_smfmac_f32_32x32x32_bf16 v[48:63], v[100:103], v[24:31], v112
    v_exp_f32 v198, v198
    v_exp_f32 v199, v199
    v_exp_f32 v200, v200
    v_smfmac_f32_32x32x32_bf16 v[64:79], v[100:103], v[40:47], v112
    s_waitcnt lgkmcnt(2)
    v_exp_f32 v201, v201
    v_exp_f32 v202, v202
    v_exp_f32 v203, v203
    v_mfma_f32_32x32x16_bf16 v[16:31], v[88:91], v[80:83], 0
    v_exp_f32 v204, v204
    v_exp_f32 v205, v205
    v_exp_f32 v206, v206
    v_mfma_f32_32x32x16_bf16 v[32:47], v[88:91], v[84:87], 0
    s_waitcnt lgkmcnt(0)
    ds_read_b128 v[88:91], v113 offset:45056
    v_exp_f32 v207, v207
    v_exp_f32 v208, v208
    v_exp_f32 v209, v209
    v_exp_f32 v210, v210
    v_exp_f32 v211, v211
    v_exp_f32 v212, v212
    v_exp_f32 v213, v213
    v_exp_f32 v214, v214
    v_exp_f32 v215, v215
    v_exp_f32 v216, v216
    v_exp_f32 v217, v217
    v_exp_f32 v218, v218
    v_exp_f32 v219, v219
    v_exp_f32 v220, v220
    v_exp_f32 v221, v221
    v_exp_f32 v222, v222
    v_exp_f32 v223, v223
    v_smfmac_f32_32x32x32_bf16 v[48:63], v[104:107], v[192:199], v112
    v_exp_f32 v16, v16
    v_exp_f32 v17, v17
    v_exp_f32 v18, v18
    v_smfmac_f32_32x32x32_bf16 v[64:79], v[104:107], v[208:215], v112
    s_mov_b64 exec, s[96:97]
    ds_read_b128 v[96:99], v114 offset:47104
    ds_read_b128 v[100:103], v114 offset:47616
    s_mov_b64 exec, -1
    v_exp_f32 v19, v19
    v_exp_f32 v20, v20
    v_exp_f32 v21, v21
    v_smfmac_f32_32x32x32_bf16 v[48:63], v[108:111], v[200:207], v112
    v_exp_f32 v22, v22
    v_exp_f32 v23, v23
    v_exp_f32 v24, v24
    v_smfmac_f32_32x32x32_bf16 v[64:79], v[108:111], v[216:223], v112
    s_waitcnt lgkmcnt(2)
    v_exp_f32 v25, v25
    v_exp_f32 v26, v26
    v_exp_f32 v27, v27
    v_mfma_f32_32x32x16_bf16 v[192:207], v[88:91], v[80:83], 0
    v_exp_f32 v28, v28
    v_exp_f32 v29, v29
    v_exp_f32 v30, v30
    v_mfma_f32_32x32x16_bf16 v[208:223], v[88:91], v[84:87], 0
    s_waitcnt lgkmcnt(0)
    ds_read_b128 v[88:91], v113 offset:43008
    v_exp_f32 v31, v31
    v_exp_f32 v32, v32
    v_exp_f32 v33, v33
    v_exp_f32 v34, v34
    v_exp_f32 v35, v35
    v_exp_f32 v36, v36
    v_exp_f32 v37, v37
    v_exp_f32 v38, v38
    v_exp_f32 v39, v39
    v_exp_f32 v40, v40
    v_exp_f32 v41, v41
    v_exp_f32 v42, v42
    v_exp_f32 v43, v43
    v_exp_f32 v44, v44
    v_exp_f32 v45, v45
    v_exp_f32 v46, v46
    v_exp_f32 v47, v47
    v_smfmac_f32_32x32x32_bf16 v[48:63], v[96:99], v[16:23], v112
    v_exp_f32 v192, v192
    v_exp_f32 v193, v193
    v_exp_f32 v194, v194
    v_smfmac_f32_32x32x32_bf16 v[64:79], v[96:99], v[32:39], v112
    s_mov_b64 exec, s[96:97]
    ds_read_b128 v[104:107], v114 offset:45056
    ds_read_b128 v[108:111], v114 offset:45568
    s_mov_b64 exec, -1
    v_exp_f32 v195, v195
    v_exp_f32 v196, v196
    v_exp_f32 v197, v197
    v_smfmac_f32_32x32x32_bf16 v[48:63], v[100:103], v[24:31], v112
    v_exp_f32 v198, v198
    v_exp_f32 v199, v199
    v_exp_f32 v200, v200
    v_smfmac_f32_32x32x32_bf16 v[64:79], v[100:103], v[40:47], v112
    s_waitcnt lgkmcnt(2)
    v_exp_f32 v201, v201
    v_exp_f32 v202, v202
    v_exp_f32 v203, v203
    v_mfma_f32_32x32x16_bf16 v[16:31], v[88:91], v[80:83], 0
    v_exp_f32 v204, v204
    v_exp_f32 v205, v205
    v_exp_f32 v206, v206
    v_mfma_f32_32x32x16_bf16 v[32:47], v[88:91], v[84:87], 0
    s_waitcnt lgkmcnt(0)
    ds_read_b128 v[88:91], v113 offset:40960
    v_exp_f32 v207, v207
    v_exp_f32 v208, v208
    v_exp_f32 v209, v209
    v_exp_f32 v210, v210
    v_exp_f32 v211, v211
    v_exp_f32 v212, v212
    v_exp_f32 v213, v213
    v_exp_f32 v214, v214
    v_exp_f32 v215, v215
    v_exp_f32 v216, v216
    v_exp_f32 v217, v217
    v_exp_f32 v218, v218
    v_exp_f32 v219, v219
    v_exp_f32 v220, v220
    v_exp_f32 v221, v221
    v_exp_f32 v222, v222
    v_exp_f32 v223, v223
    v_smfmac_f32_32x32x32_bf16 v[48:63], v[104:107], v[192:199], v112
    v_exp_f32 v16, v16
    v_exp_f32 v17, v17
    v_exp_f32 v18, v18
    v_smfmac_f32_32x32x32_bf16 v[64:79], v[104:107], v[208:215], v112
    s_mov_b64 exec, s[96:97]
    ds_read_b128 v[96:99], v114 offset:43008
    ds_read_b128 v[100:103], v114 offset:43520
    s_mov_b64 exec, -1
    v_exp_f32 v19, v19
    v_exp_f32 v20, v20
    v_exp_f32 v21, v21
    v_smfmac_f32_32x32x32_bf16 v[48:63], v[108:111], v[200:207], v112
    v_exp_f32 v22, v22
    v_exp_f32 v23, v23
    v_exp_f32 v24, v24
    v_smfmac_f32_32x32x32_bf16 v[64:79], v[108:111], v[216:223], v112
    s_waitcnt lgkmcnt(2)
    v_exp_f32 v25, v25
    v_exp_f32 v26, v26
    v_exp_f32 v27, v27
    v_mfma_f32_32x32x16_bf16 v[192:207], v[88:91], v[80:83], 0
    v_exp_f32 v28, v28
    v_exp_f32 v29, v29
    v_exp_f32 v30, v30
    v_mfma_f32_32x32x16_bf16 v[208:223], v[88:91], v[84:87], 0
    s_waitcnt lgkmcnt(0)
    ds_read_b128 v[88:91], v113 offset:38912
    v_exp_f32 v31, v31
    v_exp_f32 v32, v32
    v_exp_f32 v33, v33
    v_exp_f32 v34, v34
    v_exp_f32 v35, v35
    v_exp_f32 v36, v36
    v_exp_f32 v37, v37
    v_exp_f32 v38, v38
    v_exp_f32 v39, v39
    v_exp_f32 v40, v40
    v_exp_f32 v41, v41
    v_exp_f32 v42, v42
    v_exp_f32 v43, v43
    v_exp_f32 v44, v44
    v_exp_f32 v45, v45
    v_exp_f32 v46, v46
    v_exp_f32 v47, v47
    v_smfmac_f32_32x32x32_bf16 v[48:63], v[96:99], v[16:23], v112
    v_exp_f32 v192, v192
    v_exp_f32 v193, v193
    v_exp_f32 v194, v194
    v_smfmac_f32_32x32x32_bf16 v[64:79], v[96:99], v[32:39], v112
    s_mov_b64 exec, s[96:97]
    ds_read_b128 v[104:107], v114 offset:40960
    ds_read_b128 v[108:111], v114 offset:41472
    s_mov_b64 exec, -1
    v_exp_f32 v195, v195
    v_exp_f32 v196, v196
    v_exp_f32 v197, v197
    v_smfmac_f32_32x32x32_bf16 v[48:63], v[100:103], v[24:31], v112
    v_exp_f32 v198, v198
    v_exp_f32 v199, v199
    v_exp_f32 v200, v200
    v_smfmac_f32_32x32x32_bf16 v[64:79], v[100:103], v[40:47], v112
    s_waitcnt lgkmcnt(2)
    v_exp_f32 v201, v201
    v_exp_f32 v202, v202
    v_exp_f32 v203, v203
    v_mfma_f32_32x32x16_bf16 v[16:31], v[88:91], v[80:83], 0
    v_exp_f32 v204, v204
    v_exp_f32 v205, v205
    v_exp_f32 v206, v206
    v_mfma_f32_32x32x16_bf16 v[32:47], v[88:91], v[84:87], 0
    s_waitcnt lgkmcnt(0)
    ds_read_b128 v[88:91], v113 offset:36864
    v_exp_f32 v207, v207
    v_exp_f32 v208, v208
    v_exp_f32 v209, v209
    v_exp_f32 v210, v210
    v_exp_f32 v211, v211
    v_exp_f32 v212, v212
    v_exp_f32 v213, v213
    v_exp_f32 v214, v214
    v_exp_f32 v215, v215
    v_exp_f32 v216, v216
    v_exp_f32 v217, v217
    v_exp_f32 v218, v218
    v_exp_f32 v219, v219
    v_exp_f32 v220, v220
    v_exp_f32 v221, v221
    v_exp_f32 v222, v222
    v_exp_f32 v223, v223
    v_smfmac_f32_32x32x32_bf16 v[48:63], v[104:107], v[192:199], v112
    v_exp_f32 v16, v16
    v_exp_f32 v17, v17
    v_exp_f32 v18, v18
    v_smfmac_f32_32x32x32_bf16 v[64:79], v[104:107], v[208:215], v112
    s_mov_b64 exec, s[96:97]
    ds_read_b128 v[96:99], v114 offset:38912
    ds_read_b128 v[100:103], v114 offset:39424
    s_mov_b64 exec, -1
    v_exp_f32 v19, v19
    v_exp_f32 v20, v20
    v_exp_f32 v21, v21
    v_smfmac_f32_32x32x32_bf16 v[48:63], v[108:111], v[200:207], v112
    v_exp_f32 v22, v22
    v_exp_f32 v23, v23
    v_exp_f32 v24, v24
    v_smfmac_f32_32x32x32_bf16 v[64:79], v[108:111], v[216:223], v112
    s_waitcnt lgkmcnt(2)
    v_exp_f32 v25, v25
    v_exp_f32 v26, v26
    v_exp_f32 v27, v27
    v_mfma_f32_32x32x16_bf16 v[192:207], v[88:91], v[80:83], 0
    v_exp_f32 v28, v28
    v_exp_f32 v29, v29
    v_exp_f32 v30, v30
    v_mfma_f32_32x32x16_bf16 v[208:223], v[88:91], v[84:87], 0
    s_waitcnt lgkmcnt(0)
    ds_read_b128 v[88:91], v113 offset:34816
    v_exp_f32 v31, v31
    v_exp_f32 v32, v32
    v_exp_f32 v33, v33
    v_exp_f32 v34, v34
    v_exp_f32 v35, v35
    v_exp_f32 v36, v36
    v_exp_f32 v37, v37
    v_exp_f32 v38, v38
    v_exp_f32 v39, v39
    v_exp_f32 v40, v40
    v_exp_f32 v41, v41
    v_exp_f32 v42, v42
    v_exp_f32 v43, v43
    v_exp_f32 v44, v44
    v_exp_f32 v45, v45
    v_exp_f32 v46, v46
    v_exp_f32 v47, v47
    v_smfmac_f32_32x32x32_bf16 v[48:63], v[96:99], v[16:23], v112
    v_exp_f32 v192, v192
    v_exp_f32 v193, v193
    v_exp_f32 v194, v194
    v_smfmac_f32_32x32x32_bf16 v[64:79], v[96:99], v[32:39], v112
    s_mov_b64 exec, s[96:97]
    ds_read_b128 v[104:107], v114 offset:36864
    ds_read_b128 v[108:111], v114 offset:37376
    s_mov_b64 exec, -1
    v_exp_f32 v195, v195
    v_exp_f32 v196, v196
    v_exp_f32 v197, v197
    v_smfmac_f32_32x32x32_bf16 v[48:63], v[100:103], v[24:31], v112
    v_exp_f32 v198, v198
    v_exp_f32 v199, v199
    v_exp_f32 v200, v200
    v_smfmac_f32_32x32x32_bf16 v[64:79], v[100:103], v[40:47], v112
    s_waitcnt lgkmcnt(2)
    v_exp_f32 v201, v201
    v_exp_f32 v202, v202
    v_exp_f32 v203, v203
    v_mfma_f32_32x32x16_bf16 v[16:31], v[88:91], v[80:83], 0
    v_exp_f32 v204, v204
    v_exp_f32 v205, v205
    v_exp_f32 v206, v206
    v_mfma_f32_32x32x16_bf16 v[32:47], v[88:91], v[84:87], 0
    s_waitcnt lgkmcnt(0)
    ds_read_b128 v[88:91], v113 offset:32768
    v_exp_f32 v207, v207
    v_exp_f32 v208, v208
    v_exp_f32 v209, v209
    v_exp_f32 v210, v210
    v_exp_f32 v211, v211
    v_exp_f32 v212, v212
    v_exp_f32 v213, v213
    v_exp_f32 v214, v214
    v_exp_f32 v215, v215
    v_exp_f32 v216, v216
    v_exp_f32 v217, v217
    v_exp_f32 v218, v218
    v_exp_f32 v219, v219
    v_exp_f32 v220, v220
    v_exp_f32 v221, v221
    v_exp_f32 v222, v222
    v_exp_f32 v223, v223
    v_smfmac_f32_32x32x32_bf16 v[48:63], v[104:107], v[192:199], v112
    v_exp_f32 v16, v16
    v_exp_f32 v17, v17
    v_exp_f32 v18, v18
    v_smfmac_f32_32x32x32_bf16 v[64:79], v[104:107], v[208:215], v112
    s_mov_b64 exec, s[96:97]
    ds_read_b128 v[96:99], v114 offset:34816
    ds_read_b128 v[100:103], v114 offset:35328
    s_mov_b64 exec, -1
    v_exp_f32 v19, v19
    v_exp_f32 v20, v20
    v_exp_f32 v21, v21
    v_smfmac_f32_32x32x32_bf16 v[48:63], v[108:111], v[200:207], v112
    v_exp_f32 v22, v22
    v_exp_f32 v23, v23
    v_exp_f32 v24, v24
    v_smfmac_f32_32x32x32_bf16 v[64:79], v[108:111], v[216:223], v112
    s_waitcnt lgkmcnt(2)
    v_exp_f32 v25, v25
    v_exp_f32 v26, v26
    v_exp_f32 v27, v27
    v_mfma_f32_32x32x16_bf16 v[192:207], v[88:91], v[80:83], 0
    v_exp_f32 v28, v28
    v_exp_f32 v29, v29
    v_exp_f32 v30, v30
    v_mfma_f32_32x32x16_bf16 v[208:223], v[88:91], v[84:87], 0
    s_waitcnt lgkmcnt(0)
    ds_read_b128 v[88:91], v113 offset:30720
    v_exp_f32 v31, v31
    v_exp_f32 v32, v32
    v_exp_f32 v33, v33
    v_exp_f32 v34, v34
    v_exp_f32 v35, v35
    v_exp_f32 v36, v36
    v_exp_f32 v37, v37
    v_exp_f32 v38, v38
    v_exp_f32 v39, v39
    v_exp_f32 v40, v40
    v_exp_f32 v41, v41
    v_exp_f32 v42, v42
    v_exp_f32 v43, v43
    v_exp_f32 v44, v44
    v_exp_f32 v45, v45
    v_exp_f32 v46, v46
    v_exp_f32 v47, v47
    v_smfmac_f32_32x32x32_bf16 v[48:63], v[96:99], v[16:23], v112
    v_exp_f32 v192, v192
    v_exp_f32 v193, v193
    v_exp_f32 v194, v194
    v_smfmac_f32_32x32x32_bf16 v[64:79], v[96:99], v[32:39], v112
    s_mov_b64 exec, s[96:97]
    ds_read_b128 v[104:107], v114 offset:32768
    ds_read_b128 v[108:111], v114 offset:33280
    s_mov_b64 exec, -1
    v_exp_f32 v195, v195
    v_exp_f32 v196, v196
    v_exp_f32 v197, v197
    v_smfmac_f32_32x32x32_bf16 v[48:63], v[100:103], v[24:31], v112
    v_exp_f32 v198, v198
    v_exp_f32 v199, v199
    v_exp_f32 v200, v200
    v_smfmac_f32_32x32x32_bf16 v[64:79], v[100:103], v[40:47], v112
    s_waitcnt lgkmcnt(2)
    v_exp_f32 v201, v201
    v_exp_f32 v202, v202
    v_exp_f32 v203, v203
    v_mfma_f32_32x32x16_bf16 v[16:31], v[88:91], v[80:83], 0
    v_exp_f32 v204, v204
    v_exp_f32 v205, v205
    v_exp_f32 v206, v206
    v_mfma_f32_32x32x16_bf16 v[32:47], v[88:91], v[84:87], 0
    s_waitcnt lgkmcnt(0)
    ds_read_b128 v[88:91], v113 offset:28672
    v_exp_f32 v207, v207
    v_exp_f32 v208, v208
    v_exp_f32 v209, v209
    v_exp_f32 v210, v210
    v_exp_f32 v211, v211
    v_exp_f32 v212, v212
    v_exp_f32 v213, v213
    buffer_load_dword v117, v115, s[52:55], 0 offen sc1
    v_exp_f32 v214, v214
    v_exp_f32 v215, v215
    v_exp_f32 v216, v216
    v_exp_f32 v217, v217
    v_exp_f32 v218, v218
    v_exp_f32 v219, v219
    v_exp_f32 v220, v220
    v_exp_f32 v221, v221
    v_exp_f32 v222, v222
    v_exp_f32 v223, v223
    v_smfmac_f32_32x32x32_bf16 v[48:63], v[104:107], v[192:199], v112
    v_exp_f32 v16, v16
    v_exp_f32 v17, v17
    v_exp_f32 v18, v18
    v_smfmac_f32_32x32x32_bf16 v[64:79], v[104:107], v[208:215], v112
    s_mov_b64 exec, s[96:97]
    ds_read_b128 v[96:99], v114 offset:30720
    ds_read_b128 v[100:103], v114 offset:31232
    s_mov_b64 exec, -1
    v_exp_f32 v19, v19
    v_exp_f32 v20, v20
    v_exp_f32 v21, v21
    v_smfmac_f32_32x32x32_bf16 v[48:63], v[108:111], v[200:207], v112
    v_exp_f32 v22, v22
    v_exp_f32 v23, v23
    v_exp_f32 v24, v24
    v_smfmac_f32_32x32x32_bf16 v[64:79], v[108:111], v[216:223], v112
    s_waitcnt lgkmcnt(2)
    v_exp_f32 v25, v25
    v_exp_f32 v26, v26
    v_exp_f32 v27, v27
    v_mfma_f32_32x32x16_bf16 v[192:207], v[88:91], v[80:83], 0
    v_exp_f32 v28, v28
    v_exp_f32 v29, v29
    v_exp_f32 v30, v30
    v_mfma_f32_32x32x16_bf16 v[208:223], v[88:91], v[84:87], 0
    s_waitcnt lgkmcnt(0)
    ds_read_b128 v[88:91], v113 offset:26624
    v_exp_f32 v31, v31
    v_exp_f32 v32, v32
    v_exp_f32 v33, v33
    v_exp_f32 v34, v34
    v_exp_f32 v35, v35
    v_exp_f32 v36, v36
    v_exp_f32 v37, v37
    v_exp_f32 v38, v38
    v_exp_f32 v39, v39
    v_exp_f32 v40, v40
    v_exp_f32 v41, v41
    v_exp_f32 v42, v42
    v_exp_f32 v43, v43
    v_exp_f32 v44, v44
    v_exp_f32 v45, v45
    v_exp_f32 v46, v46
    v_exp_f32 v47, v47
    v_smfmac_f32_32x32x32_bf16 v[48:63], v[96:99], v[16:23], v112
    v_exp_f32 v192, v192
    v_exp_f32 v193, v193
    v_exp_f32 v194, v194
    v_smfmac_f32_32x32x32_bf16 v[64:79], v[96:99], v[32:39], v112
    s_mov_b64 exec, s[96:97]
    ds_read_b128 v[104:107], v114 offset:28672
    ds_read_b128 v[108:111], v114 offset:29184
    s_mov_b64 exec, -1
    v_exp_f32 v195, v195
    v_exp_f32 v196, v196
    v_exp_f32 v197, v197
    v_smfmac_f32_32x32x32_bf16 v[48:63], v[100:103], v[24:31], v112
    v_exp_f32 v198, v198
    v_exp_f32 v199, v199
    v_exp_f32 v200, v200
    v_smfmac_f32_32x32x32_bf16 v[64:79], v[100:103], v[40:47], v112
    s_waitcnt lgkmcnt(2)
    v_exp_f32 v201, v201
    v_exp_f32 v202, v202
    v_exp_f32 v203, v203
    v_mfma_f32_32x32x16_bf16 v[16:31], v[88:91], v[80:83], 0
    v_exp_f32 v204, v204
    v_exp_f32 v205, v205
    v_exp_f32 v206, v206
    v_mfma_f32_32x32x16_bf16 v[32:47], v[88:91], v[84:87], 0
    s_waitcnt lgkmcnt(0)
    ds_read_b128 v[88:91], v113 offset:24576
    v_exp_f32 v207, v207
    v_exp_f32 v208, v208
    v_exp_f32 v209, v209
    v_exp_f32 v210, v210
    v_exp_f32 v211, v211
    v_exp_f32 v212, v212
    v_exp_f32 v213, v213
    v_exp_f32 v214, v214
    v_exp_f32 v215, v215
    v_exp_f32 v216, v216
    v_exp_f32 v217, v217
    v_exp_f32 v218, v218
    v_exp_f32 v219, v219
    v_exp_f32 v220, v220
    v_exp_f32 v221, v221
    v_exp_f32 v222, v222
    v_exp_f32 v223, v223
    v_smfmac_f32_32x32x32_bf16 v[48:63], v[104:107], v[192:199], v112
    v_exp_f32 v16, v16
    v_exp_f32 v17, v17
    v_exp_f32 v18, v18
    v_smfmac_f32_32x32x32_bf16 v[64:79], v[104:107], v[208:215], v112
    s_mov_b64 exec, s[96:97]
    ds_read_b128 v[96:99], v114 offset:26624
    ds_read_b128 v[100:103], v114 offset:27136
    s_mov_b64 exec, -1
    v_exp_f32 v19, v19
    v_exp_f32 v20, v20
    v_exp_f32 v21, v21
    v_smfmac_f32_32x32x32_bf16 v[48:63], v[108:111], v[200:207], v112
    v_exp_f32 v22, v22
    v_exp_f32 v23, v23
    v_exp_f32 v24, v24
    v_smfmac_f32_32x32x32_bf16 v[64:79], v[108:111], v[216:223], v112
    s_waitcnt lgkmcnt(2)
    v_exp_f32 v25, v25
    v_exp_f32 v26, v26
    v_exp_f32 v27, v27
    v_mfma_f32_32x32x16_bf16 v[192:207], v[88:91], v[80:83], 0
    v_exp_f32 v28, v28
    v_exp_f32 v29, v29
    v_exp_f32 v30, v30
    v_mfma_f32_32x32x16_bf16 v[208:223], v[88:91], v[84:87], 0
    s_waitcnt lgkmcnt(0)
    ds_read_b128 v[88:91], v113 offset:22528
    v_exp_f32 v31, v31
    v_exp_f32 v32, v32
    v_exp_f32 v33, v33
    v_exp_f32 v34, v34
    v_exp_f32 v35, v35
    v_exp_f32 v36, v36
    v_exp_f32 v37, v37
    v_exp_f32 v38, v38
    v_exp_f32 v39, v39
    v_exp_f32 v40, v40
    v_exp_f32 v41, v41
    v_exp_f32 v42, v42
    v_exp_f32 v43, v43
    v_exp_f32 v44, v44
    v_exp_f32 v45, v45
    v_exp_f32 v46, v46
    v_exp_f32 v47, v47
    v_smfmac_f32_32x32x32_bf16 v[48:63], v[96:99], v[16:23], v112
    v_exp_f32 v192, v192
    v_exp_f32 v193, v193
    v_exp_f32 v194, v194
    v_smfmac_f32_32x32x32_bf16 v[64:79], v[96:99], v[32:39], v112
    s_mov_b64 exec, s[96:97]
    ds_read_b128 v[104:107], v114 offset:24576
    ds_read_b128 v[108:111], v114 offset:25088
    s_mov_b64 exec, -1
    v_exp_f32 v195, v195
    v_exp_f32 v196, v196
    v_exp_f32 v197, v197
    v_smfmac_f32_32x32x32_bf16 v[48:63], v[100:103], v[24:31], v112
    v_exp_f32 v198, v198
    v_exp_f32 v199, v199
    v_exp_f32 v200, v200
    v_smfmac_f32_32x32x32_bf16 v[64:79], v[100:103], v[40:47], v112
    s_waitcnt lgkmcnt(2)
    v_exp_f32 v201, v201
    v_exp_f32 v202, v202
    v_exp_f32 v203, v203
    v_mfma_f32_32x32x16_bf16 v[16:31], v[88:91], v[80:83], 0
    v_exp_f32 v204, v204
    v_exp_f32 v205, v205
    v_exp_f32 v206, v206
    v_mfma_f32_32x32x16_bf16 v[32:47], v[88:91], v[84:87], 0
    s_waitcnt lgkmcnt(0)
    ds_read_b128 v[88:91], v113 offset:20480
    v_exp_f32 v207, v207
    v_exp_f32 v208, v208
    v_exp_f32 v209, v209
    v_exp_f32 v210, v210
    v_exp_f32 v211, v211
    v_exp_f32 v212, v212
    v_exp_f32 v213, v213
    v_exp_f32 v214, v214
    v_exp_f32 v215, v215
    v_exp_f32 v216, v216
    v_exp_f32 v217, v217
    v_exp_f32 v218, v218
    v_exp_f32 v219, v219
    v_exp_f32 v220, v220
    v_exp_f32 v221, v221
    v_exp_f32 v222, v222
    v_exp_f32 v223, v223
    v_smfmac_f32_32x32x32_bf16 v[48:63], v[104:107], v[192:199], v112
    v_exp_f32 v16, v16
    v_exp_f32 v17, v17
    v_exp_f32 v18, v18
    v_smfmac_f32_32x32x32_bf16 v[64:79], v[104:107], v[208:215], v112
    s_mov_b64 exec, s[96:97]
    ds_read_b128 v[96:99], v114 offset:22528
    ds_read_b128 v[100:103], v114 offset:23040
    s_mov_b64 exec, -1
    v_exp_f32 v19, v19
    v_exp_f32 v20, v20
    v_exp_f32 v21, v21
    v_smfmac_f32_32x32x32_bf16 v[48:63], v[108:111], v[200:207], v112
    v_exp_f32 v22, v22
    v_exp_f32 v23, v23
    v_exp_f32 v24, v24
    v_smfmac_f32_32x32x32_bf16 v[64:79], v[108:111], v[216:223], v112
    s_waitcnt lgkmcnt(2)
    v_exp_f32 v25, v25
    v_exp_f32 v26, v26
    v_exp_f32 v27, v27
    v_mfma_f32_32x32x16_bf16 v[192:207], v[88:91], v[80:83], 0
    v_exp_f32 v28, v28
    v_exp_f32 v29, v29
    v_exp_f32 v30, v30
    v_mfma_f32_32x32x16_bf16 v[208:223], v[88:91], v[84:87], 0
    s_waitcnt lgkmcnt(0)
    ds_read_b128 v[88:91], v113 offset:18432
    v_exp_f32 v31, v31
    v_exp_f32 v32, v32
    v_exp_f32 v33, v33
    v_exp_f32 v34, v34
    v_exp_f32 v35, v35
    v_exp_f32 v36, v36
    v_exp_f32 v37, v37
    v_exp_f32 v38, v38
    v_exp_f32 v39, v39
    v_exp_f32 v40, v40
    v_exp_f32 v41, v41
    v_exp_f32 v42, v42
    v_exp_f32 v43, v43
    v_exp_f32 v44, v44
    v_exp_f32 v45, v45
    v_exp_f32 v46, v46
    v_exp_f32 v47, v47
    v_smfmac_f32_32x32x32_bf16 v[48:63], v[96:99], v[16:23], v112
    v_exp_f32 v192, v192
    v_exp_f32 v193, v193
    v_exp_f32 v194, v194
    v_smfmac_f32_32x32x32_bf16 v[64:79], v[96:99], v[32:39], v112
    s_mov_b64 exec, s[96:97]
    ds_read_b128 v[104:107], v114 offset:20480
    ds_read_b128 v[108:111], v114 offset:20992
    s_mov_b64 exec, -1
    v_exp_f32 v195, v195
    v_exp_f32 v196, v196
    v_exp_f32 v197, v197
    v_smfmac_f32_32x32x32_bf16 v[48:63], v[100:103], v[24:31], v112
    v_exp_f32 v198, v198
    v_exp_f32 v199, v199
    v_exp_f32 v200, v200
    v_smfmac_f32_32x32x32_bf16 v[64:79], v[100:103], v[40:47], v112
    s_waitcnt lgkmcnt(2)
    v_exp_f32 v201, v201
    v_exp_f32 v202, v202
    v_exp_f32 v203, v203
    v_mfma_f32_32x32x16_bf16 v[16:31], v[88:91], v[80:83], 0
    v_exp_f32 v204, v204
    v_exp_f32 v205, v205
    v_exp_f32 v206, v206
    v_mfma_f32_32x32x16_bf16 v[32:47], v[88:91], v[84:87], 0
    s_waitcnt lgkmcnt(0)
    ds_read_b128 v[88:91], v113 offset:16384
    v_exp_f32 v207, v207
    v_exp_f32 v208, v208
    v_exp_f32 v209, v209
    v_exp_f32 v210, v210
    v_exp_f32 v211, v211
    v_exp_f32 v212, v212
    v_exp_f32 v213, v213
    s_waitcnt vmcnt(0)
    v_cmp_ne_u32 vcc, s13, v117
    v_exp_f32 v214, v214
    v_exp_f32 v215, v215
    v_exp_f32 v216, v216
    v_exp_f32 v217, v217
    v_exp_f32 v218, v218
    v_exp_f32 v219, v219
    s_cmp_lg_u64 vcc, 0
    s_cbranch_scc1 Lgp
Lgpx:
    v_exp_f32 v220, v220
    v_exp_f32 v221, v221
    v_exp_f32 v222, v222
    v_exp_f32 v223, v223
    v_smfmac_f32_32x32x32_bf16 v[48:63], v[104:107], v[192:199], v112
    v_exp_f32 v16, v16
    v_exp_f32 v17, v17
    v_exp_f32 v18, v18
    v_smfmac_f32_32x32x32_bf16 v[64:79], v[104:107], v[208:215], v112
    s_mov_b64 exec, s[96:97]
    ds_read_b128 v[96:99], v114 offset:18432
    ds_read_b128 v[100:103], v114 offset:18944
    s_mov_b64 exec, -1
    v_exp_f32 v19, v19
    v_exp_f32 v20, v20
    v_exp_f32 v21, v21
    v_smfmac_f32_32x32x32_bf16 v[48:63], v[108:111], v[200:207], v112
    v_exp_f32 v22, v22
    v_exp_f32 v23, v23
    v_exp_f32 v24, v24
    v_smfmac_f32_32x32x32_bf16 v[64:79], v[108:111], v[216:223], v112
    s_waitcnt lgkmcnt(2)
    v_exp_f32 v25, v25
    v_exp_f32 v26, v26
    v_exp_f32 v27, v27
    v_mfma_f32_32x32x16_bf16 v[192:207], v[88:91], v[80:83], 0
    v_exp_f32 v28, v28
    v_exp_f32 v29, v29
    v_exp_f32 v30, v30
    v_mfma_f32_32x32x16_bf16 v[208:223], v[88:91], v[84:87], 0
    s_waitcnt lgkmcnt(0)
    ds_read_b128 v[88:91], v113 offset:14336
    v_exp_f32 v31, v31
    v_exp_f32 v32, v32
    v_exp_f32 v33, v33
    v_exp_f32 v34, v34
    buffer_load_dword v118, v116, s[52:55], 0 offen sc1
    v_exp_f32 v35, v35
    v_exp_f32 v36, v36
    v_exp_f32 v37, v37
    buffer_load_dword v119, v116, s[52:55], 0 offen offset:128 sc1
    v_exp_f32 v38, v38
    v_exp_f32 v39, v39
    v_exp_f32 v40, v40
    v_exp_f32 v41, v41
    v_exp_f32 v42, v42
    v_exp_f32 v43, v43
    v_exp_f32 v44, v44
    v_exp_f32 v45, v45
    v_exp_f32 v46, v46
    v_exp_f32 v47, v47
    v_smfmac_f32_32x32x32_bf16 v[48:63], v[96:99], v[16:23], v112
    v_exp_f32 v192, v192
    v_exp_f32 v193, v193
    v_exp_f32 v194, v194
    v_smfmac_f32_32x32x32_bf16 v[64:79], v[96:99], v[32:39], v112
    s_mov_b64 exec, s[96:97]
    ds_read_b128 v[104:107], v114 offset:16384
    ds_read_b128 v[108:111], v114 offset:16896
    s_mov_b64 exec, -1
    v_exp_f32 v195, v195
    v_exp_f32 v196, v196
    v_exp_f32 v197, v197
    v_smfmac_f32_32x32x32_bf16 v[48:63], v[100:103], v[24:31], v112
    v_exp_f32 v198, v198
    v_exp_f32 v199, v199
    v_exp_f32 v200, v200
    v_smfmac_f32_32x32x32_bf16 v[64:79], v[100:103], v[40:47], v112
    s_waitcnt lgkmcnt(2)
    v_exp_f32 v201, v201
    v_exp_f32 v202, v202
    v_exp_f32 v203, v203
    v_mfma_f32_32x32x16_bf16 v[16:31], v[88:91], v[80:83], 0
    v_exp_f32 v204, v204
    v_exp_f32 v205, v205
    v_exp_f32 v206, v206
    v_mfma_f32_32x32x16_bf16 v[32:47], v[88:91], v[84:87], 0
    s_waitcnt lgkmcnt(0)
    ds_read_b128 v[88:91], v113 offset:12288
    v_exp_f32 v207, v207
    v_exp_f32 v208, v208
    v_exp_f32 v209, v209
    v_exp_f32 v210, v210
    v_exp_f32 v211, v211
    v_exp_f32 v212, v212
    v_exp_f32 v213, v213
    v_exp_f32 v214, v214
    v_exp_f32 v215, v215
    v_exp_f32 v216, v216
    v_exp_f32 v217, v217
    v_exp_f32 v218, v218
    v_exp_f32 v219, v219
    v_exp_f32 v220, v220
    v_exp_f32 v221, v221
    v_exp_f32 v222, v222
    v_exp_f32 v223, v223
    v_smfmac_f32_32x32x32_bf16 v[48:63], v[104:107], v[192:199], v112
    v_exp_f32 v16, v16
    v_exp_f32 v17, v17
    v_exp_f32 v18, v18
    v_smfmac_f32_32x32x32_bf16 v[64:79], v[104:107], v[208:215], v112
    s_mov_b64 exec, s[96:97]
    ds_read_b128 v[96:99], v114 offset:14336
    ds_read_b128 v[100:103], v114 offset:14848
    s_mov_b64 exec, -1
    v_exp_f32 v19, v19
    v_exp_f32 v20, v20
    v_exp_f32 v21, v21
    v_smfmac_f32_32x32x32_bf16 v[48:63], v[108:111], v[200:207], v112
    v_exp_f32 v22, v22
    v_exp_f32 v23, v23
    v_exp_f32 v24, v24
    v_smfmac_f32_32x32x32_bf16 v[64:79], v[108:111], v[216:223], v112
    s_waitcnt lgkmcnt(2)
    v_exp_f32 v25, v25
    v_exp_f32 v26, v26
    v_exp_f32 v27, v27
    v_mfma_f32_32x32x16_bf16 v[192:207], v[88:91], v[80:83], 0
    v_exp_f32 v28, v28
    v_exp_f32 v29, v29
    v_exp_f32 v30, v30
    v_mfma_f32_32x32x16_bf16 v[208:223], v[88:91], v[84:87], 0
    s_waitcnt lgkmcnt(0)
    ds_read_b128 v[88:91], v113 offset:10240
    v_exp_f32 v31, v31
    v_exp_f32 v32, v32
    v_exp_f32 v33, v33
    v_exp_f32 v34, v34
    v_exp_f32 v35, v35
    v_exp_f32 v36, v36
    v_exp_f32 v37, v37
    v_exp_f32 v38, v38
    v_exp_f32 v39, v39
    v_exp_f32 v40, v40
    v_exp_f32 v41, v41
    v_exp_f32 v42, v42
    v_exp_f32 v43, v43
    v_exp_f32 v44, v44
    v_exp_f32 v45, v45
    v_exp_f32 v46, v46
    v_exp_f32 v47, v47
    v_smfmac_f32_32x32x32_bf16 v[48:63], v[96:99], v[16:23], v112
    v_exp_f32 v192, v192
    v_exp_f32 v193, v193
    v_exp_f32 v194, v194
    v_smfmac_f32_32x32x32_bf16 v[64:79], v[96:99], v[32:39], v112
    s_mov_b64 exec, s[96:97]
    ds_read_b128 v[104:107], v114 offset:12288
    ds_read_b128 v[108:111], v114 offset:12800
    s_mov_b64 exec, -1
    v_exp_f32 v195, v195
    v_exp_f32 v196, v196
    v_exp_f32 v197, v197
    v_smfmac_f32_32x32x32_bf16 v[48:63], v[100:103], v[24:31], v112
    v_exp_f32 v198, v198
    v_exp_f32 v199, v199
    v_exp_f32 v200, v200
    v_smfmac_f32_32x32x32_bf16 v[64:79], v[100:103], v[40:47], v112
    s_waitcnt lgkmcnt(2)
    v_exp_f32 v201, v201
    v_exp_f32 v202, v202
    v_exp_f32 v203, v203
    v_mfma_f32_32x32x16_bf16 v[16:31], v[88:91], v[80:83], 0
    v_exp_f32 v204, v204
    v_exp_f32 v205, v205
    v_exp_f32 v206, v206
    v_mfma_f32_32x32x16_bf16 v[32:47], v[88:91], v[84:87], 0
    s_waitcnt lgkmcnt(0)
    ds_read_b128 v[88:91], v113 offset:8192
    v_exp_f32 v207, v207
    v_exp_f32 v208, v208
    v_exp_f32 v209, v209
    v_exp_f32 v210, v210
    v_exp_f32 v211, v211
    v_exp_f32 v212, v212
    v_exp_f32 v213, v213
    v_exp_f32 v214, v214
    v_exp_f32 v215, v215
    v_exp_f32 v216, v216
    v_exp_f32 v217, v217
    v_exp_f32 v218, v218
    v_exp_f32 v219, v219
    v_exp_f32 v220, v220
    v_exp_f32 v221, v221
    v_exp_f32 v222, v222
    v_exp_f32 v223, v223
    v_smfmac_f32_32x32x32_bf16 v[48:63], v[104:107], v[192:199], v112
    v_exp_f32 v16, v16
    v_exp_f32 v17, v17
    v_exp_f32 v18, v18
    v_smfmac_f32_32x32x32_bf16 v[64:79], v[104:107], v[208:215], v112
    s_mov_b64 exec, s[96:97]
    ds_read_b128 v[96:99], v114 offset:10240
    ds_read_b128 v[100:103], v114 offset:10752
    s_mov_b64 exec, -1
    v_exp_f32 v19, v19
    v_exp_f32 v20, v20
    v_exp_f32 v21, v21
    v_smfmac_f32_32x32x32_bf16 v[48:63], v[108:111], v[200:207], v112
    v_exp_f32 v22, v22
    v_exp_f32 v23, v23
    v_exp_f32 v24, v24
    v_smfmac_f32_32x32x32_bf16 v[64:79], v[108:111], v[216:223], v112
    s_waitcnt lgkmcnt(2)
    v_exp_f32 v25, v25
    v_exp_f32 v26, v26
    v_exp_f32 v27, v27
    v_mfma_f32_32x32x16_bf16 v[192:207], v[88:91], v[80:83], 0
    v_exp_f32 v28, v28
    v_exp_f32 v29, v29
    v_exp_f32 v30, v30
    v_mfma_f32_32x32x16_bf16 v[208:223], v[88:91], v[84:87], 0
    s_waitcnt lgkmcnt(0)
    ds_read_b128 v[88:91], v113 offset:6144
    v_exp_f32 v31, v31
    v_exp_f32 v32, v32
    v_exp_f32 v33, v33
    v_exp_f32 v34, v34
    v_exp_f32 v35, v35
    v_exp_f32 v36, v36
    v_exp_f32 v37, v37
    v_exp_f32 v38, v38
    v_exp_f32 v39, v39
    v_exp_f32 v40, v40
    v_exp_f32 v41, v41
    v_exp_f32 v42, v42
    v_exp_f32 v43, v43
    v_exp_f32 v44, v44
    v_exp_f32 v45, v45
    v_exp_f32 v46, v46
    v_exp_f32 v47, v47
    v_smfmac_f32_32x32x32_bf16 v[48:63], v[96:99], v[16:23], v112
    v_exp_f32 v192, v192
    v_exp_f32 v193, v193
    v_exp_f32 v194, v194
    v_smfmac_f32_32x32x32_bf16 v[64:79], v[96:99], v[32:39], v112
    s_mov_b64 exec, s[96:97]
    ds_read_b128 v[104:107], v114 offset:8192
    ds_read_b128 v[108:111], v114 offset:8704
    s_mov_b64 exec, -1
    v_exp_f32 v195, v195
    v_exp_f32 v196, v196
    v_exp_f32 v197, v197
    v_smfmac_f32_32x32x32_bf16 v[48:63], v[100:103], v[24:31], v112
    v_exp_f32 v198, v198
    v_exp_f32 v199, v199
    v_exp_f32 v200, v200
    v_smfmac_f32_32x32x32_bf16 v[64:79], v[100:103], v[40:47], v112
    s_waitcnt lgkmcnt(2)
    v_exp_f32 v201, v201
    v_exp_f32 v202, v202
    v_exp_f32 v203, v203
    v_mfma_f32_32x32x16_bf16 v[16:31], v[88:91], v[80:83], 0
    v_exp_f32 v204, v204
    v_exp_f32 v205, v205
    v_exp_f32 v206, v206
    v_mfma_f32_32x32x16_bf16 v[32:47], v[88:91], v[84:87], 0
    s_waitcnt lgkmcnt(0)
    ds_read_b128 v[88:91], v113 offset:4096
    v_exp_f32 v207, v207
    v_exp_f32 v208, v208
    v_exp_f32 v209, v209
    v_exp_f32 v210, v210
    v_exp_f32 v211, v211
    v_exp_f32 v212, v212
    v_exp_f32 v213, v213
    v_exp_f32 v214, v214
    v_exp_f32 v215, v215
    v_exp_f32 v216, v216
    v_exp_f32 v217, v217
    v_exp_f32 v218, v218
    v_exp_f32 v219, v219
    v_exp_f32 v220, v220
    v_exp_f32 v221, v221
    v_exp_f32 v222, v222
    v_exp_f32 v223, v223
    v_smfmac_f32_32x32x32_bf16 v[48:63], v[104:107], v[192:199], v112
    v_exp_f32 v16, v16
    v_exp_f32 v17, v17
    v_exp_f32 v18, v18
    v_smfmac_f32_32x32x32_bf16 v[64:79], v[104:107], v[208:215], v112
    s_mov_b64 exec, s[96:97]
    ds_read_b128 v[96:99], v114 offset:6144
    ds_read_b128 v[100:103], v114 offset:6656
    s_mov_b64 exec, -1
    v_exp_f32 v19, v19
    v_exp_f32 v20, v20
    v_exp_f32 v21, v21
    v_smfmac_f32_32x32x32_bf16 v[48:63], v[108:111], v[200:207], v112
    v_exp_f32 v22, v22
    v_exp_f32 v23, v23
    v_exp_f32 v24, v24
    v_smfmac_f32_32x32x32_bf16 v[64:79], v[108:111], v[216:223], v112
    s_waitcnt lgkmcnt(2)
    v_exp_f32 v25, v25
    v_exp_f32 v26, v26
    v_exp_f32 v27, v27
    v_mfma_f32_32x32x16_bf16 v[192:207], v[88:91], v[80:83], 0
    v_exp_f32 v28, v28
    v_exp_f32 v29, v29
    v_exp_f32 v30, v30
    v_mfma_f32_32x32x16_bf16 v[208:223], v[88:91], v[84:87], 0
    s_waitcnt lgkmcnt(0)
    ds_read_b128 v[88:91], v113 offset:2048
    v_exp_f32 v31, v31
    v_exp_f32 v32, v32
    v_exp_f32 v33, v33
    v_exp_f32 v34, v34
    v_exp_f32 v35, v35
    v_exp_f32 v36, v36
    v_exp_f32 v37, v37
    v_exp_f32 v38, v38
    v_exp_f32 v39, v39
    v_exp_f32 v40, v40
    v_exp_f32 v41, v41
    v_exp_f32 v42, v42
    v_exp_f32 v43, v43
    v_exp_f32 v44, v44
    v_exp_f32 v45, v45
    v_exp_f32 v46, v46
    v_exp_f32 v47, v47
    v_smfmac_f32_32x32x32_bf16 v[48:63], v[96:99], v[16:23], v112
    v_exp_f32 v192, v192
    v_exp_f32 v193, v193
    v_exp_f32 v194, v194
    v_smfmac_f32_32x32x32_bf16 v[64:79], v[96:99], v[32:39], v112
    s_mov_b64 exec, s[96:97]
    ds_read_b128 v[104:107], v114 offset:4096
    ds_read_b128 v[108:111], v114 offset:4608
    s_mov_b64 exec, -1
    v_exp_f32 v195, v195
    v_exp_f32 v196, v196
    v_exp_f32 v197, v197
    v_smfmac_f32_32x32x32_bf16 v[48:63], v[100:103], v[24:31], v112
    v_exp_f32 v198, v198
    v_exp_f32 v199, v199
    v_exp_f32 v200, v200
    v_smfmac_f32_32x32x32_bf16 v[64:79], v[100:103], v[40:47], v112
    s_waitcnt lgkmcnt(2)
    v_exp_f32 v201, v201
    v_exp_f32 v202, v202
    v_exp_f32 v203, v203
    v_mfma_f32_32x32x16_bf16 v[16:31], v[88:91], v[80:83], 0
    v_exp_f32 v204, v204
    v_exp_f32 v205, v205
    v_exp_f32 v206, v206
    v_mfma_f32_32x32x16_bf16 v[32:47], v[88:91], v[84:87], 0
    s_waitcnt lgkmcnt(0)
    ds_read_b128 v[88:91], v113 offset:0
    v_exp_f32 v207, v207
    v_exp_f32 v208, v208
    v_exp_f32 v209, v209
    v_exp_f32 v210, v210
    v_exp_f32 v211, v211
    v_exp_f32 v212, v212
    v_exp_f32 v213, v213
    v_exp_f32 v214, v214
    v_exp_f32 v215, v215
    v_exp_f32 v216, v216
    v_exp_f32 v217, v217
    v_exp_f32 v218, v218
    v_exp_f32 v219, v219
    v_exp_f32 v220, v220
    v_exp_f32 v221, v221
    v_exp_f32 v222, v222
    v_exp_f32 v223, v223
    v_smfmac_f32_32x32x32_bf16 v[48:63], v[104:107], v[192:199], v112
    v_exp_f32 v16, v16
    v_exp_f32 v17, v17
    v_exp_f32 v18, v18
    v_smfmac_f32_32x32x32_bf16 v[64:79], v[104:107], v[208:215], v112
    s_mov_b64 exec, s[96:97]
    ds_read_b128 v[96:99], v114 offset:2048
    ds_read_b128 v[100:103], v114 offset:2560
    s_mov_b64 exec, -1
    v_exp_f32 v19, v19
    v_exp_f32 v20, v20
    v_exp_f32 v21, v21
    v_smfmac_f32_32x32x32_bf16 v[48:63], v[108:111], v[200:207], v112
    v_exp_f32 v22, v22
    v_exp_f32 v23, v23
    v_exp_f32 v24, v24
    v_smfmac_f32_32x32x32_bf16 v[64:79], v[108:111], v[216:223], v112
    s_waitcnt lgkmcnt(2)
    v_exp_f32 v25, v25
    v_exp_f32 v26, v26
    v_exp_f32 v27, v27
    v_mfma_f32_32x32x16_bf16 v[192:207], v[88:91], v[80:83], 0
    v_exp_f32 v28, v28
    v_exp_f32 v29, v29
    v_exp_f32 v30, v30
    v_mfma_f32_32x32x16_bf16 v[208:223], v[88:91], v[84:87], 0
    s_waitcnt lgkmcnt(0)
    v_exp_f32 v31, v31
    v_exp_f32 v32, v32
    v_exp_f32 v33, v33
    v_exp_f32 v34, v34
    v_exp_f32 v35, v35
    v_exp_f32 v36, v36
    v_exp_f32 v37, v37
    v_exp_f32 v38, v38
    v_exp_f32 v39, v39
    v_exp_f32 v40, v40
    v_exp_f32 v41, v41
    v_exp_f32 v42, v42
    v_exp_f32 v43, v43
    v_exp_f32 v44, v44
    v_exp_f32 v45, v45
    v_exp_f32 v46, v46
    v_exp_f32 v47, v47
    v_smfmac_f32_32x32x32_bf16 v[48:63], v[96:99], v[16:23], v112
    s_mov_b64 exec, s[96:97]
    ds_read_b128 v[104:107], v114 offset:0
    ds_read_b128 v[108:111], v114 offset:512
    s_mov_b64 exec, -1
    v_exp_f32 v192, v192
    v_exp_f32 v193, v193
    v_exp_f32 v194, v194
    v_smfmac_f32_32x32x32_bf16 v[64:79], v[96:99], v[32:39], v112
    v_exp_f32 v195, v195
    v_exp_f32 v196, v196
    v_exp_f32 v197, v197
    v_smfmac_f32_32x32x32_bf16 v[48:63], v[100:103], v[24:31], v112
    v_exp_f32 v198, v198
    v_exp_f32 v199, v199
    v_exp_f32 v200, v200
    v_smfmac_f32_32x32x32_bf16 v[64:79], v[100:103], v[40:47], v112
    v_exp_f32 v201, v201
    s_waitcnt lgkmcnt(0)
    v_smfmac_f32_32x32x32_bf16 v[48:63], v[104:107], v[192:199], v112
    v_exp_f32 v202, v202
    v_exp_f32 v203, v203
    v_exp_f32 v204, v204
    v_exp_f32 v205, v205
    v_exp_f32 v206, v206
    v_exp_f32 v207, v207
    v_exp_f32 v208, v208
    v_exp_f32 v209, v209
    v_smfmac_f32_32x32x32_bf16 v[48:63], v[108:111], v[200:207], v112
    v_exp_f32 v210, v210
    v_exp_f32 v211, v211
    v_exp_f32 v212, v212
    v_exp_f32 v213, v213
    v_exp_f32 v214, v214
    v_exp_f32 v215, v215
    v_exp_f32 v216, v216
    v_exp_f32 v217, v217
    v_smfmac_f32_32x32x32_bf16 v[64:79], v[104:107], v[208:215], v112
    v_exp_f32 v218, v218
    v_exp_f32 v219, v219
    v_exp_f32 v220, v220
    v_exp_f32 v221, v221
    v_exp_f32 v222, v222
    v_exp_f32 v223, v223
    s_nop 1
    v_smfmac_f32_32x32x32_bf16 v[64:79], v[108:111], v[216:223], v112
    s_waitcnt vmcnt(0)
    v_rcp_f32 v9, v56
    s_nop 0
    v_mul_f32 v9, v9, v118
    v_mul_f32 v48, v9, v48
    v_mul_f32 v49, v9, v49
    v_mul_f32 v50, v9, v50
    v_mul_f32 v51, v9, v51
    v_mul_f32 v52, v9, v52
    v_mul_f32 v53, v9, v53
    v_mul_f32 v54, v9, v54
    v_mul_f32 v55, v9, v55
    v_cvt_pk_bf16_f32 v48, v48, v49
    v_cvt_pk_bf16_f32 v49, v50, v51
    v_cvt_pk_bf16_f32 v50, v52, v53
    v_cvt_pk_bf16_f32 v51, v54, v55
    buffer_store_dwordx4 v[48:51], v12, s[52:55], s81 offen offset:0 sc1
    s_nop 4
    v_rcp_f32 v10, v72
    s_nop 0
    v_mul_f32 v10, v10, v119
    v_mul_f32 v64, v10, v64
    v_mul_f32 v65, v10, v65
    v_mul_f32 v66, v10, v66
    v_mul_f32 v67, v10, v67
    v_mul_f32 v68, v10, v68
    v_mul_f32 v69, v10, v69
    v_mul_f32 v70, v10, v70
    v_mul_f32 v71, v10, v71
    v_cvt_pk_bf16_f32 v64, v64, v65
    v_cvt_pk_bf16_f32 v65, v66, v67
    v_cvt_pk_bf16_f32 v66, v68, v69
    v_cvt_pk_bf16_f32 v67, v70, v71
    buffer_store_dwordx4 v[64:67], v12, s[52:55], s81 offen offset:1024 sc1
    s_mov_b32 s14, 0x7fff7fff
    s_mov_b32 s15, 0x30800000
    s_mov_b32 s92, 0x5f800000
    v_and_b32 v16, s14, v48
    v_and_b32 v17, s14, v49
    v_and_b32 v18, s14, v50
    v_and_b32 v19, s14, v51
    v_and_b32 v20, s14, v64
    v_and_b32 v21, s14, v65
    v_and_b32 v22, s14, v66
    v_and_b32 v23, s14, v67
    v_pk_max_u16 v16, v16, v20
    v_pk_max_u16 v17, v17, v21
    v_pk_max_u16 v18, v18, v22
    v_pk_max_u16 v19, v19, v23
    v_pk_max_u16 v16, v16, v18
    v_pk_max_u16 v17, v17, v19
    v_pk_max_u16 v16, v16, v17
    v_lshrrev_b32 v17, 16, v16
    v_and_b32 v16, 0xffff, v16
    v_max_u32 v16, v16, v17
    v_min_f32 v9, v56, v72
    v_max_f32 v10, v56, v72
    v_cmp_u_f32 s[82:83], v56, v72
    v_cmp_gt_u32 vcc, 0x7f80, v16
    v_cmp_lt_f32 s[84:85], s15, v9
    v_cmp_gt_f32 s[86:87], s92, v10
    s_nop 4
    s_and_b64 vcc, vcc, s[84:85]
    s_and_b64 vcc, vcc, s[86:87]
    s_andn2_b64 vcc, vcc, s[82:83]
    s_cmp_lg_u64 vcc, -1
    s_cbranch_scc1 Lslow
Lfin:
    s_barrier
    s_waitcnt vmcnt(0)
    v_mov_b32 v9, s13
    s_mov_b64 exec, 1
    buffer_store_dword v9, off, s[52:55], s89 sc1
    s_mov_b64 exec, -1
    s_endpgm
Lgp:
    s_mov_b32 s15, 400000
Lpg:
    buffer_load_dword v117, v115, s[52:55], 0 offen sc1
    s_sub_u32 s15, s15, 1
    s_cmp_eq_u32 s15, 0
    s_cbranch_scc1 Lpg_x
    s_waitcnt vmcnt(0)
    v_cmp_ne_u32 vcc, s13, v117
    s_nop 4
    s_cmp_lg_u64 vcc, 0
    s_cbranch_scc1 Lpg
Lpg_x:
    s_waitcnt vmcnt(0)
    s_branch Lgpx
Lslow:
    v_mov_b32 v113, v12
    v_mov_b32 v9, 0xff800000
    v_mov_b32 v10, 0xff800000
    s_mov_b32 s98, 0
Ls1:
    ds_read_b128 v[88:91], v113
    v_add_u32 v113, 2048, v113
    s_add_u32 s98, s98, 1
    s_waitcnt lgkmcnt(0)
    v_mfma_f32_32x32x16_bf16 v[16:31], v[88:91], v[80:83], 0
    v_mfma_f32_32x32x16_bf16 v[32:47], v[88:91], v[84:87], 0
    s_nop 7
    s_nop 3
    v_max3_f32 v9, v9, v16, v17
    v_max3_f32 v9, v9, v18, v19
    v_max3_f32 v9, v9, v20, v21
    v_max3_f32 v9, v9, v22, v23
    v_max3_f32 v9, v9, v24, v25
    v_max3_f32 v9, v9, v26, v27
    v_max3_f32 v9, v9, v28, v29
    v_max3_f32 v9, v9, v30, v31
    v_max3_f32 v10, v10, v32, v33
    v_max3_f32 v10, v10, v34, v35
    v_max3_f32 v10, v10, v36, v37
    v_max3_f32 v10, v10, v38, v39
    v_max3_f32 v10, v10, v40, v41
    v_max3_f32 v10, v10, v42, v43
    v_max3_f32 v10, v10, v44, v45
    v_max3_f32 v10, v10, v46, v47
    s_cmp_lt_u32 s98, 64
    s_cbranch_scc1 Ls1
    v_mov_b32 v11, v9
    s_nop 1
    v_permlane32_swap_b32 v9, v11
    s_nop 1
    v_max_f32 v11, v11, v9
    v_xor_b32 v11, 0x80000000, v11
    v_mov_b32 v120, v11
    v_mov_b32 v121, v11
    v_mov_b32 v122, v11
    v_mov_b32 v123, v11
    v_mov_b32 v124, v11
    v_mov_b32 v125, v11
    v_mov_b32 v126, v11
    v_mov_b32 v127, v11
    v_mov_b32 v128, v11
    v_mov_b32 v129, v11
    v_mov_b32 v130, v11
    v_mov_b32 v131, v11
    v_mov_b32 v132, v11
    v_mov_b32 v133, v11
    v_mov_b32 v134, v11
    v_mov_b32 v135, v11
    v_mov_b32 v11, v10
    s_nop 1
    v_permlane32_swap_b32 v10, v11
    s_nop 1
    v_max_f32 v11, v11, v10
    v_xor_b32 v11, 0x80000000, v11
    v_mov_b32 v136, v11
    v_mov_b32 v137, v11
    v_mov_b32 v138, v11
    v_mov_b32 v139, v11
    v_mov_b32 v140, v11
    v_mov_b32 v141, v11
    v_mov_b32 v142, v11
    v_mov_b32 v143, v11
    v_mov_b32 v144, v11
    v_mov_b32 v145, v11
    v_mov_b32 v146, v11
    v_mov_b32 v147, v11
    v_mov_b32 v148, v11
    v_mov_b32 v149, v11
    v_mov_b32 v150, v11
    v_mov_b32 v151, v11
    v_mov_b32 v48, 0
    v_mov_b32 v49, 0
    v_mov_b32 v50, 0
    v_mov_b32 v51, 0
    v_mov_b32 v52, 0
    v_mov_b32 v53, 0
    v_mov_b32 v54, 0
    v_mov_b32 v55, 0
    v_mov_b32 v56, 0
    v_mov_b32 v57, 0
    v_mov_b32 v58, 0
    v_mov_b32 v59, 0
    v_mov_b32 v60, 0
    v_mov_b32 v61, 0
    v_mov_b32 v62, 0
    v_mov_b32 v63, 0
    v_mov_b32 v64, 0
    v_mov_b32 v65, 0
    v_mov_b32 v66, 0
    v_mov_b32 v67, 0
    v_mov_b32 v68, 0
    v_mov_b32 v69, 0
    v_mov_b32 v70, 0
    v_mov_b32 v71, 0
    v_mov_b32 v72, 0
    v_mov_b32 v73, 0
    v_mov_b32 v74, 0
    v_mov_b32 v75, 0
    v_mov_b32 v76, 0
    v_mov_b32 v77, 0
    v_mov_b32 v78, 0
    v_mov_b32 v79, 0
    v_mov_b32 v113, v12
    s_mov_b32 s98, 0
Ls2:
    ds_read_b128 v[88:91], v113
    s_mov_b64 exec, s[96:97]
    ds_read_b128 v[96:99], v114
    ds_read_b128 v[100:103], v114 offset:512
    s_mov_b64 exec, -1
    v_add_u32 v113, 2048, v113
    v_add_u32 v114, 2048, v114
    s_add_u32 s98, s98, 1
    s_waitcnt lgkmcnt(0)
    v_mfma_f32_32x32x16_bf16 v[16:31], v[88:91], v[80:83], v[120:135]
    v_mfma_f32_32x32x16_bf16 v[32:47], v[88:91], v[84:87], v[136:151]
    s_nop 7
    s_nop 3
    v_exp_f32 v16, v16
    v_exp_f32 v17, v17
    v_exp_f32 v18, v18
    v_exp_f32 v19, v19
    v_exp_f32 v20, v20
    v_exp_f32 v21, v21
    v_exp_f32 v22, v22
    v_exp_f32 v23, v23
    v_exp_f32 v24, v24
    v_exp_f32 v25, v25
    v_exp_f32 v26, v26
    v_exp_f32 v27, v27
    v_exp_f32 v28, v28
    v_exp_f32 v29, v29
    v_exp_f32 v30, v30
    v_exp_f32 v31, v31
    v_exp_f32 v32, v32
    v_exp_f32 v33, v33
    v_exp_f32 v34, v34
    v_exp_f32 v35, v35
    v_exp_f32 v36, v36
    v_exp_f32 v37, v37
    v_exp_f32 v38, v38
    v_exp_f32 v39, v39
    v_exp_f32 v40, v40
    v_exp_f32 v41, v41
    v_exp_f32 v42, v42
    v_exp_f32 v43, v43
    v_exp_f32 v44, v44
    v_exp_f32 v45, v45
    v_exp_f32 v46, v46
    v_exp_f32 v47, v47
    s_nop 1
    v_smfmac_f32_32x32x32_bf16 v[48:63], v[96:99], v[16:23], v112
    v_smfmac_f32_32x32x32_bf16 v[64:79], v[96:99], v[32:39], v112
    v_smfmac_f32_32x32x32_bf16 v[48:63], v[100:103], v[24:31], v112
    v_smfmac_f32_32x32x32_bf16 v[64:79], v[100:103], v[40:47], v112
    s_cmp_lt_u32 s98, 64
    s_cbranch_scc1 Ls2
    s_nop 7
    s_nop 7
    s_waitcnt vmcnt(0)
    v_rcp_f32 v9, v56
    s_nop 0
    v_mul_f32 v9, v9, v118
    v_mul_f32 v48, v9, v48
    v_mul_f32 v49, v9, v49
    v_mul_f32 v50, v9, v50
    v_mul_f32 v51, v9, v51
    v_mul_f32 v52, v9, v52
    v_mul_f32 v53, v9, v53
    v_mul_f32 v54, v9, v54
    v_mul_f32 v55, v9, v55
    v_cvt_pk_bf16_f32 v48, v48, v49
    v_cvt_pk_bf16_f32 v49, v50, v51
    v_cvt_pk_bf16_f32 v50, v52, v53
    v_cvt_pk_bf16_f32 v51, v54, v55
    buffer_store_dwordx4 v[48:51], v12, s[52:55], s81 offen offset:0 sc1
    v_rcp_f32 v10, v72
    s_nop 0
    v_mul_f32 v10, v10, v119
    v_mul_f32 v64, v10, v64
    v_mul_f32 v65, v10, v65
    v_mul_f32 v66, v10, v66
    v_mul_f32 v67, v10, v67
    v_mul_f32 v68, v10, v68
    v_mul_f32 v69, v10, v69
    v_mul_f32 v70, v10, v70
    v_mul_f32 v71, v10, v71
    v_cvt_pk_bf16_f32 v64, v64, v65
    v_cvt_pk_bf16_f32 v65, v66, v67
    v_cvt_pk_bf16_f32 v66, v68, v69
    v_cvt_pk_bf16_f32 v67, v70, v71
    buffer_store_dwordx4 v[64:67], v12, s[52:55], s81 offen offset:1024 sc1
    s_branch Lfin
Llast_:
    s_endpgm
.section .rodata,"a"
.p2align 6
.amdhsa_kernel gated_mix__softmax_full_mha__dense_activation_squared_relu__prompt_kernel
.amdhsa_next_free_vgpr 256
.amdhsa_next_free_sgpr 102
.amdhsa_accum_offset 256
.amdhsa_group_segment_fixed_size 0
.amdhsa_kernarg_size 96
.amdhsa_user_sgpr_count 2
.amdhsa_user_sgpr_kernarg_segment_ptr 1
.amdhsa_system_sgpr_workgroup_id_x 1
.end_amdhsa_kernel
```
